```python
import torch

def _softmax(x, axis=-1):
    return torch.softmax(x, dim=axis)
def _gelu(x):
    return torch.nn.functional.gelu(x, approximate="tanh")
def _silu(x):
    return torch.nn.functional.silu(x)
def _sigmoid(x):
    return torch.sigmoid(x)
def _layernorm(x, axis=-1, eps=1e-5):
    m = x.mean(dim=axis, keepdim=True)
    v = x.var(dim=axis, keepdim=True, unbiased=False)
    return (x - m) / torch.sqrt(v + eps)
def _scatter_add(tgt, idx, src, axis=0):
    return tgt.clone().index_add_(axis, idx, src)
def _segment_sum(src, seg, n):
    out = torch.zeros((n,) + src.shape[1:], dtype=src.dtype)
    return out.index_add_(0, seg, src)
def _pad(x, pw):
    flat = tuple(v for pair in reversed(pw) for v in pair)
    return torch.nn.functional.pad(x, flat)

kernel_name = 'sequential_preLN__mha_block_cached__moe_arch_mod__decode'

def setup_inputs():

    _w = (lambda a: (lambda t: t.to(torch.bfloat16) if t.is_floating_point() else t)(torch.as_tensor(a)))
    def _A_setup():
        B, Sq, D = 4, 1, 640
        H, Sk, Dh = 32, 8192, 192
        return {
            "x": _w((lambda *s: torch.randn(*s, dtype=torch.bfloat16) * 0.05)(B, Sq, D)),
            "k_cache": _w((lambda *s: torch.randn(*s, dtype=torch.bfloat16) * 3.2)(B, H, Sk, Dh)),
            "v_cache": _w((lambda *s: torch.randn(*s, dtype=torch.bfloat16) * 0.4)(B, H, Sk, Dh)),
            "wq": _w((lambda *s: torch.randn(*s, dtype=torch.bfloat16) * 3.2)(D, H * Dh) * (D ** -0.5)),
            "wo": _w((lambda *s: torch.randn(*s, dtype=torch.bfloat16) * 0.4)(H * Dh, D) * ((H * Dh) ** -0.5)),
        }
    _A_in = _A_setup()

    def _B_setup():
        B, S, D, F, C = 4, 1, 640, 1536, 1
        return {
            "x": _w((lambda *s: torch.randn(*s, dtype=torch.bfloat16) * 0.05)(B, S, D)),
            "w_r": _w((lambda *s: torch.randn(*s, dtype=torch.bfloat16) * 0.05)(D)),
            "w_gate": _w((lambda *s: torch.randn(*s, dtype=torch.bfloat16) * 0.05)(D, F)),
            "w_up": _w((lambda *s: torch.randn(*s, dtype=torch.bfloat16) * 0.05)(D, F)),
            "w_down": _w((lambda *s: torch.randn(*s, dtype=torch.bfloat16) * 0.05)(F, D)),
        }
    _B_in = _B_setup()

    return {
        "A_x": _A_in["x"],
        "A_k_cache": _A_in["k_cache"],
        "A_v_cache": _A_in["v_cache"],
        "A_wq": _A_in["wq"],
        "A_wo": _A_in["wo"],
        "B_x": _B_in["x"],
        "B_w_r": _B_in["w_r"],
        "B_w_gate": _B_in["w_gate"],
        "B_w_up": _B_in["w_up"],
        "B_w_down": _B_in["w_down"],
    }

def reference(A_x, A_k_cache, A_v_cache, A_wq, A_wo, B_x, B_w_r, B_w_gate, B_w_up, B_w_down):
    def _A_ref(x, k_cache, v_cache, wq, wo):
        B, Sq, D = x.shape
        H, Dh = 32, 192
        q = (lambda x, *d: x.permute(*d))((x @ wq).reshape(B, Sq, H, Dh), 0, 2, 1, 3)
        scores = torch.einsum("bhqd,bhkd->bhqk", q, k_cache) * (Dh ** -0.5)
        p = _softmax(scores, axis=-1)
        o = torch.einsum("bhqk,bhkd->bhqd", p, v_cache)
        return (lambda x, *d: x.permute(*d))(o, 0, 2, 1, 3).reshape(B, Sq, H * Dh) @ wo

    def _B_ref(x, w_r, w_gate, w_up, w_down):
        B, S, D = x.shape
        C = 1
        r = x @ w_r
        idx = torch.argsort(-r, axis=-1)[:, :C]
        idx_e = (lambda x, n, axis: torch.repeat_interleave(x, n, dim=axis))(idx.reshape(B, C, 1), D, axis=2)
        x_sel = (lambda x, i, axis: torch.take_along_dim(x, i, dim=axis))(x, idx_e, axis=1)
        g = _silu(x_sel @ w_gate)
        u = x_sel @ w_up
        y = (g * u) @ w_down
        r_sel = _sigmoid((lambda x, i, axis: torch.take_along_dim(x, i, dim=axis))(r, idx, axis=1))
        y = y * r_sel.reshape(B, C, 1)
        b_off = (torch.arange(B) * S).reshape(B, 1)
        flat_idx = (idx + b_off).reshape(B * C)
        zero = (x * 0.0).reshape(B * S, D)
        upd = _scatter_add(zero, flat_idx, y.reshape(B * C, D), axis=0)
        return x + upd.reshape(B, S, D)

    x = A_x
    h = x + _A_ref(_layernorm(x, axis=-1), A_k_cache, A_v_cache, A_wq, A_wo)
    h2 = h + _B_ref(_layernorm(h, axis=-1), B_w_r, B_w_gate, B_w_up, B_w_down)
    return h2
```

```asm
; @launch kernel=attn_kernel grid=(256,1,1) block=(512,1,1) lds=48640
; @launch kernel=mlp_kernel grid=(48,1,1) block=(1024,1,1) lds=112640
.amdgcn_target "amdgcn-amd-amdhsa--gfx950"
.text
.globl attn_kernel
.p2align 8
.type attn_kernel,@function
attn_kernel:
  s_cmp_ge_u32 s2, 256
  s_cbranch_scc1 L_endA
  s_load_dwordx8 s[8:15], s[0:1], 0
  s_load_dwordx2 s[16:17], s[0:1], 32
  s_load_dwordx4 s[20:23], s[0:1], 88
  v_and_b32 v1, 63, v0
  v_lshrrev_b32 v5, 6, v0
  s_nop 0
  v_readfirstlane_b32 s59, v5
  s_and_b32 s64, s2, 1
  s_lshr_b32 s56, s2, 4
  s_lshl_b32 s56, s56, 1
  s_add_u32 s56, s56, s64
  s_bfe_u32 s57, s2, 0x10003
  s_bfe_u32 s58, s2, 0x20001
  v_mul_u32_u24 v2, 12, v1
  s_mov_b32 s82, 0x3d93cd3a
  s_mov_b32 s83, 0x3fb8aa3b
  s_mov_b32 s80, 0x11111111
  s_mov_b32 s81, 0x11111111
  s_lshl_b32 s65, s57, 6
  s_add_u32 s65, s65, s56
  s_add_u32 s66, s65, 32
  s_mul_i32 s67, s58, 786432
  s_mul_i32 s68, s59, 768
  s_add_u32 s67, s67, s68
  s_mul_i32 s60, s65, 3145728
  s_add_u32 s60, s60, s67
  s_add_u32 s61, s60, 100663296
  s_lshl_b32 s68, s58, 3
  s_lshl_b32 s74, s65, 7
  s_add_u32 s74, s74, 32768
  s_add_u32 s75, s74, 4096
  s_add_u32 s72, s74, s68
  s_add_u32 s73, s75, s68
  s_lshr_b32 s76, s65, 2
  s_lshl_b32 s76, s76, 2
  s_add_u32 s77, s76, 32
  s_and_b32 s78, s56, 3
  s_lshl_b32 s78, s78, 3
  s_lshl_b32 s79, 1, s78
  s_waitcnt lgkmcnt(0)
  s_mov_b32 s24, s8
  s_mov_b32 s25, s9
  s_mov_b32 s26, 5120
  s_mov_b32 s27, 0x00020000
  s_mov_b32 s28, s10
  s_mov_b32 s29, s11
  s_mov_b32 s30, 402653184
  s_mov_b32 s31, 0x00020000
  s_mov_b32 s32, s12
  s_mov_b32 s33, s13
  s_mov_b32 s34, 402653184
  s_mov_b32 s35, 0x00020000
  s_mov_b32 s36, s14
  s_mov_b32 s37, s15
  s_mov_b32 s38, 7864320
  s_mov_b32 s39, 0x00020000
  s_mov_b32 s40, s16
  s_mov_b32 s41, s17
  s_mov_b32 s42, 7864320
  s_mov_b32 s43, 0x00020000
  s_mov_b32 s44, s20
  s_mov_b32 s45, s21
  s_mov_b32 s46, 256
  s_mov_b32 s47, 0x00020000
  s_mov_b32 s48, s22
  s_mov_b32 s49, s23
  s_mov_b32 s50, 16777216
  s_mov_b32 s51, 0x00020000
  s_mul_i32 s8, s66, 3145728
  s_mul_i32 s64, s59, 768
  s_add_u32 s8, s8, s64
  s_lshl_b32 s64, s56, 1
  s_add_u32 s64, s64, s57
  s_lshl_b32 s9, s64, 15
  s_lshl_b32 s68, s59, 10
  s_add_u32 s9, s9, s68
  s_add_u32 s9, s9, 131072
  s_lshl_b32 s68, s58, 13
  s_add_u32 s10, s9, s68
  s_lshl_b32 s11, s64, 7
  s_add_u32 s11, s11, 65536
  s_cmp_eq_u32 s2, 0
  s_cbranch_scc0 L_nozero
  s_cmp_eq_u32 s59, 7
  s_cbranch_scc0 L_nozero
  v_mov_b32 v8, 0
  v_mov_b32 v9, 0
  v_mov_b32 v10, 0
  v_mov_b32 v11, 0
  v_lshlrev_b32 v5, 4, v1
  buffer_store_dwordx4 v[8:11], v5, s[48:51], 0 offen offset:0 sc0 sc1
  buffer_store_dwordx4 v[8:11], v5, s[48:51], 0 offen offset:1024 sc0 sc1
  buffer_store_dwordx4 v[8:11], v5, s[48:51], 0 offen offset:2048 sc0 sc1
  buffer_store_dwordx4 v[8:11], v5, s[48:51], 0 offen offset:3072 sc0 sc1
  s_mov_b32 s64, 4096
  buffer_store_dwordx4 v[8:11], v5, s[48:51], s64 offen sc0 sc1
  s_mov_b32 s64, 5120
  buffer_store_dwordx4 v[8:11], v5, s[48:51], s64 offen sc0 sc1
  s_mov_b32 s64, 6144
  buffer_store_dwordx4 v[8:11], v5, s[48:51], s64 offen sc0 sc1
  s_mov_b32 s64, 7168
  buffer_store_dwordx4 v[8:11], v5, s[48:51], s64 offen sc0 sc1
  s_mov_b32 s64, 8192
  buffer_store_dwordx4 v[8:11], v5, s[48:51], s64 offen sc0 sc1
  s_mov_b32 s64, 9216
  buffer_store_dwordx4 v[8:11], v5, s[48:51], s64 offen sc0 sc1
  s_mov_b32 s64, 16384
  buffer_store_dwordx4 v[8:11], v5, s[48:51], s64 offen sc0 sc1
  s_mov_b32 s64, 17408
  buffer_store_dwordx4 v[8:11], v5, s[48:51], s64 offen sc0 sc1
  s_mov_b32 s64, 18432
  buffer_store_dwordx4 v[8:11], v5, s[48:51], s64 offen sc0 sc1
  s_mov_b32 s64, 19456
  buffer_store_dwordx4 v[8:11], v5, s[48:51], s64 offen sc0 sc1
  s_mov_b32 s64, 20480
  buffer_store_dwordx4 v[8:11], v5, s[48:51], s64 offen sc0 sc1
  s_mov_b32 s64, 21504
  buffer_store_dwordx4 v[8:11], v5, s[48:51], s64 offen sc0 sc1
  s_mov_b32 s64, 22528
  buffer_store_dwordx4 v[8:11], v5, s[48:51], s64 offen sc0 sc1
  s_mov_b32 s64, 23552
  buffer_store_dwordx4 v[8:11], v5, s[48:51], s64 offen sc0 sc1
  s_mov_b32 s64, 24576
  buffer_store_dwordx4 v[8:11], v5, s[48:51], s64 offen sc0 sc1
  s_mov_b32 s64, 25600
  buffer_store_dwordx4 v[8:11], v5, s[48:51], s64 offen sc0 sc1
  s_mov_b32 s64, 65536
  buffer_store_dwordx4 v[8:11], v5, s[48:51], s64 offen sc0 sc1
  s_mov_b32 s64, 66560
  buffer_store_dwordx4 v[8:11], v5, s[48:51], s64 offen sc0 sc1
  s_mov_b32 s64, 67584
  buffer_store_dwordx4 v[8:11], v5, s[48:51], s64 offen sc0 sc1
  s_mov_b32 s64, 68608
  buffer_store_dwordx4 v[8:11], v5, s[48:51], s64 offen sc0 sc1
  s_mov_b32 s64, 69632
  buffer_store_dwordx4 v[8:11], v5, s[48:51], s64 offen sc0 sc1
  s_mov_b32 s64, 70656
  buffer_store_dwordx4 v[8:11], v5, s[48:51], s64 offen sc0 sc1
  s_mov_b32 s64, 71680
  buffer_store_dwordx4 v[8:11], v5, s[48:51], s64 offen sc0 sc1
  s_mov_b32 s64, 72704
  buffer_store_dwordx4 v[8:11], v5, s[48:51], s64 offen sc0 sc1
L_nozero:
  v_lshrrev_b32 v5, 4, v1
  v_bfe_u32 v6, v1, 2, 2
  v_and_b32 v7, 1, v6
  v_lshlrev_b32 v7, 1, v7
  v_lshrrev_b32 v6, 1, v6
  v_add_u32 v6, v6, v7
  v_lshlrev_b32 v6, 1, v6
  v_and_b32 v7, 1, v5
  v_add_u32 v6, v6, v7
  v_lshrrev_b32 v5, 1, v5
  v_lshlrev_b32 v5, 9, v5
  v_lshlrev_b32 v6, 2, v6
  v_add_u32 v3, v5, v6
  s_lshl_b32 s64, s59, 10
  v_add_u32 v3, s64, v3
  v_lshlrev_b32 v7, 4, v1
  v_add_u32 v7, s64, v7
  v_mov_b32 v4, 0xff800000
  v_lshrrev_b32 v5, 5, v1
  v_mul_u32_u24 v5, 12288, v5
  v_and_b32 v6, 31, v1
  v_mul_u32_u24 v6, 12, v6
  v_add_u32 v26, v5, v6
  s_mul_i32 s69, s56, 384
  s_mul_i32 s68, s59, 24576
  s_add_u32 s69, s69, s68
  s_cmp_lt_u32 s59, 2
  s_cbranch_scc0 L_ln_done
  s_lshl_b32 s68, s57, 1
  s_add_u32 s64, s59, s68
  s_mul_i32 s64, s64, 1280
  v_lshlrev_b32 v5, 4, v1
  v_lshlrev_b32 v6, 2, v1
  buffer_load_dwordx4 v[28:31], v5, s[24:27], s64 offen
  buffer_load_dword v25, v6, s[24:27], s64 offen offset:1024
  s_waitcnt vmcnt(0)
  v_lshlrev_b32 v8, 16, v28
  v_and_b32 v9, 0xffff0000, v28
  v_lshlrev_b32 v10, 16, v29
  v_and_b32 v11, 0xffff0000, v29
  v_lshlrev_b32 v12, 16, v30
  v_and_b32 v13, 0xffff0000, v30
  v_lshlrev_b32 v14, 16, v31
  v_and_b32 v15, 0xffff0000, v31
  v_lshlrev_b32 v16, 16, v25
  v_and_b32 v17, 0xffff0000, v25
  v_add_f32 v18, v8, v9
  v_add_f32 v18, v18, v10
  v_add_f32 v18, v18, v11
  v_add_f32 v18, v18, v12
  v_add_f32 v18, v18, v13
  v_add_f32 v18, v18, v14
  v_add_f32 v18, v18, v15
  v_add_f32 v18, v18, v16
  v_add_f32 v18, v18, v17
  s_nop 1
  v_add_f32_dpp v18, v18, v18 quad_perm:[1,0,3,2] row_mask:0xf bank_mask:0xf
  s_nop 1
  v_add_f32_dpp v18, v18, v18 quad_perm:[2,3,0,1] row_mask:0xf bank_mask:0xf
  s_nop 1
  v_add_f32_dpp v18, v18, v18 row_half_mirror row_mask:0xf bank_mask:0xf
  s_nop 1
  v_add_f32_dpp v18, v18, v18 row_mirror row_mask:0xf bank_mask:0xf
  v_mov_b32 v19, v18
  s_nop 1
  v_permlane16_swap_b32 v18, v19
  s_nop 1
  v_add_f32 v18, v18, v19
  v_mov_b32 v19, v18
  s_nop 1
  v_permlane32_swap_b32 v18, v19
  s_nop 1
  v_add_f32 v18, v18, v19
  v_mul_f32 v20, 0x3acccccd, v18
  v_sub_f32 v19, v8, v20
  v_mul_f32 v18, v19, v19
  v_sub_f32 v19, v9, v20
  v_fmac_f32 v18, v19, v19
  v_sub_f32 v19, v10, v20
  v_fmac_f32 v18, v19, v19
  v_sub_f32 v19, v11, v20
  v_fmac_f32 v18, v19, v19
  v_sub_f32 v19, v12, v20
  v_fmac_f32 v18, v19, v19
  v_sub_f32 v19, v13, v20
  v_fmac_f32 v18, v19, v19
  v_sub_f32 v19, v14, v20
  v_fmac_f32 v18, v19, v19
  v_sub_f32 v19, v15, v20
  v_fmac_f32 v18, v19, v19
  v_sub_f32 v19, v16, v20
  v_fmac_f32 v18, v19, v19
  v_sub_f32 v19, v17, v20
  v_fmac_f32 v18, v19, v19
  s_nop 1
  v_add_f32_dpp v18, v18, v18 quad_perm:[1,0,3,2] row_mask:0xf bank_mask:0xf
  s_nop 1
  v_add_f32_dpp v18, v18, v18 quad_perm:[2,3,0,1] row_mask:0xf bank_mask:0xf
  s_nop 1
  v_add_f32_dpp v18, v18, v18 row_half_mirror row_mask:0xf bank_mask:0xf
  s_nop 1
  v_add_f32_dpp v18, v18, v18 row_mirror row_mask:0xf bank_mask:0xf
  v_mov_b32 v19, v18
  s_nop 1
  v_permlane16_swap_b32 v18, v19
  s_nop 1
  v_add_f32 v18, v18, v19
  v_mov_b32 v19, v18
  s_nop 1
  v_permlane32_swap_b32 v18, v19
  s_nop 1
  v_add_f32 v18, v18, v19
  v_mul_f32 v21, 0x3acccccd, v18
  v_cvt_pk_bf16_f32 v20, v20, v20
  v_lshlrev_b32 v20, 16, v20
  v_cvt_pk_bf16_f32 v21, v21, v21
  v_lshlrev_b32 v21, 16, v21
  v_add_f32 v21, 0x3727c5ac, v21
  v_cvt_pk_bf16_f32 v21, v21, v21
  v_lshlrev_b32 v21, 16, v21
  v_sqrt_f32 v21, v21
  s_nop 0
  v_cvt_pk_bf16_f32 v21, v21, v21
  v_lshlrev_b32 v21, 16, v21
  v_rcp_f32 v22, v21
  s_nop 0
  v_sub_f32 v8, v8, v20
  v_cvt_pk_bf16_f32 v8, v8, v8
  v_lshlrev_b32 v8, 16, v8
  v_mul_f32 v18, v8, v22
  v_fma_f32 v19, -v18, v21, v8
  v_fma_f32 v8, v19, v22, v18
  v_cvt_pk_bf16_f32 v8, v8, v8
  v_lshlrev_b32 v8, 16, v8
  v_sub_f32 v9, v9, v20
  v_cvt_pk_bf16_f32 v9, v9, v9
  v_lshlrev_b32 v9, 16, v9
  v_mul_f32 v18, v9, v22
  v_fma_f32 v19, -v18, v21, v9
  v_fma_f32 v9, v19, v22, v18
  v_cvt_pk_bf16_f32 v9, v9, v9
  v_lshlrev_b32 v9, 16, v9
  v_sub_f32 v10, v10, v20
  v_cvt_pk_bf16_f32 v10, v10, v10
  v_lshlrev_b32 v10, 16, v10
  v_mul_f32 v18, v10, v22
  v_fma_f32 v19, -v18, v21, v10
  v_fma_f32 v10, v19, v22, v18
  v_cvt_pk_bf16_f32 v10, v10, v10
  v_lshlrev_b32 v10, 16, v10
  v_sub_f32 v11, v11, v20
  v_cvt_pk_bf16_f32 v11, v11, v11
  v_lshlrev_b32 v11, 16, v11
  v_mul_f32 v18, v11, v22
  v_fma_f32 v19, -v18, v21, v11
  v_fma_f32 v11, v19, v22, v18
  v_cvt_pk_bf16_f32 v11, v11, v11
  v_lshlrev_b32 v11, 16, v11
  v_sub_f32 v12, v12, v20
  v_cvt_pk_bf16_f32 v12, v12, v12
  v_lshlrev_b32 v12, 16, v12
  v_mul_f32 v18, v12, v22
  v_fma_f32 v19, -v18, v21, v12
  v_fma_f32 v12, v19, v22, v18
  v_cvt_pk_bf16_f32 v12, v12, v12
  v_lshlrev_b32 v12, 16, v12
  v_sub_f32 v13, v13, v20
  v_cvt_pk_bf16_f32 v13, v13, v13
  v_lshlrev_b32 v13, 16, v13
  v_mul_f32 v18, v13, v22
  v_fma_f32 v19, -v18, v21, v13
  v_fma_f32 v13, v19, v22, v18
  v_cvt_pk_bf16_f32 v13, v13, v13
  v_lshlrev_b32 v13, 16, v13
  v_sub_f32 v14, v14, v20
  v_cvt_pk_bf16_f32 v14, v14, v14
  v_lshlrev_b32 v14, 16, v14
  v_mul_f32 v18, v14, v22
  v_fma_f32 v19, -v18, v21, v14
  v_fma_f32 v14, v19, v22, v18
  v_cvt_pk_bf16_f32 v14, v14, v14
  v_lshlrev_b32 v14, 16, v14
  v_sub_f32 v15, v15, v20
  v_cvt_pk_bf16_f32 v15, v15, v15
  v_lshlrev_b32 v15, 16, v15
  v_mul_f32 v18, v15, v22
  v_fma_f32 v19, -v18, v21, v15
  v_fma_f32 v15, v19, v22, v18
  v_cvt_pk_bf16_f32 v15, v15, v15
  v_lshlrev_b32 v15, 16, v15
  v_sub_f32 v16, v16, v20
  v_cvt_pk_bf16_f32 v16, v16, v16
  v_lshlrev_b32 v16, 16, v16
  v_mul_f32 v18, v16, v22
  v_fma_f32 v19, -v18, v21, v16
  v_fma_f32 v16, v19, v22, v18
  v_cvt_pk_bf16_f32 v16, v16, v16
  v_lshlrev_b32 v16, 16, v16
  v_sub_f32 v17, v17, v20
  v_cvt_pk_bf16_f32 v17, v17, v17
  v_lshlrev_b32 v17, 16, v17
  v_mul_f32 v18, v17, v22
  v_fma_f32 v19, -v18, v21, v17
  v_fma_f32 v17, v19, v22, v18
  v_cvt_pk_bf16_f32 v17, v17, v17
  v_lshlrev_b32 v17, 16, v17
  v_mov_b32 v6, 0
  v_cvt_pk_bf16_f32 v8, v8, v6
  v_cvt_pk_bf16_f32 v9, v9, v6
  v_cvt_pk_bf16_f32 v10, v10, v6
  v_cvt_pk_bf16_f32 v11, v11, v6
  v_cvt_pk_bf16_f32 v12, v12, v6
  v_cvt_pk_bf16_f32 v13, v13, v6
  v_cvt_pk_bf16_f32 v14, v14, v6
  v_cvt_pk_bf16_f32 v15, v15, v6
  v_cvt_pk_bf16_f32 v16, v16, v6
  v_cvt_pk_bf16_f32 v17, v17, v6
  v_and_b32 v5, 1, v1
  v_mul_u32_u24 v5, 1280, v5
  v_lshrrev_b32 v6, 1, v1
  v_lshlrev_b32 v6, 2, v6
  v_add_u32 v5, v5, v6
  s_mul_i32 s64, s59, 2560
  v_add_u32 v5, s64, v5
  ds_write_b32 v5, v8 offset:16384
  ds_write_b32 v5, v9 offset:16544
  ds_write_b32 v5, v10 offset:16704
  ds_write_b32 v5, v11 offset:16864
  ds_write_b32 v5, v12 offset:17024
  ds_write_b32 v5, v13 offset:17184
  ds_write_b32 v5, v14 offset:17344
  ds_write_b32 v5, v15 offset:17504
  v_and_b32 v5, 7, v1
  v_mul_u32_u24 v5, 320, v5
  v_lshrrev_b32 v6, 3, v1
  v_lshlrev_b32 v6, 2, v6
  v_add_u32 v5, v5, v6
  v_add_u32 v5, s64, v5
  ds_write_b32 v5, v16 offset:16512
  ds_write_b32 v5, v17 offset:16672
L_ln_done:
  buffer_load_dwordx3 v[32:34], v26, s[36:39], s69 offen
  s_add_u32 s69, s69, 196608
  buffer_load_dwordx3 v[36:38], v26, s[36:39], s69 offen
  s_add_u32 s69, s69, 196608
  buffer_load_dwordx3 v[40:42], v26, s[36:39], s69 offen
  s_add_u32 s69, s69, 196608
  buffer_load_dwordx3 v[44:46], v26, s[36:39], s69 offen
  s_add_u32 s69, s69, 196608
  buffer_load_dwordx3 v[48:50], v26, s[36:39], s69 offen
  s_add_u32 s69, s69, 196608
  buffer_load_dwordx3 v[52:54], v26, s[36:39], s69 offen
  s_add_u32 s69, s69, 196608
  buffer_load_dwordx3 v[56:58], v26, s[36:39], s69 offen
  s_add_u32 s69, s69, 196608
  buffer_load_dwordx3 v[60:62], v26, s[36:39], s69 offen
  s_add_u32 s69, s69, 196608
  buffer_load_dwordx3 v[64:66], v26, s[36:39], s69 offen
  s_add_u32 s69, s69, 196608
  buffer_load_dwordx3 v[68:70], v26, s[36:39], s69 offen
  s_add_u32 s69, s69, 196608
  buffer_load_dwordx3 v[72:74], v26, s[36:39], s69 offen
  s_add_u32 s69, s69, 196608
  buffer_load_dwordx3 v[76:78], v26, s[36:39], s69 offen
  s_add_u32 s69, s69, 196608
  buffer_load_dwordx3 v[80:82], v26, s[36:39], s69 offen
  s_add_u32 s69, s69, 196608
  buffer_load_dwordx3 v[84:86], v26, s[36:39], s69 offen
  s_add_u32 s69, s69, 196608
  buffer_load_dwordx3 v[88:90], v26, s[36:39], s69 offen
  s_add_u32 s69, s69, 196608
  buffer_load_dwordx3 v[92:94], v26, s[36:39], s69 offen
  s_add_u32 s69, s69, 196608
  buffer_load_dwordx3 v[96:98], v26, s[36:39], s69 offen
  s_add_u32 s69, s69, 196608
  buffer_load_dwordx3 v[100:102], v26, s[36:39], s69 offen
  s_add_u32 s69, s69, 196608
  buffer_load_dwordx3 v[104:106], v26, s[36:39], s69 offen
  s_add_u32 s69, s69, 196608
  buffer_load_dwordx3 v[108:110], v26, s[36:39], s69 offen
  s_add_u32 s69, s69, 196608
  buffer_load_dwordx3 v[112:114], v26, s[36:39], s69 offen
  s_add_u32 s69, s69, 196608
  buffer_load_dwordx3 v[116:118], v26, s[36:39], s69 offen
  s_add_u32 s69, s69, 196608
  buffer_load_dwordx3 v[120:122], v26, s[36:39], s69 offen
  s_add_u32 s69, s69, 196608
  buffer_load_dwordx3 v[124:126], v26, s[36:39], s69 offen
  s_add_u32 s69, s69, 196608
  buffer_load_dwordx3 v[192:194], v26, s[36:39], s69 offen
  s_add_u32 s69, s69, 196608
  buffer_load_dwordx3 v[196:198], v26, s[36:39], s69 offen
  s_add_u32 s69, s69, 196608
  buffer_load_dwordx3 v[200:202], v26, s[36:39], s69 offen
  s_add_u32 s69, s69, 196608
  buffer_load_dwordx3 v[204:206], v26, s[36:39], s69 offen
  s_add_u32 s69, s69, 196608
  buffer_load_dwordx3 v[208:210], v26, s[36:39], s69 offen
  s_add_u32 s69, s69, 196608
  buffer_load_dwordx3 v[212:214], v26, s[36:39], s69 offen
  s_add_u32 s69, s69, 196608
  buffer_load_dwordx3 v[216:218], v26, s[36:39], s69 offen
  s_add_u32 s69, s69, 196608
  buffer_load_dwordx3 v[220:222], v26, s[36:39], s69 offen
  s_add_u32 s69, s69, 196608
  buffer_load_dwordx3 v[224:226], v26, s[36:39], s69 offen
  s_add_u32 s69, s69, 196608
  buffer_load_dwordx3 v[228:230], v26, s[36:39], s69 offen
  s_add_u32 s69, s69, 196608
  buffer_load_dwordx3 v[232:234], v26, s[36:39], s69 offen
  s_add_u32 s69, s69, 196608
  buffer_load_dwordx3 v[236:238], v26, s[36:39], s69 offen
  s_add_u32 s69, s69, 196608
  buffer_load_dwordx3 v[240:242], v26, s[36:39], s69 offen
  s_add_u32 s69, s69, 196608
  buffer_load_dwordx3 v[244:246], v26, s[36:39], s69 offen
  s_add_u32 s69, s69, 196608
  buffer_load_dwordx3 v[248:250], v26, s[36:39], s69 offen
  s_add_u32 s69, s69, 196608
  buffer_load_dwordx3 v[252:254], v26, s[36:39], s69 offen
  s_add_u32 s69, s69, 196608
  s_waitcnt lgkmcnt(0)
  s_barrier
  s_mov_b32 s52, s28
  s_mov_b32 s53, s29
  s_mov_b32 s54, s30
  s_mov_b32 s55, s31
  s_mov_b32 s62, s60
  v_mov_b32 v14, 0
  v_mov_b32 v15, 0
  v_mov_b32 v16, 0
  v_mov_b32 v17, 0
  v_mov_b32 v18, 0
  v_mov_b32 v19, 0
  v_mov_b32 v20, 0
  v_mov_b32 v21, 0
  v_mov_b32 v22, 0
  v_mov_b32 v23, 0
  v_mov_b32 v24, 0
  v_mov_b32 v25, 0
  v_lshrrev_b32 v5, 5, v1
  s_lshl_b32 s64, s59, 1
  v_add_u32 v5, s64, v5
  v_mul_u32_u24 v27, 160, v5
  ds_read_b128 v[8:11], v27 offset:16384
  ds_read_b128 v[28:31], v27 offset:18944
  s_waitcnt vmcnt(39) lgkmcnt(0)
  v_lshlrev_b32 v8, 16, v8
  v_lshlrev_b32 v28, 16, v28
  v_lshlrev_b32 v9, 16, v9
  v_lshlrev_b32 v29, 16, v29
  v_lshlrev_b32 v10, 16, v10
  v_lshlrev_b32 v30, 16, v30
  v_lshlrev_b32 v11, 16, v11
  v_lshlrev_b32 v31, 16, v31
  v_lshlrev_b32 v5, 16, v32
  v_and_b32 v6, 0xffff0000, v32
  v_fmac_f32 v14, v5, v8
  v_fmac_f32 v15, v6, v8
  v_fmac_f32 v20, v5, v28
  v_fmac_f32 v21, v6, v28
  v_lshlrev_b32 v5, 16, v33
  v_and_b32 v6, 0xffff0000, v33
  v_fmac_f32 v16, v5, v8
  v_fmac_f32 v17, v6, v8
  v_fmac_f32 v22, v5, v28
  v_fmac_f32 v23, v6, v28
  v_lshlrev_b32 v5, 16, v34
  v_and_b32 v6, 0xffff0000, v34
  v_fmac_f32 v18, v5, v8
  v_fmac_f32 v19, v6, v8
  v_fmac_f32 v24, v5, v28
  v_fmac_f32 v25, v6, v28
  buffer_load_dwordx3 v[128:130], v2, s[52:55], s62 offen nt
  s_add_u32 s62, s62, 6144
  s_waitcnt vmcnt(39)
  v_lshlrev_b32 v5, 16, v36
  v_and_b32 v6, 0xffff0000, v36
  v_fmac_f32 v14, v5, v9
  v_fmac_f32 v15, v6, v9
  v_fmac_f32 v20, v5, v29
  v_fmac_f32 v21, v6, v29
  v_lshlrev_b32 v5, 16, v37
  v_and_b32 v6, 0xffff0000, v37
  v_fmac_f32 v16, v5, v9
  v_fmac_f32 v17, v6, v9
  v_fmac_f32 v22, v5, v29
  v_fmac_f32 v23, v6, v29
  v_lshlrev_b32 v5, 16, v38
  v_and_b32 v6, 0xffff0000, v38
  v_fmac_f32 v18, v5, v9
  v_fmac_f32 v19, v6, v9
  v_fmac_f32 v24, v5, v29
  v_fmac_f32 v25, v6, v29
  buffer_load_dwordx3 v[132:134], v2, s[52:55], s62 offen nt
  s_add_u32 s62, s62, 6144
  s_waitcnt vmcnt(39)
  v_lshlrev_b32 v5, 16, v40
  v_and_b32 v6, 0xffff0000, v40
  v_fmac_f32 v14, v5, v10
  v_fmac_f32 v15, v6, v10
  v_fmac_f32 v20, v5, v30
  v_fmac_f32 v21, v6, v30
  v_lshlrev_b32 v5, 16, v41
  v_and_b32 v6, 0xffff0000, v41
  v_fmac_f32 v16, v5, v10
  v_fmac_f32 v17, v6, v10
  v_fmac_f32 v22, v5, v30
  v_fmac_f32 v23, v6, v30
  v_lshlrev_b32 v5, 16, v42
  v_and_b32 v6, 0xffff0000, v42
  v_fmac_f32 v18, v5, v10
  v_fmac_f32 v19, v6, v10
  v_fmac_f32 v24, v5, v30
  v_fmac_f32 v25, v6, v30
  buffer_load_dwordx3 v[136:138], v2, s[52:55], s62 offen nt
  s_add_u32 s62, s62, 6144
  s_waitcnt vmcnt(39)
  v_lshlrev_b32 v5, 16, v44
  v_and_b32 v6, 0xffff0000, v44
  v_fmac_f32 v14, v5, v11
  v_fmac_f32 v15, v6, v11
  v_fmac_f32 v20, v5, v31
  v_fmac_f32 v21, v6, v31
  v_lshlrev_b32 v5, 16, v45
  v_and_b32 v6, 0xffff0000, v45
  v_fmac_f32 v16, v5, v11
  v_fmac_f32 v17, v6, v11
  v_fmac_f32 v22, v5, v31
  v_fmac_f32 v23, v6, v31
  v_lshlrev_b32 v5, 16, v46
  v_and_b32 v6, 0xffff0000, v46
  v_fmac_f32 v18, v5, v11
  v_fmac_f32 v19, v6, v11
  v_fmac_f32 v24, v5, v31
  v_fmac_f32 v25, v6, v31
  buffer_load_dwordx3 v[140:142], v2, s[52:55], s62 offen nt
  s_add_u32 s62, s62, 6144
  s_cmp_eq_u32 s2, 0
  s_cbranch_scc0 L_nozf
  s_cmp_eq_u32 s59, 7
  s_cbranch_scc0 L_nozf
  v_mov_b32 v5, 1
  v_mov_b32 v6, 0
  s_mov_b64 exec, 1
  buffer_store_dword v5, v6, s[44:47], 0 offen offset:160 sc0 sc1
  s_mov_b64 exec, -1
L_nozf:
  ds_read_b128 v[8:11], v27 offset:16400
  ds_read_b128 v[28:31], v27 offset:18960
  s_waitcnt vmcnt(39) lgkmcnt(0)
  v_lshlrev_b32 v8, 16, v8
  v_lshlrev_b32 v28, 16, v28
  v_lshlrev_b32 v9, 16, v9
  v_lshlrev_b32 v29, 16, v29
  v_lshlrev_b32 v10, 16, v10
  v_lshlrev_b32 v30, 16, v30
  v_lshlrev_b32 v11, 16, v11
  v_lshlrev_b32 v31, 16, v31
  v_lshlrev_b32 v5, 16, v48
  v_and_b32 v6, 0xffff0000, v48
  v_fmac_f32 v14, v5, v8
  v_fmac_f32 v15, v6, v8
  v_fmac_f32 v20, v5, v28
  v_fmac_f32 v21, v6, v28
  v_lshlrev_b32 v5, 16, v49
  v_and_b32 v6, 0xffff0000, v49
  v_fmac_f32 v16, v5, v8
  v_fmac_f32 v17, v6, v8
  v_fmac_f32 v22, v5, v28
  v_fmac_f32 v23, v6, v28
  v_lshlrev_b32 v5, 16, v50
  v_and_b32 v6, 0xffff0000, v50
  v_fmac_f32 v18, v5, v8
  v_fmac_f32 v19, v6, v8
  v_fmac_f32 v24, v5, v28
  v_fmac_f32 v25, v6, v28
  buffer_load_dwordx3 v[144:146], v2, s[52:55], s62 offen nt
  s_add_u32 s62, s62, 6144
  s_waitcnt vmcnt(39)
  v_lshlrev_b32 v5, 16, v52
  v_and_b32 v6, 0xffff0000, v52
  v_fmac_f32 v14, v5, v9
  v_fmac_f32 v15, v6, v9
  v_fmac_f32 v20, v5, v29
  v_fmac_f32 v21, v6, v29
  v_lshlrev_b32 v5, 16, v53
  v_and_b32 v6, 0xffff0000, v53
  v_fmac_f32 v16, v5, v9
  v_fmac_f32 v17, v6, v9
  v_fmac_f32 v22, v5, v29
  v_fmac_f32 v23, v6, v29
  v_lshlrev_b32 v5, 16, v54
  v_and_b32 v6, 0xffff0000, v54
  v_fmac_f32 v18, v5, v9
  v_fmac_f32 v19, v6, v9
  v_fmac_f32 v24, v5, v29
  v_fmac_f32 v25, v6, v29
  buffer_load_dwordx3 v[148:150], v2, s[52:55], s62 offen nt
  s_add_u32 s62, s62, 6144
  s_waitcnt vmcnt(39)
  v_lshlrev_b32 v5, 16, v56
  v_and_b32 v6, 0xffff0000, v56
  v_fmac_f32 v14, v5, v10
  v_fmac_f32 v15, v6, v10
  v_fmac_f32 v20, v5, v30
  v_fmac_f32 v21, v6, v30
  v_lshlrev_b32 v5, 16, v57
  v_and_b32 v6, 0xffff0000, v57
  v_fmac_f32 v16, v5, v10
  v_fmac_f32 v17, v6, v10
  v_fmac_f32 v22, v5, v30
  v_fmac_f32 v23, v6, v30
  v_lshlrev_b32 v5, 16, v58
  v_and_b32 v6, 0xffff0000, v58
  v_fmac_f32 v18, v5, v10
  v_fmac_f32 v19, v6, v10
  v_fmac_f32 v24, v5, v30
  v_fmac_f32 v25, v6, v30
  buffer_load_dwordx3 v[152:154], v2, s[52:55], s62 offen nt
  s_add_u32 s62, s62, 6144
  s_waitcnt vmcnt(39)
  v_lshlrev_b32 v5, 16, v60
  v_and_b32 v6, 0xffff0000, v60
  v_fmac_f32 v14, v5, v11
  v_fmac_f32 v15, v6, v11
  v_fmac_f32 v20, v5, v31
  v_fmac_f32 v21, v6, v31
  v_lshlrev_b32 v5, 16, v61
  v_and_b32 v6, 0xffff0000, v61
  v_fmac_f32 v16, v5, v11
  v_fmac_f32 v17, v6, v11
  v_fmac_f32 v22, v5, v31
  v_fmac_f32 v23, v6, v31
  v_lshlrev_b32 v5, 16, v62
  v_and_b32 v6, 0xffff0000, v62
  v_fmac_f32 v18, v5, v11
  v_fmac_f32 v19, v6, v11
  v_fmac_f32 v24, v5, v31
  v_fmac_f32 v25, v6, v31
  buffer_load_dwordx3 v[156:158], v2, s[52:55], s62 offen nt
  s_add_u32 s62, s62, 6144
  ds_read_b128 v[8:11], v27 offset:16416
  ds_read_b128 v[28:31], v27 offset:18976
  s_waitcnt vmcnt(39) lgkmcnt(0)
  v_lshlrev_b32 v8, 16, v8
  v_lshlrev_b32 v28, 16, v28
  v_lshlrev_b32 v9, 16, v9
  v_lshlrev_b32 v29, 16, v29
  v_lshlrev_b32 v10, 16, v10
  v_lshlrev_b32 v30, 16, v30
  v_lshlrev_b32 v11, 16, v11
  v_lshlrev_b32 v31, 16, v31
  v_lshlrev_b32 v5, 16, v64
  v_and_b32 v6, 0xffff0000, v64
  v_fmac_f32 v14, v5, v8
  v_fmac_f32 v15, v6, v8
  v_fmac_f32 v20, v5, v28
  v_fmac_f32 v21, v6, v28
  v_lshlrev_b32 v5, 16, v65
  v_and_b32 v6, 0xffff0000, v65
  v_fmac_f32 v16, v5, v8
  v_fmac_f32 v17, v6, v8
  v_fmac_f32 v22, v5, v28
  v_fmac_f32 v23, v6, v28
  v_lshlrev_b32 v5, 16, v66
  v_and_b32 v6, 0xffff0000, v66
  v_fmac_f32 v18, v5, v8
  v_fmac_f32 v19, v6, v8
  v_fmac_f32 v24, v5, v28
  v_fmac_f32 v25, v6, v28
  buffer_load_dwordx3 v[160:162], v2, s[52:55], s62 offen nt
  s_add_u32 s62, s62, 6144
  s_waitcnt vmcnt(39)
  v_lshlrev_b32 v5, 16, v68
  v_and_b32 v6, 0xffff0000, v68
  v_fmac_f32 v14, v5, v9
  v_fmac_f32 v15, v6, v9
  v_fmac_f32 v20, v5, v29
  v_fmac_f32 v21, v6, v29
  v_lshlrev_b32 v5, 16, v69
  v_and_b32 v6, 0xffff0000, v69
  v_fmac_f32 v16, v5, v9
  v_fmac_f32 v17, v6, v9
  v_fmac_f32 v22, v5, v29
  v_fmac_f32 v23, v6, v29
  v_lshlrev_b32 v5, 16, v70
  v_and_b32 v6, 0xffff0000, v70
  v_fmac_f32 v18, v5, v9
  v_fmac_f32 v19, v6, v9
  v_fmac_f32 v24, v5, v29
  v_fmac_f32 v25, v6, v29
  buffer_load_dwordx3 v[164:166], v2, s[52:55], s62 offen nt
  s_add_u32 s62, s62, 6144
  s_waitcnt vmcnt(39)
  v_lshlrev_b32 v5, 16, v72
  v_and_b32 v6, 0xffff0000, v72
  v_fmac_f32 v14, v5, v10
  v_fmac_f32 v15, v6, v10
  v_fmac_f32 v20, v5, v30
  v_fmac_f32 v21, v6, v30
  v_lshlrev_b32 v5, 16, v73
  v_and_b32 v6, 0xffff0000, v73
  v_fmac_f32 v16, v5, v10
  v_fmac_f32 v17, v6, v10
  v_fmac_f32 v22, v5, v30
  v_fmac_f32 v23, v6, v30
  v_lshlrev_b32 v5, 16, v74
  v_and_b32 v6, 0xffff0000, v74
  v_fmac_f32 v18, v5, v10
  v_fmac_f32 v19, v6, v10
  v_fmac_f32 v24, v5, v30
  v_fmac_f32 v25, v6, v30
  buffer_load_dwordx3 v[168:170], v2, s[52:55], s62 offen nt
  s_add_u32 s62, s62, 6144
  s_waitcnt vmcnt(39)
  v_lshlrev_b32 v5, 16, v76
  v_and_b32 v6, 0xffff0000, v76
  v_fmac_f32 v14, v5, v11
  v_fmac_f32 v15, v6, v11
  v_fmac_f32 v20, v5, v31
  v_fmac_f32 v21, v6, v31
  v_lshlrev_b32 v5, 16, v77
  v_and_b32 v6, 0xffff0000, v77
  v_fmac_f32 v16, v5, v11
  v_fmac_f32 v17, v6, v11
  v_fmac_f32 v22, v5, v31
  v_fmac_f32 v23, v6, v31
  v_lshlrev_b32 v5, 16, v78
  v_and_b32 v6, 0xffff0000, v78
  v_fmac_f32 v18, v5, v11
  v_fmac_f32 v19, v6, v11
  v_fmac_f32 v24, v5, v31
  v_fmac_f32 v25, v6, v31
  buffer_load_dwordx3 v[172:174], v2, s[52:55], s62 offen nt
  s_add_u32 s62, s62, 6144
  ds_read_b128 v[8:11], v27 offset:16432
  ds_read_b128 v[28:31], v27 offset:18992
  s_waitcnt vmcnt(39) lgkmcnt(0)
  v_lshlrev_b32 v8, 16, v8
  v_lshlrev_b32 v28, 16, v28
  v_lshlrev_b32 v9, 16, v9
  v_lshlrev_b32 v29, 16, v29
  v_lshlrev_b32 v10, 16, v10
  v_lshlrev_b32 v30, 16, v30
  v_lshlrev_b32 v11, 16, v11
  v_lshlrev_b32 v31, 16, v31
  v_lshlrev_b32 v5, 16, v80
  v_and_b32 v6, 0xffff0000, v80
  v_fmac_f32 v14, v5, v8
  v_fmac_f32 v15, v6, v8
  v_fmac_f32 v20, v5, v28
  v_fmac_f32 v21, v6, v28
  v_lshlrev_b32 v5, 16, v81
  v_and_b32 v6, 0xffff0000, v81
  v_fmac_f32 v16, v5, v8
  v_fmac_f32 v17, v6, v8
  v_fmac_f32 v22, v5, v28
  v_fmac_f32 v23, v6, v28
  v_lshlrev_b32 v5, 16, v82
  v_and_b32 v6, 0xffff0000, v82
  v_fmac_f32 v18, v5, v8
  v_fmac_f32 v19, v6, v8
  v_fmac_f32 v24, v5, v28
  v_fmac_f32 v25, v6, v28
  buffer_load_dwordx3 v[176:178], v2, s[52:55], s62 offen nt
  s_add_u32 s62, s62, 6144
  s_waitcnt vmcnt(39)
  v_lshlrev_b32 v5, 16, v84
  v_and_b32 v6, 0xffff0000, v84
  v_fmac_f32 v14, v5, v9
  v_fmac_f32 v15, v6, v9
  v_fmac_f32 v20, v5, v29
  v_fmac_f32 v21, v6, v29
  v_lshlrev_b32 v5, 16, v85
  v_and_b32 v6, 0xffff0000, v85
  v_fmac_f32 v16, v5, v9
  v_fmac_f32 v17, v6, v9
  v_fmac_f32 v22, v5, v29
  v_fmac_f32 v23, v6, v29
  v_lshlrev_b32 v5, 16, v86
  v_and_b32 v6, 0xffff0000, v86
  v_fmac_f32 v18, v5, v9
  v_fmac_f32 v19, v6, v9
  v_fmac_f32 v24, v5, v29
  v_fmac_f32 v25, v6, v29
  buffer_load_dwordx3 v[180:182], v2, s[52:55], s62 offen nt
  s_add_u32 s62, s62, 6144
  s_waitcnt vmcnt(39)
  v_lshlrev_b32 v5, 16, v88
  v_and_b32 v6, 0xffff0000, v88
  v_fmac_f32 v14, v5, v10
  v_fmac_f32 v15, v6, v10
  v_fmac_f32 v20, v5, v30
  v_fmac_f32 v21, v6, v30
  v_lshlrev_b32 v5, 16, v89
  v_and_b32 v6, 0xffff0000, v89
  v_fmac_f32 v16, v5, v10
  v_fmac_f32 v17, v6, v10
  v_fmac_f32 v22, v5, v30
  v_fmac_f32 v23, v6, v30
  v_lshlrev_b32 v5, 16, v90
  v_and_b32 v6, 0xffff0000, v90
  v_fmac_f32 v18, v5, v10
  v_fmac_f32 v19, v6, v10
  v_fmac_f32 v24, v5, v30
  v_fmac_f32 v25, v6, v30
  buffer_load_dwordx3 v[184:186], v2, s[52:55], s62 offen nt
  s_add_u32 s62, s62, 6144
  s_waitcnt vmcnt(39)
  v_lshlrev_b32 v5, 16, v92
  v_and_b32 v6, 0xffff0000, v92
  v_fmac_f32 v14, v5, v11
  v_fmac_f32 v15, v6, v11
  v_fmac_f32 v20, v5, v31
  v_fmac_f32 v21, v6, v31
  v_lshlrev_b32 v5, 16, v93
  v_and_b32 v6, 0xffff0000, v93
  v_fmac_f32 v16, v5, v11
  v_fmac_f32 v17, v6, v11
  v_fmac_f32 v22, v5, v31
  v_fmac_f32 v23, v6, v31
  v_lshlrev_b32 v5, 16, v94
  v_and_b32 v6, 0xffff0000, v94
  v_fmac_f32 v18, v5, v11
  v_fmac_f32 v19, v6, v11
  v_fmac_f32 v24, v5, v31
  v_fmac_f32 v25, v6, v31
  buffer_load_dwordx3 v[188:190], v2, s[52:55], s62 offen nt
  s_add_u32 s62, s62, 6144
  ds_read_b128 v[8:11], v27 offset:16448
  ds_read_b128 v[28:31], v27 offset:19008
  s_waitcnt vmcnt(39) lgkmcnt(0)
  v_lshlrev_b32 v8, 16, v8
  v_lshlrev_b32 v28, 16, v28
  v_lshlrev_b32 v9, 16, v9
  v_lshlrev_b32 v29, 16, v29
  v_lshlrev_b32 v10, 16, v10
  v_lshlrev_b32 v30, 16, v30
  v_lshlrev_b32 v11, 16, v11
  v_lshlrev_b32 v31, 16, v31
  v_lshlrev_b32 v5, 16, v96
  v_and_b32 v6, 0xffff0000, v96
  v_fmac_f32 v14, v5, v8
  v_fmac_f32 v15, v6, v8
  v_fmac_f32 v20, v5, v28
  v_fmac_f32 v21, v6, v28
  v_lshlrev_b32 v5, 16, v97
  v_and_b32 v6, 0xffff0000, v97
  v_fmac_f32 v16, v5, v8
  v_fmac_f32 v17, v6, v8
  v_fmac_f32 v22, v5, v28
  v_fmac_f32 v23, v6, v28
  v_lshlrev_b32 v5, 16, v98
  v_and_b32 v6, 0xffff0000, v98
  v_fmac_f32 v18, v5, v8
  v_fmac_f32 v19, v6, v8
  v_fmac_f32 v24, v5, v28
  v_fmac_f32 v25, v6, v28
  s_waitcnt vmcnt(38)
  v_lshlrev_b32 v5, 16, v100
  v_and_b32 v6, 0xffff0000, v100
  v_fmac_f32 v14, v5, v9
  v_fmac_f32 v15, v6, v9
  v_fmac_f32 v20, v5, v29
  v_fmac_f32 v21, v6, v29
  v_lshlrev_b32 v5, 16, v101
  v_and_b32 v6, 0xffff0000, v101
  v_fmac_f32 v16, v5, v9
  v_fmac_f32 v17, v6, v9
  v_fmac_f32 v22, v5, v29
  v_fmac_f32 v23, v6, v29
  v_lshlrev_b32 v5, 16, v102
  v_and_b32 v6, 0xffff0000, v102
  v_fmac_f32 v18, v5, v9
  v_fmac_f32 v19, v6, v9
  v_fmac_f32 v24, v5, v29
  v_fmac_f32 v25, v6, v29
  s_waitcnt vmcnt(37)
  v_lshlrev_b32 v5, 16, v104
  v_and_b32 v6, 0xffff0000, v104
  v_fmac_f32 v14, v5, v10
  v_fmac_f32 v15, v6, v10
  v_fmac_f32 v20, v5, v30
  v_fmac_f32 v21, v6, v30
  v_lshlrev_b32 v5, 16, v105
  v_and_b32 v6, 0xffff0000, v105
  v_fmac_f32 v16, v5, v10
  v_fmac_f32 v17, v6, v10
  v_fmac_f32 v22, v5, v30
  v_fmac_f32 v23, v6, v30
  v_lshlrev_b32 v5, 16, v106
  v_and_b32 v6, 0xffff0000, v106
  v_fmac_f32 v18, v5, v10
  v_fmac_f32 v19, v6, v10
  v_fmac_f32 v24, v5, v30
  v_fmac_f32 v25, v6, v30
  s_waitcnt vmcnt(36)
  v_lshlrev_b32 v5, 16, v108
  v_and_b32 v6, 0xffff0000, v108
  v_fmac_f32 v14, v5, v11
  v_fmac_f32 v15, v6, v11
  v_fmac_f32 v20, v5, v31
  v_fmac_f32 v21, v6, v31
  v_lshlrev_b32 v5, 16, v109
  v_and_b32 v6, 0xffff0000, v109
  v_fmac_f32 v16, v5, v11
  v_fmac_f32 v17, v6, v11
  v_fmac_f32 v22, v5, v31
  v_fmac_f32 v23, v6, v31
  v_lshlrev_b32 v5, 16, v110
  v_and_b32 v6, 0xffff0000, v110
  v_fmac_f32 v18, v5, v11
  v_fmac_f32 v19, v6, v11
  v_fmac_f32 v24, v5, v31
  v_fmac_f32 v25, v6, v31
  ds_read_b128 v[8:11], v27 offset:16464
  ds_read_b128 v[28:31], v27 offset:19024
  s_waitcnt vmcnt(35) lgkmcnt(0)
  v_lshlrev_b32 v8, 16, v8
  v_lshlrev_b32 v28, 16, v28
  v_lshlrev_b32 v9, 16, v9
  v_lshlrev_b32 v29, 16, v29
  v_lshlrev_b32 v10, 16, v10
  v_lshlrev_b32 v30, 16, v30
  v_lshlrev_b32 v11, 16, v11
  v_lshlrev_b32 v31, 16, v31
  v_lshlrev_b32 v5, 16, v112
  v_and_b32 v6, 0xffff0000, v112
  v_fmac_f32 v14, v5, v8
  v_fmac_f32 v15, v6, v8
  v_fmac_f32 v20, v5, v28
  v_fmac_f32 v21, v6, v28
  v_lshlrev_b32 v5, 16, v113
  v_and_b32 v6, 0xffff0000, v113
  v_fmac_f32 v16, v5, v8
  v_fmac_f32 v17, v6, v8
  v_fmac_f32 v22, v5, v28
  v_fmac_f32 v23, v6, v28
  v_lshlrev_b32 v5, 16, v114
  v_and_b32 v6, 0xffff0000, v114
  v_fmac_f32 v18, v5, v8
  v_fmac_f32 v19, v6, v8
  v_fmac_f32 v24, v5, v28
  v_fmac_f32 v25, v6, v28
  s_waitcnt vmcnt(34)
  v_lshlrev_b32 v5, 16, v116
  v_and_b32 v6, 0xffff0000, v116
  v_fmac_f32 v14, v5, v9
  v_fmac_f32 v15, v6, v9
  v_fmac_f32 v20, v5, v29
  v_fmac_f32 v21, v6, v29
  v_lshlrev_b32 v5, 16, v117
  v_and_b32 v6, 0xffff0000, v117
  v_fmac_f32 v16, v5, v9
  v_fmac_f32 v17, v6, v9
  v_fmac_f32 v22, v5, v29
  v_fmac_f32 v23, v6, v29
  v_lshlrev_b32 v5, 16, v118
  v_and_b32 v6, 0xffff0000, v118
  v_fmac_f32 v18, v5, v9
  v_fmac_f32 v19, v6, v9
  v_fmac_f32 v24, v5, v29
  v_fmac_f32 v25, v6, v29
  s_waitcnt vmcnt(33)
  v_lshlrev_b32 v5, 16, v120
  v_and_b32 v6, 0xffff0000, v120
  v_fmac_f32 v14, v5, v10
  v_fmac_f32 v15, v6, v10
  v_fmac_f32 v20, v5, v30
  v_fmac_f32 v21, v6, v30
  v_lshlrev_b32 v5, 16, v121
  v_and_b32 v6, 0xffff0000, v121
  v_fmac_f32 v16, v5, v10
  v_fmac_f32 v17, v6, v10
  v_fmac_f32 v22, v5, v30
  v_fmac_f32 v23, v6, v30
  v_lshlrev_b32 v5, 16, v122
  v_and_b32 v6, 0xffff0000, v122
  v_fmac_f32 v18, v5, v10
  v_fmac_f32 v19, v6, v10
  v_fmac_f32 v24, v5, v30
  v_fmac_f32 v25, v6, v30
  s_waitcnt vmcnt(32)
  v_lshlrev_b32 v5, 16, v124
  v_and_b32 v6, 0xffff0000, v124
  v_fmac_f32 v14, v5, v11
  v_fmac_f32 v15, v6, v11
  v_fmac_f32 v20, v5, v31
  v_fmac_f32 v21, v6, v31
  v_lshlrev_b32 v5, 16, v125
  v_and_b32 v6, 0xffff0000, v125
  v_fmac_f32 v16, v5, v11
  v_fmac_f32 v17, v6, v11
  v_fmac_f32 v22, v5, v31
  v_fmac_f32 v23, v6, v31
  v_lshlrev_b32 v5, 16, v126
  v_and_b32 v6, 0xffff0000, v126
  v_fmac_f32 v18, v5, v11
  v_fmac_f32 v19, v6, v11
  v_fmac_f32 v24, v5, v31
  v_fmac_f32 v25, v6, v31
  ds_read_b128 v[8:11], v27 offset:16480
  ds_read_b128 v[28:31], v27 offset:19040
  s_waitcnt vmcnt(31) lgkmcnt(0)
  v_lshlrev_b32 v8, 16, v8
  v_lshlrev_b32 v28, 16, v28
  v_lshlrev_b32 v9, 16, v9
  v_lshlrev_b32 v29, 16, v29
  v_lshlrev_b32 v10, 16, v10
  v_lshlrev_b32 v30, 16, v30
  v_lshlrev_b32 v11, 16, v11
  v_lshlrev_b32 v31, 16, v31
  v_lshlrev_b32 v5, 16, v192
  v_and_b32 v6, 0xffff0000, v192
  v_fmac_f32 v14, v5, v8
  v_fmac_f32 v15, v6, v8
  v_fmac_f32 v20, v5, v28
  v_fmac_f32 v21, v6, v28
  v_lshlrev_b32 v5, 16, v193
  v_and_b32 v6, 0xffff0000, v193
  v_fmac_f32 v16, v5, v8
  v_fmac_f32 v17, v6, v8
  v_fmac_f32 v22, v5, v28
  v_fmac_f32 v23, v6, v28
  v_lshlrev_b32 v5, 16, v194
  v_and_b32 v6, 0xffff0000, v194
  v_fmac_f32 v18, v5, v8
  v_fmac_f32 v19, v6, v8
  v_fmac_f32 v24, v5, v28
  v_fmac_f32 v25, v6, v28
  buffer_load_dwordx3 v[192:194], v2, s[52:55], s62 offen nt
  s_add_u32 s62, s62, 6144
  s_waitcnt vmcnt(31)
  v_lshlrev_b32 v5, 16, v196
  v_and_b32 v6, 0xffff0000, v196
  v_fmac_f32 v14, v5, v9
  v_fmac_f32 v15, v6, v9
  v_fmac_f32 v20, v5, v29
  v_fmac_f32 v21, v6, v29
  v_lshlrev_b32 v5, 16, v197
  v_and_b32 v6, 0xffff0000, v197
  v_fmac_f32 v16, v5, v9
  v_fmac_f32 v17, v6, v9
  v_fmac_f32 v22, v5, v29
  v_fmac_f32 v23, v6, v29
  v_lshlrev_b32 v5, 16, v198
  v_and_b32 v6, 0xffff0000, v198
  v_fmac_f32 v18, v5, v9
  v_fmac_f32 v19, v6, v9
  v_fmac_f32 v24, v5, v29
  v_fmac_f32 v25, v6, v29
  buffer_load_dwordx3 v[196:198], v2, s[52:55], s62 offen nt
  s_add_u32 s62, s62, 6144
  s_waitcnt vmcnt(31)
  v_lshlrev_b32 v5, 16, v200
  v_and_b32 v6, 0xffff0000, v200
  v_fmac_f32 v14, v5, v10
  v_fmac_f32 v15, v6, v10
  v_fmac_f32 v20, v5, v30
  v_fmac_f32 v21, v6, v30
  v_lshlrev_b32 v5, 16, v201
  v_and_b32 v6, 0xffff0000, v201
  v_fmac_f32 v16, v5, v10
  v_fmac_f32 v17, v6, v10
  v_fmac_f32 v22, v5, v30
  v_fmac_f32 v23, v6, v30
  v_lshlrev_b32 v5, 16, v202
  v_and_b32 v6, 0xffff0000, v202
  v_fmac_f32 v18, v5, v10
  v_fmac_f32 v19, v6, v10
  v_fmac_f32 v24, v5, v30
  v_fmac_f32 v25, v6, v30
  buffer_load_dwordx3 v[200:202], v2, s[52:55], s62 offen nt
  s_add_u32 s62, s62, 6144
  s_waitcnt vmcnt(31)
  v_lshlrev_b32 v5, 16, v204
  v_and_b32 v6, 0xffff0000, v204
  v_fmac_f32 v14, v5, v11
  v_fmac_f32 v15, v6, v11
  v_fmac_f32 v20, v5, v31
  v_fmac_f32 v21, v6, v31
  v_lshlrev_b32 v5, 16, v205
  v_and_b32 v6, 0xffff0000, v205
  v_fmac_f32 v16, v5, v11
  v_fmac_f32 v17, v6, v11
  v_fmac_f32 v22, v5, v31
  v_fmac_f32 v23, v6, v31
  v_lshlrev_b32 v5, 16, v206
  v_and_b32 v6, 0xffff0000, v206
  v_fmac_f32 v18, v5, v11
  v_fmac_f32 v19, v6, v11
  v_fmac_f32 v24, v5, v31
  v_fmac_f32 v25, v6, v31
  buffer_load_dwordx3 v[204:206], v2, s[52:55], s62 offen nt
  s_add_u32 s62, s62, 6144
  ds_read_b128 v[8:11], v27 offset:16496
  ds_read_b128 v[28:31], v27 offset:19056
  s_waitcnt vmcnt(31) lgkmcnt(0)
  v_lshlrev_b32 v8, 16, v8
  v_lshlrev_b32 v28, 16, v28
  v_lshlrev_b32 v9, 16, v9
  v_lshlrev_b32 v29, 16, v29
  v_lshlrev_b32 v10, 16, v10
  v_lshlrev_b32 v30, 16, v30
  v_lshlrev_b32 v11, 16, v11
  v_lshlrev_b32 v31, 16, v31
  v_lshlrev_b32 v5, 16, v208
  v_and_b32 v6, 0xffff0000, v208
  v_fmac_f32 v14, v5, v8
  v_fmac_f32 v15, v6, v8
  v_fmac_f32 v20, v5, v28
  v_fmac_f32 v21, v6, v28
  v_lshlrev_b32 v5, 16, v209
  v_and_b32 v6, 0xffff0000, v209
  v_fmac_f32 v16, v5, v8
  v_fmac_f32 v17, v6, v8
  v_fmac_f32 v22, v5, v28
  v_fmac_f32 v23, v6, v28
  v_lshlrev_b32 v5, 16, v210
  v_and_b32 v6, 0xffff0000, v210
  v_fmac_f32 v18, v5, v8
  v_fmac_f32 v19, v6, v8
  v_fmac_f32 v24, v5, v28
  v_fmac_f32 v25, v6, v28
  buffer_load_dwordx3 v[208:210], v2, s[52:55], s62 offen nt
  s_add_u32 s62, s62, 6144
  s_waitcnt vmcnt(31)
  v_lshlrev_b32 v5, 16, v212
  v_and_b32 v6, 0xffff0000, v212
  v_fmac_f32 v14, v5, v9
  v_fmac_f32 v15, v6, v9
  v_fmac_f32 v20, v5, v29
  v_fmac_f32 v21, v6, v29
  v_lshlrev_b32 v5, 16, v213
  v_and_b32 v6, 0xffff0000, v213
  v_fmac_f32 v16, v5, v9
  v_fmac_f32 v17, v6, v9
  v_fmac_f32 v22, v5, v29
  v_fmac_f32 v23, v6, v29
  v_lshlrev_b32 v5, 16, v214
  v_and_b32 v6, 0xffff0000, v214
  v_fmac_f32 v18, v5, v9
  v_fmac_f32 v19, v6, v9
  v_fmac_f32 v24, v5, v29
  v_fmac_f32 v25, v6, v29
  buffer_load_dwordx3 v[212:214], v2, s[52:55], s62 offen nt
  s_add_u32 s62, s62, 6144
  s_waitcnt vmcnt(31)
  v_lshlrev_b32 v5, 16, v216
  v_and_b32 v6, 0xffff0000, v216
  v_fmac_f32 v14, v5, v10
  v_fmac_f32 v15, v6, v10
  v_fmac_f32 v20, v5, v30
  v_fmac_f32 v21, v6, v30
  v_lshlrev_b32 v5, 16, v217
  v_and_b32 v6, 0xffff0000, v217
  v_fmac_f32 v16, v5, v10
  v_fmac_f32 v17, v6, v10
  v_fmac_f32 v22, v5, v30
  v_fmac_f32 v23, v6, v30
  v_lshlrev_b32 v5, 16, v218
  v_and_b32 v6, 0xffff0000, v218
  v_fmac_f32 v18, v5, v10
  v_fmac_f32 v19, v6, v10
  v_fmac_f32 v24, v5, v30
  v_fmac_f32 v25, v6, v30
  buffer_load_dwordx3 v[216:218], v2, s[52:55], s62 offen nt
  s_add_u32 s62, s62, 6144
  s_waitcnt vmcnt(31)
  v_lshlrev_b32 v5, 16, v220
  v_and_b32 v6, 0xffff0000, v220
  v_fmac_f32 v14, v5, v11
  v_fmac_f32 v15, v6, v11
  v_fmac_f32 v20, v5, v31
  v_fmac_f32 v21, v6, v31
  v_lshlrev_b32 v5, 16, v221
  v_and_b32 v6, 0xffff0000, v221
  v_fmac_f32 v16, v5, v11
  v_fmac_f32 v17, v6, v11
  v_fmac_f32 v22, v5, v31
  v_fmac_f32 v23, v6, v31
  v_lshlrev_b32 v5, 16, v222
  v_and_b32 v6, 0xffff0000, v222
  v_fmac_f32 v18, v5, v11
  v_fmac_f32 v19, v6, v11
  v_fmac_f32 v24, v5, v31
  v_fmac_f32 v25, v6, v31
  buffer_load_dwordx3 v[220:222], v2, s[52:55], s62 offen nt
  s_add_u32 s62, s62, 6144
  ds_read_b128 v[8:11], v27 offset:16512
  ds_read_b128 v[28:31], v27 offset:19072
  s_waitcnt vmcnt(31) lgkmcnt(0)
  v_lshlrev_b32 v8, 16, v8
  v_lshlrev_b32 v28, 16, v28
  v_lshlrev_b32 v9, 16, v9
  v_lshlrev_b32 v29, 16, v29
  v_lshlrev_b32 v10, 16, v10
  v_lshlrev_b32 v30, 16, v30
  v_lshlrev_b32 v11, 16, v11
  v_lshlrev_b32 v31, 16, v31
  v_lshlrev_b32 v5, 16, v224
  v_and_b32 v6, 0xffff0000, v224
  v_fmac_f32 v14, v5, v8
  v_fmac_f32 v15, v6, v8
  v_fmac_f32 v20, v5, v28
  v_fmac_f32 v21, v6, v28
  v_lshlrev_b32 v5, 16, v225
  v_and_b32 v6, 0xffff0000, v225
  v_fmac_f32 v16, v5, v8
  v_fmac_f32 v17, v6, v8
  v_fmac_f32 v22, v5, v28
  v_fmac_f32 v23, v6, v28
  v_lshlrev_b32 v5, 16, v226
  v_and_b32 v6, 0xffff0000, v226
  v_fmac_f32 v18, v5, v8
  v_fmac_f32 v19, v6, v8
  v_fmac_f32 v24, v5, v28
  v_fmac_f32 v25, v6, v28
  buffer_load_dwordx3 v[224:226], v2, s[52:55], s62 offen nt
  s_add_u32 s62, s62, 6144
  s_waitcnt vmcnt(31)
  v_lshlrev_b32 v5, 16, v228
  v_and_b32 v6, 0xffff0000, v228
  v_fmac_f32 v14, v5, v9
  v_fmac_f32 v15, v6, v9
  v_fmac_f32 v20, v5, v29
  v_fmac_f32 v21, v6, v29
  v_lshlrev_b32 v5, 16, v229
  v_and_b32 v6, 0xffff0000, v229
  v_fmac_f32 v16, v5, v9
  v_fmac_f32 v17, v6, v9
  v_fmac_f32 v22, v5, v29
  v_fmac_f32 v23, v6, v29
  v_lshlrev_b32 v5, 16, v230
  v_and_b32 v6, 0xffff0000, v230
  v_fmac_f32 v18, v5, v9
  v_fmac_f32 v19, v6, v9
  v_fmac_f32 v24, v5, v29
  v_fmac_f32 v25, v6, v29
  buffer_load_dwordx3 v[228:230], v2, s[52:55], s62 offen nt
  s_add_u32 s62, s62, 6144
  s_waitcnt vmcnt(31)
  v_lshlrev_b32 v5, 16, v232
  v_and_b32 v6, 0xffff0000, v232
  v_fmac_f32 v14, v5, v10
  v_fmac_f32 v15, v6, v10
  v_fmac_f32 v20, v5, v30
  v_fmac_f32 v21, v6, v30
  v_lshlrev_b32 v5, 16, v233
  v_and_b32 v6, 0xffff0000, v233
  v_fmac_f32 v16, v5, v10
  v_fmac_f32 v17, v6, v10
  v_fmac_f32 v22, v5, v30
  v_fmac_f32 v23, v6, v30
  v_lshlrev_b32 v5, 16, v234
  v_and_b32 v6, 0xffff0000, v234
  v_fmac_f32 v18, v5, v10
  v_fmac_f32 v19, v6, v10
  v_fmac_f32 v24, v5, v30
  v_fmac_f32 v25, v6, v30
  buffer_load_dwordx3 v[232:234], v2, s[52:55], s62 offen nt
  s_add_u32 s62, s62, 6144
  s_waitcnt vmcnt(31)
  v_lshlrev_b32 v5, 16, v236
  v_and_b32 v6, 0xffff0000, v236
  v_fmac_f32 v14, v5, v11
  v_fmac_f32 v15, v6, v11
  v_fmac_f32 v20, v5, v31
  v_fmac_f32 v21, v6, v31
  v_lshlrev_b32 v5, 16, v237
  v_and_b32 v6, 0xffff0000, v237
  v_fmac_f32 v16, v5, v11
  v_fmac_f32 v17, v6, v11
  v_fmac_f32 v22, v5, v31
  v_fmac_f32 v23, v6, v31
  v_lshlrev_b32 v5, 16, v238
  v_and_b32 v6, 0xffff0000, v238
  v_fmac_f32 v18, v5, v11
  v_fmac_f32 v19, v6, v11
  v_fmac_f32 v24, v5, v31
  v_fmac_f32 v25, v6, v31
  buffer_load_dwordx3 v[236:238], v2, s[52:55], s62 offen nt
  s_add_u32 s62, s62, 6144
  ds_read_b128 v[8:11], v27 offset:16528
  ds_read_b128 v[28:31], v27 offset:19088
  s_waitcnt vmcnt(31) lgkmcnt(0)
  v_lshlrev_b32 v8, 16, v8
  v_lshlrev_b32 v28, 16, v28
  v_lshlrev_b32 v9, 16, v9
  v_lshlrev_b32 v29, 16, v29
  v_lshlrev_b32 v10, 16, v10
  v_lshlrev_b32 v30, 16, v30
  v_lshlrev_b32 v11, 16, v11
  v_lshlrev_b32 v31, 16, v31
  v_lshlrev_b32 v5, 16, v240
  v_and_b32 v6, 0xffff0000, v240
  v_fmac_f32 v14, v5, v8
  v_fmac_f32 v15, v6, v8
  v_fmac_f32 v20, v5, v28
  v_fmac_f32 v21, v6, v28
  v_lshlrev_b32 v5, 16, v241
  v_and_b32 v6, 0xffff0000, v241
  v_fmac_f32 v16, v5, v8
  v_fmac_f32 v17, v6, v8
  v_fmac_f32 v22, v5, v28
  v_fmac_f32 v23, v6, v28
  v_lshlrev_b32 v5, 16, v242
  v_and_b32 v6, 0xffff0000, v242
  v_fmac_f32 v18, v5, v8
  v_fmac_f32 v19, v6, v8
  v_fmac_f32 v24, v5, v28
  v_fmac_f32 v25, v6, v28
  buffer_load_dwordx3 v[240:242], v2, s[52:55], s62 offen nt
  s_add_u32 s62, s62, 6144
  s_waitcnt vmcnt(31)
  v_lshlrev_b32 v5, 16, v244
  v_and_b32 v6, 0xffff0000, v244
  v_fmac_f32 v14, v5, v9
  v_fmac_f32 v15, v6, v9
  v_fmac_f32 v20, v5, v29
  v_fmac_f32 v21, v6, v29
  v_lshlrev_b32 v5, 16, v245
  v_and_b32 v6, 0xffff0000, v245
  v_fmac_f32 v16, v5, v9
  v_fmac_f32 v17, v6, v9
  v_fmac_f32 v22, v5, v29
  v_fmac_f32 v23, v6, v29
  v_lshlrev_b32 v5, 16, v246
  v_and_b32 v6, 0xffff0000, v246
  v_fmac_f32 v18, v5, v9
  v_fmac_f32 v19, v6, v9
  v_fmac_f32 v24, v5, v29
  v_fmac_f32 v25, v6, v29
  buffer_load_dwordx3 v[244:246], v2, s[52:55], s62 offen nt
  s_add_u32 s62, s62, 6144
  s_waitcnt vmcnt(31)
  v_lshlrev_b32 v5, 16, v248
  v_and_b32 v6, 0xffff0000, v248
  v_fmac_f32 v14, v5, v10
  v_fmac_f32 v15, v6, v10
  v_fmac_f32 v20, v5, v30
  v_fmac_f32 v21, v6, v30
  v_lshlrev_b32 v5, 16, v249
  v_and_b32 v6, 0xffff0000, v249
  v_fmac_f32 v16, v5, v10
  v_fmac_f32 v17, v6, v10
  v_fmac_f32 v22, v5, v30
  v_fmac_f32 v23, v6, v30
  v_lshlrev_b32 v5, 16, v250
  v_and_b32 v6, 0xffff0000, v250
  v_fmac_f32 v18, v5, v10
  v_fmac_f32 v19, v6, v10
  v_fmac_f32 v24, v5, v30
  v_fmac_f32 v25, v6, v30
  buffer_load_dwordx3 v[248:250], v2, s[52:55], s62 offen nt
  s_add_u32 s62, s62, 6144
  s_waitcnt vmcnt(31)
  v_lshlrev_b32 v5, 16, v252
  v_and_b32 v6, 0xffff0000, v252
  v_fmac_f32 v14, v5, v11
  v_fmac_f32 v15, v6, v11
  v_fmac_f32 v20, v5, v31
  v_fmac_f32 v21, v6, v31
  v_lshlrev_b32 v5, 16, v253
  v_and_b32 v6, 0xffff0000, v253
  v_fmac_f32 v16, v5, v11
  v_fmac_f32 v17, v6, v11
  v_fmac_f32 v22, v5, v31
  v_fmac_f32 v23, v6, v31
  v_lshlrev_b32 v5, 16, v254
  v_and_b32 v6, 0xffff0000, v254
  v_fmac_f32 v18, v5, v11
  v_fmac_f32 v19, v6, v11
  v_fmac_f32 v24, v5, v31
  v_fmac_f32 v25, v6, v31
  buffer_load_dwordx3 v[252:254], v2, s[52:55], s62 offen nt
  s_add_u32 s62, s62, 6144
  v_lshrrev_b32 v5, 5, v1
  s_lshl_b32 s64, s59, 1
  v_add_u32 v5, s64, v5
  v_mul_u32_u24 v5, 768, v5
  v_and_b32 v6, 31, v1
  v_mul_u32_u24 v6, 24, v6
  v_add_u32 v5, v5, v6
  ds_write_b64 v5, v[14:15] offset:21504
  ds_write_b64 v5, v[16:17] offset:21512
  ds_write_b64 v5, v[18:19] offset:21520
  ds_write_b64 v5, v[20:21] offset:33792
  ds_write_b64 v5, v[22:23] offset:33800
  ds_write_b64 v5, v[24:25] offset:33808
  s_waitcnt lgkmcnt(0)
  s_barrier
  v_cmp_gt_u32 vcc, 384, v0
  s_and_saveexec_b64 s[64:65], vcc
  s_cbranch_execz L_cw_q
  v_cmp_le_u32 vcc, 192, v0
  v_mov_b32 v6, 0
  v_mov_b32 v5, 11520
  s_nop 0
  v_cndmask_b32 v6, v6, v5, vcc
  v_lshlrev_b32 v5, 2, v0
  v_add_u32 v5, v5, v6
  ds_read_b32 v112, v5 offset:21504
  ds_read_b32 v113, v5 offset:22272
  ds_read_b32 v114, v5 offset:23040
  ds_read_b32 v115, v5 offset:23808
  ds_read_b32 v116, v5 offset:24576
  ds_read_b32 v117, v5 offset:25344
  ds_read_b32 v118, v5 offset:26112
  ds_read_b32 v119, v5 offset:26880
  ds_read_b32 v120, v5 offset:27648
  ds_read_b32 v121, v5 offset:28416
  ds_read_b32 v122, v5 offset:29184
  ds_read_b32 v123, v5 offset:29952
  ds_read_b32 v124, v5 offset:30720
  ds_read_b32 v125, v5 offset:31488
  ds_read_b32 v126, v5 offset:32256
  ds_read_b32 v127, v5 offset:33024
  s_waitcnt lgkmcnt(0)
  v_add_f32 v112, v112, v120
  v_add_f32 v113, v113, v121
  v_add_f32 v114, v114, v122
  v_add_f32 v115, v115, v123
  v_add_f32 v116, v116, v124
  v_add_f32 v117, v117, v125
  v_add_f32 v118, v118, v126
  v_add_f32 v119, v119, v127
  v_add_f32 v112, v112, v116
  v_add_f32 v113, v113, v117
  v_add_f32 v114, v114, v118
  v_add_f32 v115, v115, v119
  v_add_f32 v112, v112, v114
  v_add_f32 v113, v113, v115
  v_add_f32 v112, v112, v113
  v_cvt_pk_bf16_f32 v112, v112, v112
  v_lshlrev_b32 v5, 1, v0
  ds_write_b16 v5, v112 offset:46080
L_cw_q:
  s_mov_b64 exec, -1
  s_waitcnt lgkmcnt(0)
  s_barrier
  v_and_b32 v5, 31, v1
  v_mul_u32_u24 v5, 12, v5
  ds_read_b32 v8, v5 offset:46080
  ds_read_b32 v9, v5 offset:46084
  ds_read_b32 v10, v5 offset:46088
  ds_read_b32 v11, v5 offset:46464
  ds_read_b32 v12, v5 offset:46468
  ds_read_b32 v13, v5 offset:46472
  s_waitcnt lgkmcnt(0)
  s_mov_b32 s63, 0
L_K0:
  s_waitcnt lgkmcnt(0)
  s_barrier
  s_cmp_eq_u32 s63, 3
  s_cbranch_scc0 L_K0_h3
  s_mov_b32 s52, s28
  s_mov_b32 s53, s29
  s_mov_b32 s54, s30
  s_mov_b32 s55, s31
  s_mov_b32 s62, s61
L_K0_h3:
  s_waitcnt vmcnt(31)
  v_dot2_f32_bf16 v131, v128, v8, 0
  v_dot2_f32_bf16 v131, v129, v9, v131
  v_dot2_f32_bf16 v131, v130, v10, v131
  buffer_load_dwordx3 v[128:130], v2, s[52:55], s62 offen nt
  s_add_u32 s62, s62, 6144
  s_waitcnt vmcnt(31)
  v_dot2_f32_bf16 v135, v132, v8, 0
  v_dot2_f32_bf16 v135, v133, v9, v135
  v_dot2_f32_bf16 v135, v134, v10, v135
  buffer_load_dwordx3 v[132:134], v2, s[52:55], s62 offen nt
  s_add_u32 s62, s62, 6144
  s_waitcnt vmcnt(31)
  v_dot2_f32_bf16 v139, v136, v8, 0
  v_dot2_f32_bf16 v139, v137, v9, v139
  v_dot2_f32_bf16 v139, v138, v10, v139
  buffer_load_dwordx3 v[136:138], v2, s[52:55], s62 offen nt
  s_add_u32 s62, s62, 6144
  s_waitcnt vmcnt(31)
  v_dot2_f32_bf16 v143, v140, v8, 0
  v_dot2_f32_bf16 v143, v141, v9, v143
  v_dot2_f32_bf16 v143, v142, v10, v143
  buffer_load_dwordx3 v[140:142], v2, s[52:55], s62 offen nt
  s_add_u32 s62, s62, 6144
  s_waitcnt vmcnt(31)
  v_dot2_f32_bf16 v147, v144, v8, 0
  v_dot2_f32_bf16 v147, v145, v9, v147
  v_dot2_f32_bf16 v147, v146, v10, v147
  buffer_load_dwordx3 v[144:146], v2, s[52:55], s62 offen nt
  s_add_u32 s62, s62, 6144
  s_waitcnt vmcnt(31)
  v_dot2_f32_bf16 v151, v148, v8, 0
  v_dot2_f32_bf16 v151, v149, v9, v151
  v_dot2_f32_bf16 v151, v150, v10, v151
  buffer_load_dwordx3 v[148:150], v2, s[52:55], s62 offen nt
  s_add_u32 s62, s62, 6144
  s_waitcnt vmcnt(31)
  v_dot2_f32_bf16 v155, v152, v8, 0
  v_dot2_f32_bf16 v155, v153, v9, v155
  v_dot2_f32_bf16 v155, v154, v10, v155
  buffer_load_dwordx3 v[152:154], v2, s[52:55], s62 offen nt
  s_add_u32 s62, s62, 6144
  s_waitcnt vmcnt(31)
  v_dot2_f32_bf16 v159, v156, v8, 0
  v_dot2_f32_bf16 v159, v157, v9, v159
  v_dot2_f32_bf16 v159, v158, v10, v159
  buffer_load_dwordx3 v[156:158], v2, s[52:55], s62 offen nt
  s_add_u32 s62, s62, 6144
  s_nop 1
  v_permlane16_swap_b32 v131, v135
  v_permlane16_swap_b32 v139, v143
  v_permlane16_swap_b32 v147, v151
  v_permlane16_swap_b32 v155, v159
  s_nop 0
  v_add_f32 v131, v131, v135
  v_add_f32 v139, v139, v143
  v_add_f32 v147, v147, v151
  v_add_f32 v155, v155, v159
  s_nop 0
  v_add_f32_dpp v131, v131, v131 row_ror:8 row_mask:0xf bank_mask:0x3
  v_add_f32_dpp v147, v147, v147 row_ror:8 row_mask:0xf bank_mask:0x3
  v_add_f32_dpp v131, v139, v139 row_ror:8 row_mask:0xf bank_mask:0xc
  v_add_f32_dpp v147, v155, v155 row_ror:8 row_mask:0xf bank_mask:0xc
  s_nop 1
  v_add_f32_dpp v131, v131, v131 row_half_mirror row_mask:0xf bank_mask:0x5
  v_add_f32_dpp v131, v147, v147 row_half_mirror row_mask:0xf bank_mask:0xa
  s_nop 1
  v_add_f32_dpp v131, v131, v131 quad_perm:[1,0,3,2] row_mask:0xf bank_mask:0xf
  s_nop 1
  v_add_f32_dpp v131, v131, v131 quad_perm:[2,3,0,1] row_mask:0xf bank_mask:0xf
  v_cvt_pk_bf16_f32 v131, v131, v131
  v_lshlrev_b32 v131, 16, v131
  v_mul_f32 v131, s82, v131
  v_cvt_pk_bf16_f32 v131, v131, v131
  v_lshlrev_b32 v131, 16, v131
  v_max_f32 v4, v4, v131
  s_mov_b64 exec, s[80:81]
  ds_write_b32 v3, v131 offset:0
  s_mov_b64 exec, -1
  s_waitcnt vmcnt(31)
  v_dot2_f32_bf16 v163, v160, v8, 0
  v_dot2_f32_bf16 v163, v161, v9, v163
  v_dot2_f32_bf16 v163, v162, v10, v163
  buffer_load_dwordx3 v[160:162], v2, s[52:55], s62 offen nt
  s_add_u32 s62, s62, 6144
  s_waitcnt vmcnt(31)
  v_dot2_f32_bf16 v167, v164, v8, 0
  v_dot2_f32_bf16 v167, v165, v9, v167
  v_dot2_f32_bf16 v167, v166, v10, v167
  buffer_load_dwordx3 v[164:166], v2, s[52:55], s62 offen nt
  s_add_u32 s62, s62, 6144
  s_waitcnt vmcnt(31)
  v_dot2_f32_bf16 v171, v168, v8, 0
  v_dot2_f32_bf16 v171, v169, v9, v171
  v_dot2_f32_bf16 v171, v170, v10, v171
  buffer_load_dwordx3 v[168:170], v2, s[52:55], s62 offen nt
  s_add_u32 s62, s62, 6144
  s_waitcnt vmcnt(31)
  v_dot2_f32_bf16 v175, v172, v8, 0
  v_dot2_f32_bf16 v175, v173, v9, v175
  v_dot2_f32_bf16 v175, v174, v10, v175
  buffer_load_dwordx3 v[172:174], v2, s[52:55], s62 offen nt
  s_add_u32 s62, s62, 6144
  s_waitcnt vmcnt(31)
  v_dot2_f32_bf16 v179, v176, v8, 0
  v_dot2_f32_bf16 v179, v177, v9, v179
  v_dot2_f32_bf16 v179, v178, v10, v179
  buffer_load_dwordx3 v[176:178], v2, s[52:55], s62 offen nt
  s_add_u32 s62, s62, 6144
  s_waitcnt vmcnt(31)
  v_dot2_f32_bf16 v183, v180, v8, 0
  v_dot2_f32_bf16 v183, v181, v9, v183
  v_dot2_f32_bf16 v183, v182, v10, v183
  buffer_load_dwordx3 v[180:182], v2, s[52:55], s62 offen nt
  s_add_u32 s62, s62, 6144
  s_waitcnt vmcnt(31)
  v_dot2_f32_bf16 v187, v184, v8, 0
  v_dot2_f32_bf16 v187, v185, v9, v187
  v_dot2_f32_bf16 v187, v186, v10, v187
  buffer_load_dwordx3 v[184:186], v2, s[52:55], s62 offen nt
  s_add_u32 s62, s62, 6144
  s_waitcnt vmcnt(31)
  v_dot2_f32_bf16 v191, v188, v8, 0
  v_dot2_f32_bf16 v191, v189, v9, v191
  v_dot2_f32_bf16 v191, v190, v10, v191
  buffer_load_dwordx3 v[188:190], v2, s[52:55], s62 offen nt
  s_add_u32 s62, s62, 6144
  s_nop 1
  v_permlane16_swap_b32 v163, v167
  v_permlane16_swap_b32 v171, v175
  v_permlane16_swap_b32 v179, v183
  v_permlane16_swap_b32 v187, v191
  s_nop 0
  v_add_f32 v163, v163, v167
  v_add_f32 v171, v171, v175
  v_add_f32 v179, v179, v183
  v_add_f32 v187, v187, v191
  s_nop 0
  v_add_f32_dpp v163, v163, v163 row_ror:8 row_mask:0xf bank_mask:0x3
  v_add_f32_dpp v179, v179, v179 row_ror:8 row_mask:0xf bank_mask:0x3
  v_add_f32_dpp v163, v171, v171 row_ror:8 row_mask:0xf bank_mask:0xc
  v_add_f32_dpp v179, v187, v187 row_ror:8 row_mask:0xf bank_mask:0xc
  s_nop 1
  v_add_f32_dpp v163, v163, v163 row_half_mirror row_mask:0xf bank_mask:0x5
  v_add_f32_dpp v163, v179, v179 row_half_mirror row_mask:0xf bank_mask:0xa
  s_nop 1
  v_add_f32_dpp v163, v163, v163 quad_perm:[1,0,3,2] row_mask:0xf bank_mask:0xf
  s_nop 1
  v_add_f32_dpp v163, v163, v163 quad_perm:[2,3,0,1] row_mask:0xf bank_mask:0xf
  v_cvt_pk_bf16_f32 v163, v163, v163
  v_lshlrev_b32 v163, 16, v163
  v_mul_f32 v163, s82, v163
  v_cvt_pk_bf16_f32 v163, v163, v163
  v_lshlrev_b32 v163, 16, v163
  v_max_f32 v4, v4, v163
  s_mov_b64 exec, s[80:81]
  ds_write_b32 v3, v163 offset:32
  s_mov_b64 exec, -1
  s_waitcnt vmcnt(31)
  v_dot2_f32_bf16 v195, v192, v8, 0
  v_dot2_f32_bf16 v195, v193, v9, v195
  v_dot2_f32_bf16 v195, v194, v10, v195
  buffer_load_dwordx3 v[192:194], v2, s[52:55], s62 offen nt
  s_add_u32 s62, s62, 6144
  s_waitcnt vmcnt(31)
  v_dot2_f32_bf16 v199, v196, v8, 0
  v_dot2_f32_bf16 v199, v197, v9, v199
  v_dot2_f32_bf16 v199, v198, v10, v199
  buffer_load_dwordx3 v[196:198], v2, s[52:55], s62 offen nt
  s_add_u32 s62, s62, 6144
  s_waitcnt vmcnt(31)
  v_dot2_f32_bf16 v203, v200, v8, 0
  v_dot2_f32_bf16 v203, v201, v9, v203
  v_dot2_f32_bf16 v203, v202, v10, v203
  buffer_load_dwordx3 v[200:202], v2, s[52:55], s62 offen nt
  s_add_u32 s62, s62, 6144
  s_waitcnt vmcnt(31)
  v_dot2_f32_bf16 v207, v204, v8, 0
  v_dot2_f32_bf16 v207, v205, v9, v207
  v_dot2_f32_bf16 v207, v206, v10, v207
  buffer_load_dwordx3 v[204:206], v2, s[52:55], s62 offen nt
  s_add_u32 s62, s62, 6144
  s_waitcnt vmcnt(31)
  v_dot2_f32_bf16 v211, v208, v8, 0
  v_dot2_f32_bf16 v211, v209, v9, v211
  v_dot2_f32_bf16 v211, v210, v10, v211
  buffer_load_dwordx3 v[208:210], v2, s[52:55], s62 offen nt
  s_add_u32 s62, s62, 6144
  s_waitcnt vmcnt(31)
  v_dot2_f32_bf16 v215, v212, v8, 0
  v_dot2_f32_bf16 v215, v213, v9, v215
  v_dot2_f32_bf16 v215, v214, v10, v215
  buffer_load_dwordx3 v[212:214], v2, s[52:55], s62 offen nt
  s_add_u32 s62, s62, 6144
  s_waitcnt vmcnt(31)
  v_dot2_f32_bf16 v219, v216, v8, 0
  v_dot2_f32_bf16 v219, v217, v9, v219
  v_dot2_f32_bf16 v219, v218, v10, v219
  buffer_load_dwordx3 v[216:218], v2, s[52:55], s62 offen nt
  s_add_u32 s62, s62, 6144
  s_waitcnt vmcnt(31)
  v_dot2_f32_bf16 v223, v220, v8, 0
  v_dot2_f32_bf16 v223, v221, v9, v223
  v_dot2_f32_bf16 v223, v222, v10, v223
  buffer_load_dwordx3 v[220:222], v2, s[52:55], s62 offen nt
  s_add_u32 s62, s62, 6144
  s_nop 1
  v_permlane16_swap_b32 v195, v199
  v_permlane16_swap_b32 v203, v207
  v_permlane16_swap_b32 v211, v215
  v_permlane16_swap_b32 v219, v223
  s_nop 0
  v_add_f32 v195, v195, v199
  v_add_f32 v203, v203, v207
  v_add_f32 v211, v211, v215
  v_add_f32 v219, v219, v223
  s_nop 0
  v_add_f32_dpp v195, v195, v195 row_ror:8 row_mask:0xf bank_mask:0x3
  v_add_f32_dpp v211, v211, v211 row_ror:8 row_mask:0xf bank_mask:0x3
  v_add_f32_dpp v195, v203, v203 row_ror:8 row_mask:0xf bank_mask:0xc
  v_add_f32_dpp v211, v219, v219 row_ror:8 row_mask:0xf bank_mask:0xc
  s_nop 1
  v_add_f32_dpp v195, v195, v195 row_half_mirror row_mask:0xf bank_mask:0x5
  v_add_f32_dpp v195, v211, v211 row_half_mirror row_mask:0xf bank_mask:0xa
  s_nop 1
  v_add_f32_dpp v195, v195, v195 quad_perm:[1,0,3,2] row_mask:0xf bank_mask:0xf
  s_nop 1
  v_add_f32_dpp v195, v195, v195 quad_perm:[2,3,0,1] row_mask:0xf bank_mask:0xf
  v_cvt_pk_bf16_f32 v195, v195, v195
  v_lshlrev_b32 v195, 16, v195
  v_mul_f32 v195, s82, v195
  v_cvt_pk_bf16_f32 v195, v195, v195
  v_lshlrev_b32 v195, 16, v195
  v_max_f32 v4, v4, v195
  s_mov_b64 exec, s[80:81]
  ds_write_b32 v3, v195 offset:64
  s_mov_b64 exec, -1
  s_waitcnt vmcnt(31)
  v_dot2_f32_bf16 v227, v224, v8, 0
  v_dot2_f32_bf16 v227, v225, v9, v227
  v_dot2_f32_bf16 v227, v226, v10, v227
  buffer_load_dwordx3 v[224:226], v2, s[52:55], s62 offen nt
  s_add_u32 s62, s62, 6144
  s_waitcnt vmcnt(31)
  v_dot2_f32_bf16 v231, v228, v8, 0
  v_dot2_f32_bf16 v231, v229, v9, v231
  v_dot2_f32_bf16 v231, v230, v10, v231
  buffer_load_dwordx3 v[228:230], v2, s[52:55], s62 offen nt
  s_add_u32 s62, s62, 6144
  s_waitcnt vmcnt(31)
  v_dot2_f32_bf16 v235, v232, v8, 0
  v_dot2_f32_bf16 v235, v233, v9, v235
  v_dot2_f32_bf16 v235, v234, v10, v235
  buffer_load_dwordx3 v[232:234], v2, s[52:55], s62 offen nt
  s_add_u32 s62, s62, 6144
  s_waitcnt vmcnt(31)
  v_dot2_f32_bf16 v239, v236, v8, 0
  v_dot2_f32_bf16 v239, v237, v9, v239
  v_dot2_f32_bf16 v239, v238, v10, v239
  buffer_load_dwordx3 v[236:238], v2, s[52:55], s62 offen nt
  s_add_u32 s62, s62, 6144
  s_waitcnt vmcnt(31)
  v_dot2_f32_bf16 v243, v240, v8, 0
  v_dot2_f32_bf16 v243, v241, v9, v243
  v_dot2_f32_bf16 v243, v242, v10, v243
  buffer_load_dwordx3 v[240:242], v2, s[52:55], s62 offen nt
  s_add_u32 s62, s62, 6144
  s_waitcnt vmcnt(31)
  v_dot2_f32_bf16 v247, v244, v8, 0
  v_dot2_f32_bf16 v247, v245, v9, v247
  v_dot2_f32_bf16 v247, v246, v10, v247
  buffer_load_dwordx3 v[244:246], v2, s[52:55], s62 offen nt
  s_add_u32 s62, s62, 6144
  s_waitcnt vmcnt(31)
  v_dot2_f32_bf16 v251, v248, v8, 0
  v_dot2_f32_bf16 v251, v249, v9, v251
  v_dot2_f32_bf16 v251, v250, v10, v251
  buffer_load_dwordx3 v[248:250], v2, s[52:55], s62 offen nt
  s_add_u32 s62, s62, 6144
  s_waitcnt vmcnt(31)
  v_dot2_f32_bf16 v255, v252, v8, 0
  v_dot2_f32_bf16 v255, v253, v9, v255
  v_dot2_f32_bf16 v255, v254, v10, v255
  buffer_load_dwordx3 v[252:254], v2, s[52:55], s62 offen nt
  s_add_u32 s62, s62, 6144
  s_nop 1
  v_permlane16_swap_b32 v227, v231
  v_permlane16_swap_b32 v235, v239
  v_permlane16_swap_b32 v243, v247
  v_permlane16_swap_b32 v251, v255
  s_nop 0
  v_add_f32 v227, v227, v231
  v_add_f32 v235, v235, v239
  v_add_f32 v243, v243, v247
  v_add_f32 v251, v251, v255
  s_nop 0
  v_add_f32_dpp v227, v227, v227 row_ror:8 row_mask:0xf bank_mask:0x3
  v_add_f32_dpp v243, v243, v243 row_ror:8 row_mask:0xf bank_mask:0x3
  v_add_f32_dpp v227, v235, v235 row_ror:8 row_mask:0xf bank_mask:0xc
  v_add_f32_dpp v243, v251, v251 row_ror:8 row_mask:0xf bank_mask:0xc
  s_nop 1
  v_add_f32_dpp v227, v227, v227 row_half_mirror row_mask:0xf bank_mask:0x5
  v_add_f32_dpp v227, v243, v243 row_half_mirror row_mask:0xf bank_mask:0xa
  s_nop 1
  v_add_f32_dpp v227, v227, v227 quad_perm:[1,0,3,2] row_mask:0xf bank_mask:0xf
  s_nop 1
  v_add_f32_dpp v227, v227, v227 quad_perm:[2,3,0,1] row_mask:0xf bank_mask:0xf
  v_cvt_pk_bf16_f32 v227, v227, v227
  v_lshlrev_b32 v227, 16, v227
  v_mul_f32 v227, s82, v227
  v_cvt_pk_bf16_f32 v227, v227, v227
  v_lshlrev_b32 v227, 16, v227
  v_max_f32 v4, v4, v227
  s_mov_b64 exec, s[80:81]
  ds_write_b32 v3, v227 offset:96
  s_mov_b64 exec, -1
  v_add_u32 v3, 128, v3
  s_add_u32 s63, s63, 1
  s_cmp_lt_u32 s63, 4
  s_cbranch_scc1 L_K0
  v_subrev_u32 v3, 512, v3
  s_waitcnt lgkmcnt(0)
  ds_read_b128 v[28:31], v7 offset:0
  s_nop 1
  v_max_f32_dpp v4, v4, v4 quad_perm:[1,0,3,2] row_mask:0xf bank_mask:0xf
  s_nop 1
  v_max_f32_dpp v4, v4, v4 quad_perm:[2,3,0,1] row_mask:0xf bank_mask:0xf
  s_nop 1
  v_max_f32_dpp v4, v4, v4 row_half_mirror row_mask:0xf bank_mask:0xf
  s_nop 1
  v_max_f32_dpp v4, v4, v4 row_mirror row_mask:0xf bank_mask:0xf
  v_mov_b32 v5, v4
  s_nop 1
  v_permlane16_swap_b32 v4, v5
  s_nop 1
  v_max_f32 v4, v4, v5
  v_mov_b32 v5, v4
  s_nop 1
  v_permlane32_swap_b32 v4, v5
  s_nop 1
  v_max_f32 v4, v4, v5
  s_waitcnt lgkmcnt(0)
  v_sub_f32 v28, v28, v4
  v_sub_f32 v29, v29, v4
  v_sub_f32 v30, v30, v4
  v_sub_f32 v31, v31, v4
  v_mul_f32 v28, s83, v28
  v_mul_f32 v29, s83, v29
  v_mul_f32 v30, s83, v30
  v_mul_f32 v31, s83, v31
  v_exp_f32 v28, v28
  v_exp_f32 v29, v29
  v_exp_f32 v30, v30
  v_exp_f32 v31, v31
  s_nop 0
  v_add_f32 v28, v28, v29
  v_add_f32 v30, v30, v31
  v_add_f32 v5, v28, v30
  s_nop 1
  v_add_f32_dpp v5, v5, v5 quad_perm:[1,0,3,2] row_mask:0xf bank_mask:0xf
  s_nop 1
  v_add_f32_dpp v5, v5, v5 quad_perm:[2,3,0,1] row_mask:0xf bank_mask:0xf
  s_nop 1
  v_add_f32_dpp v5, v5, v5 row_half_mirror row_mask:0xf bank_mask:0xf
  s_nop 1
  v_add_f32_dpp v5, v5, v5 row_mirror row_mask:0xf bank_mask:0xf
  v_mov_b32 v6, v5
  s_nop 1
  v_permlane16_swap_b32 v5, v6
  s_nop 1
  v_add_f32 v5, v5, v6
  v_mov_b32 v6, v5
  s_nop 1
  v_permlane32_swap_b32 v5, v6
  s_nop 1
  v_add_f32 v5, v5, v6
  s_lshl_b32 s64, s59, 3
  v_mov_b32 v6, s64
  s_mov_b64 exec, 1
  ds_write_b64 v6, v[4:5] offset:48384
  s_mov_b64 exec, -1
  v_mov_b32 v4, 0xff800000
  s_mov_b32 s63, 0
L_K1:
  s_waitcnt lgkmcnt(0)
  s_barrier
  s_cmp_eq_u32 s63, 3
  s_cbranch_scc0 L_K1_h3
  s_mov_b32 s52, s32
  s_mov_b32 s53, s33
  s_mov_b32 s54, s34
  s_mov_b32 s55, s35
  s_mov_b32 s62, s60
L_K1_h3:
  s_cmp_eq_u32 s59, 0
  s_cbranch_scc0 L_K1_hx
  s_cmp_eq_u32 s63, 0
  s_cbranch_scc0 L_K1_a
  v_and_b32 v6, 7, v1
  v_lshlrev_b32 v6, 3, v6
  ds_read_b64 v[30:31], v6 offset:48384
  s_waitcnt lgkmcnt(0)
  v_mov_b32 v5, v30
  s_nop 1
  v_max_f32_dpp v5, v5, v5 quad_perm:[1,0,3,2] row_mask:0xf bank_mask:0xf
  s_nop 1
  v_max_f32_dpp v5, v5, v5 quad_perm:[2,3,0,1] row_mask:0xf bank_mask:0xf
  s_nop 1
  v_max_f32_dpp v5, v5, v5 row_half_mirror row_mask:0xf bank_mask:0xf
  v_sub_f32 v30, v30, v5
  v_mul_f32 v30, s83, v30
  v_exp_f32 v30, v30
  s_nop 0
  v_mul_f32 v31, v31, v30
  s_nop 1
  v_add_f32_dpp v31, v31, v31 quad_perm:[1,0,3,2] row_mask:0xf bank_mask:0xf
  s_nop 1
  v_add_f32_dpp v31, v31, v31 quad_perm:[2,3,0,1] row_mask:0xf bank_mask:0xf
  s_nop 1
  v_add_f32_dpp v31, v31, v31 row_half_mirror row_mask:0xf bank_mask:0xf
  v_mov_b32 v30, v5
  v_mov_b32 v6, 0
  s_mov_b64 exec, 1
  buffer_store_dwordx2 v[30:31], v6, s[48:51], s72 offen sc0 sc1
  s_mov_b64 exec, -1
  s_branch L_K1_hx
L_K1_a:
  s_cmp_eq_u32 s63, 1
  s_cbranch_scc0 L_K1_b
  v_mov_b32 v6, 0
  v_mov_b32 v5, s79
  s_mov_b64 exec, 1
  buffer_atomic_add v5, v6, s[44:47], s76 offen sc1
  s_mov_b64 exec, -1
  s_branch L_K1_hx
L_K1_b:
  s_cmp_eq_u32 s63, 2
  s_cbranch_scc0 L_K1_c
  v_mov_b32 v6, 0
  buffer_load_dword v126, v6, s[44:47], s76 offen sc0 sc1
  s_branch L_K1_hx
L_K1_c:
  v_readfirstlane_b32 s64, v126
  s_nop 3
L_chk_K1:
  s_lshr_b32 s64, s64, s78
  s_and_b32 s64, s64, 0xff
  s_cmp_eq_u32 s64, 4
  s_cbranch_scc1 L_ok_K1
  s_sleep 8
  v_mov_b32 v6, 0
  buffer_load_dword v126, v6, s[44:47], s76 offen sc0 sc1
  s_waitcnt vmcnt(0)
  v_readfirstlane_b32 s64, v126
  s_nop 3
  s_branch L_chk_K1
L_ok_K1:
  v_and_b32 v6, 3, v1
  v_lshlrev_b32 v6, 3, v6
  buffer_load_dwordx2 v[124:125], v6, s[48:51], s74 offen sc0 sc1
L_K1_hx:
  s_waitcnt vmcnt(31)
  v_dot2_f32_bf16 v131, v128, v11, 0
  v_dot2_f32_bf16 v131, v129, v12, v131
  v_dot2_f32_bf16 v131, v130, v13, v131
  buffer_load_dwordx3 v[128:130], v2, s[52:55], s62 offen nt
  s_add_u32 s62, s62, 6144
  s_waitcnt vmcnt(31)
  v_dot2_f32_bf16 v135, v132, v11, 0
  v_dot2_f32_bf16 v135, v133, v12, v135
  v_dot2_f32_bf16 v135, v134, v13, v135
  buffer_load_dwordx3 v[132:134], v2, s[52:55], s62 offen nt
  s_add_u32 s62, s62, 6144
  s_waitcnt vmcnt(31)
  v_dot2_f32_bf16 v139, v136, v11, 0
  v_dot2_f32_bf16 v139, v137, v12, v139
  v_dot2_f32_bf16 v139, v138, v13, v139
  buffer_load_dwordx3 v[136:138], v2, s[52:55], s62 offen nt
  s_add_u32 s62, s62, 6144
  s_waitcnt vmcnt(31)
  v_dot2_f32_bf16 v143, v140, v11, 0
  v_dot2_f32_bf16 v143, v141, v12, v143
  v_dot2_f32_bf16 v143, v142, v13, v143
  buffer_load_dwordx3 v[140:142], v2, s[52:55], s62 offen nt
  s_add_u32 s62, s62, 6144
  s_waitcnt vmcnt(31)
  v_dot2_f32_bf16 v147, v144, v11, 0
  v_dot2_f32_bf16 v147, v145, v12, v147
  v_dot2_f32_bf16 v147, v146, v13, v147
  buffer_load_dwordx3 v[144:146], v2, s[52:55], s62 offen nt
  s_add_u32 s62, s62, 6144
  s_waitcnt vmcnt(31)
  v_dot2_f32_bf16 v151, v148, v11, 0
  v_dot2_f32_bf16 v151, v149, v12, v151
  v_dot2_f32_bf16 v151, v150, v13, v151
  buffer_load_dwordx3 v[148:150], v2, s[52:55], s62 offen nt
  s_add_u32 s62, s62, 6144
  s_waitcnt vmcnt(31)
  v_dot2_f32_bf16 v155, v152, v11, 0
  v_dot2_f32_bf16 v155, v153, v12, v155
  v_dot2_f32_bf16 v155, v154, v13, v155
  buffer_load_dwordx3 v[152:154], v2, s[52:55], s62 offen nt
  s_add_u32 s62, s62, 6144
  s_waitcnt vmcnt(31)
  v_dot2_f32_bf16 v159, v156, v11, 0
  v_dot2_f32_bf16 v159, v157, v12, v159
  v_dot2_f32_bf16 v159, v158, v13, v159
  buffer_load_dwordx3 v[156:158], v2, s[52:55], s62 offen nt
  s_add_u32 s62, s62, 6144
  s_nop 1
  v_permlane16_swap_b32 v131, v135
  v_permlane16_swap_b32 v139, v143
  v_permlane16_swap_b32 v147, v151
  v_permlane16_swap_b32 v155, v159
  s_nop 0
  v_add_f32 v131, v131, v135
  v_add_f32 v139, v139, v143
  v_add_f32 v147, v147, v151
  v_add_f32 v155, v155, v159
  s_nop 0
  v_add_f32_dpp v131, v131, v131 row_ror:8 row_mask:0xf bank_mask:0x3
  v_add_f32_dpp v147, v147, v147 row_ror:8 row_mask:0xf bank_mask:0x3
  v_add_f32_dpp v131, v139, v139 row_ror:8 row_mask:0xf bank_mask:0xc
  v_add_f32_dpp v147, v155, v155 row_ror:8 row_mask:0xf bank_mask:0xc
  s_nop 1
  v_add_f32_dpp v131, v131, v131 row_half_mirror row_mask:0xf bank_mask:0x5
  v_add_f32_dpp v131, v147, v147 row_half_mirror row_mask:0xf bank_mask:0xa
  s_nop 1
  v_add_f32_dpp v131, v131, v131 quad_perm:[1,0,3,2] row_mask:0xf bank_mask:0xf
  s_nop 1
  v_add_f32_dpp v131, v131, v131 quad_perm:[2,3,0,1] row_mask:0xf bank_mask:0xf
  v_cvt_pk_bf16_f32 v131, v131, v131
  v_lshlrev_b32 v131, 16, v131
  v_mul_f32 v131, s82, v131
  v_cvt_pk_bf16_f32 v131, v131, v131
  v_lshlrev_b32 v131, 16, v131
  v_max_f32 v4, v4, v131
  s_mov_b64 exec, s[80:81]
  ds_write_b32 v3, v131 offset:8192
  s_mov_b64 exec, -1
  s_waitcnt vmcnt(31)
  v_dot2_f32_bf16 v163, v160, v11, 0
  v_dot2_f32_bf16 v163, v161, v12, v163
  v_dot2_f32_bf16 v163, v162, v13, v163
  buffer_load_dwordx3 v[160:162], v2, s[52:55], s62 offen nt
  s_add_u32 s62, s62, 6144
  s_waitcnt vmcnt(31)
  v_dot2_f32_bf16 v167, v164, v11, 0
  v_dot2_f32_bf16 v167, v165, v12, v167
  v_dot2_f32_bf16 v167, v166, v13, v167
  buffer_load_dwordx3 v[164:166], v2, s[52:55], s62 offen nt
  s_add_u32 s62, s62, 6144
  s_waitcnt vmcnt(31)
  v_dot2_f32_bf16 v171, v168, v11, 0
  v_dot2_f32_bf16 v171, v169, v12, v171
  v_dot2_f32_bf16 v171, v170, v13, v171
  buffer_load_dwordx3 v[168:170], v2, s[52:55], s62 offen nt
  s_add_u32 s62, s62, 6144
  s_waitcnt vmcnt(31)
  v_dot2_f32_bf16 v175, v172, v11, 0
  v_dot2_f32_bf16 v175, v173, v12, v175
  v_dot2_f32_bf16 v175, v174, v13, v175
  buffer_load_dwordx3 v[172:174], v2, s[52:55], s62 offen nt
  s_add_u32 s62, s62, 6144
  s_waitcnt vmcnt(31)
  v_dot2_f32_bf16 v179, v176, v11, 0
  v_dot2_f32_bf16 v179, v177, v12, v179
  v_dot2_f32_bf16 v179, v178, v13, v179
  buffer_load_dwordx3 v[176:178], v2, s[52:55], s62 offen nt
  s_add_u32 s62, s62, 6144
  s_waitcnt vmcnt(31)
  v_dot2_f32_bf16 v183, v180, v11, 0
  v_dot2_f32_bf16 v183, v181, v12, v183
  v_dot2_f32_bf16 v183, v182, v13, v183
  buffer_load_dwordx3 v[180:182], v2, s[52:55], s62 offen nt
  s_add_u32 s62, s62, 6144
  s_waitcnt vmcnt(31)
  v_dot2_f32_bf16 v187, v184, v11, 0
  v_dot2_f32_bf16 v187, v185, v12, v187
  v_dot2_f32_bf16 v187, v186, v13, v187
  buffer_load_dwordx3 v[184:186], v2, s[52:55], s62 offen nt
  s_add_u32 s62, s62, 6144
  s_waitcnt vmcnt(31)
  v_dot2_f32_bf16 v191, v188, v11, 0
  v_dot2_f32_bf16 v191, v189, v12, v191
  v_dot2_f32_bf16 v191, v190, v13, v191
  buffer_load_dwordx3 v[188:190], v2, s[52:55], s62 offen nt
  s_add_u32 s62, s62, 6144
  s_nop 1
  v_permlane16_swap_b32 v163, v167
  v_permlane16_swap_b32 v171, v175
  v_permlane16_swap_b32 v179, v183
  v_permlane16_swap_b32 v187, v191
  s_nop 0
  v_add_f32 v163, v163, v167
  v_add_f32 v171, v171, v175
  v_add_f32 v179, v179, v183
  v_add_f32 v187, v187, v191
  s_nop 0
  v_add_f32_dpp v163, v163, v163 row_ror:8 row_mask:0xf bank_mask:0x3
  v_add_f32_dpp v179, v179, v179 row_ror:8 row_mask:0xf bank_mask:0x3
  v_add_f32_dpp v163, v171, v171 row_ror:8 row_mask:0xf bank_mask:0xc
  v_add_f32_dpp v179, v187, v187 row_ror:8 row_mask:0xf bank_mask:0xc
  s_nop 1
  v_add_f32_dpp v163, v163, v163 row_half_mirror row_mask:0xf bank_mask:0x5
  v_add_f32_dpp v163, v179, v179 row_half_mirror row_mask:0xf bank_mask:0xa
  s_nop 1
  v_add_f32_dpp v163, v163, v163 quad_perm:[1,0,3,2] row_mask:0xf bank_mask:0xf
  s_nop 1
  v_add_f32_dpp v163, v163, v163 quad_perm:[2,3,0,1] row_mask:0xf bank_mask:0xf
  v_cvt_pk_bf16_f32 v163, v163, v163
  v_lshlrev_b32 v163, 16, v163
  v_mul_f32 v163, s82, v163
  v_cvt_pk_bf16_f32 v163, v163, v163
  v_lshlrev_b32 v163, 16, v163
  v_max_f32 v4, v4, v163
  s_mov_b64 exec, s[80:81]
  ds_write_b32 v3, v163 offset:8224
  s_mov_b64 exec, -1
  s_waitcnt vmcnt(31)
  v_dot2_f32_bf16 v195, v192, v11, 0
  v_dot2_f32_bf16 v195, v193, v12, v195
  v_dot2_f32_bf16 v195, v194, v13, v195
  buffer_load_dwordx3 v[192:194], v2, s[52:55], s62 offen nt
  s_add_u32 s62, s62, 6144
  s_waitcnt vmcnt(31)
  v_dot2_f32_bf16 v199, v196, v11, 0
  v_dot2_f32_bf16 v199, v197, v12, v199
  v_dot2_f32_bf16 v199, v198, v13, v199
  buffer_load_dwordx3 v[196:198], v2, s[52:55], s62 offen nt
  s_add_u32 s62, s62, 6144
  s_waitcnt vmcnt(31)
  v_dot2_f32_bf16 v203, v200, v11, 0
  v_dot2_f32_bf16 v203, v201, v12, v203
  v_dot2_f32_bf16 v203, v202, v13, v203
  buffer_load_dwordx3 v[200:202], v2, s[52:55], s62 offen nt
  s_add_u32 s62, s62, 6144
  s_waitcnt vmcnt(31)
  v_dot2_f32_bf16 v207, v204, v11, 0
  v_dot2_f32_bf16 v207, v205, v12, v207
  v_dot2_f32_bf16 v207, v206, v13, v207
  buffer_load_dwordx3 v[204:206], v2, s[52:55], s62 offen nt
  s_add_u32 s62, s62, 6144
  s_waitcnt vmcnt(31)
  v_dot2_f32_bf16 v211, v208, v11, 0
  v_dot2_f32_bf16 v211, v209, v12, v211
  v_dot2_f32_bf16 v211, v210, v13, v211
  buffer_load_dwordx3 v[208:210], v2, s[52:55], s62 offen nt
  s_add_u32 s62, s62, 6144
  s_waitcnt vmcnt(31)
  v_dot2_f32_bf16 v215, v212, v11, 0
  v_dot2_f32_bf16 v215, v213, v12, v215
  v_dot2_f32_bf16 v215, v214, v13, v215
  buffer_load_dwordx3 v[212:214], v2, s[52:55], s62 offen nt
  s_add_u32 s62, s62, 6144
  s_waitcnt vmcnt(31)
  v_dot2_f32_bf16 v219, v216, v11, 0
  v_dot2_f32_bf16 v219, v217, v12, v219
  v_dot2_f32_bf16 v219, v218, v13, v219
  buffer_load_dwordx3 v[216:218], v2, s[52:55], s62 offen nt
  s_add_u32 s62, s62, 6144
  s_waitcnt vmcnt(31)
  v_dot2_f32_bf16 v223, v220, v11, 0
  v_dot2_f32_bf16 v223, v221, v12, v223
  v_dot2_f32_bf16 v223, v222, v13, v223
  buffer_load_dwordx3 v[220:222], v2, s[52:55], s62 offen nt
  s_add_u32 s62, s62, 6144
  s_nop 1
  v_permlane16_swap_b32 v195, v199
  v_permlane16_swap_b32 v203, v207
  v_permlane16_swap_b32 v211, v215
  v_permlane16_swap_b32 v219, v223
  s_nop 0
  v_add_f32 v195, v195, v199
  v_add_f32 v203, v203, v207
  v_add_f32 v211, v211, v215
  v_add_f32 v219, v219, v223
  s_nop 0
  v_add_f32_dpp v195, v195, v195 row_ror:8 row_mask:0xf bank_mask:0x3
  v_add_f32_dpp v211, v211, v211 row_ror:8 row_mask:0xf bank_mask:0x3
  v_add_f32_dpp v195, v203, v203 row_ror:8 row_mask:0xf bank_mask:0xc
  v_add_f32_dpp v211, v219, v219 row_ror:8 row_mask:0xf bank_mask:0xc
  s_nop 1
  v_add_f32_dpp v195, v195, v195 row_half_mirror row_mask:0xf bank_mask:0x5
  v_add_f32_dpp v195, v211, v211 row_half_mirror row_mask:0xf bank_mask:0xa
  s_nop 1
  v_add_f32_dpp v195, v195, v195 quad_perm:[1,0,3,2] row_mask:0xf bank_mask:0xf
  s_nop 1
  v_add_f32_dpp v195, v195, v195 quad_perm:[2,3,0,1] row_mask:0xf bank_mask:0xf
  v_cvt_pk_bf16_f32 v195, v195, v195
  v_lshlrev_b32 v195, 16, v195
  v_mul_f32 v195, s82, v195
  v_cvt_pk_bf16_f32 v195, v195, v195
  v_lshlrev_b32 v195, 16, v195
  v_max_f32 v4, v4, v195
  s_mov_b64 exec, s[80:81]
  ds_write_b32 v3, v195 offset:8256
  s_mov_b64 exec, -1
  s_waitcnt vmcnt(31)
  v_dot2_f32_bf16 v227, v224, v11, 0
  v_dot2_f32_bf16 v227, v225, v12, v227
  v_dot2_f32_bf16 v227, v226, v13, v227
  buffer_load_dwordx3 v[224:226], v2, s[52:55], s62 offen nt
  s_add_u32 s62, s62, 6144
  s_waitcnt vmcnt(31)
  v_dot2_f32_bf16 v231, v228, v11, 0
  v_dot2_f32_bf16 v231, v229, v12, v231
  v_dot2_f32_bf16 v231, v230, v13, v231
  buffer_load_dwordx3 v[228:230], v2, s[52:55], s62 offen nt
  s_add_u32 s62, s62, 6144
  s_waitcnt vmcnt(31)
  v_dot2_f32_bf16 v235, v232, v11, 0
  v_dot2_f32_bf16 v235, v233, v12, v235
  v_dot2_f32_bf16 v235, v234, v13, v235
  buffer_load_dwordx3 v[232:234], v2, s[52:55], s62 offen nt
  s_add_u32 s62, s62, 6144
  s_waitcnt vmcnt(31)
  v_dot2_f32_bf16 v239, v236, v11, 0
  v_dot2_f32_bf16 v239, v237, v12, v239
  v_dot2_f32_bf16 v239, v238, v13, v239
  buffer_load_dwordx3 v[236:238], v2, s[52:55], s62 offen nt
  s_add_u32 s62, s62, 6144
  s_waitcnt vmcnt(31)
  v_dot2_f32_bf16 v243, v240, v11, 0
  v_dot2_f32_bf16 v243, v241, v12, v243
  v_dot2_f32_bf16 v243, v242, v13, v243
  buffer_load_dwordx3 v[240:242], v2, s[52:55], s62 offen nt
  s_add_u32 s62, s62, 6144
  s_waitcnt vmcnt(31)
  v_dot2_f32_bf16 v247, v244, v11, 0
  v_dot2_f32_bf16 v247, v245, v12, v247
  v_dot2_f32_bf16 v247, v246, v13, v247
  buffer_load_dwordx3 v[244:246], v2, s[52:55], s62 offen nt
  s_add_u32 s62, s62, 6144
  s_waitcnt vmcnt(31)
  v_dot2_f32_bf16 v251, v248, v11, 0
  v_dot2_f32_bf16 v251, v249, v12, v251
  v_dot2_f32_bf16 v251, v250, v13, v251
  buffer_load_dwordx3 v[248:250], v2, s[52:55], s62 offen nt
  s_add_u32 s62, s62, 6144
  s_waitcnt vmcnt(31)
  v_dot2_f32_bf16 v255, v252, v11, 0
  v_dot2_f32_bf16 v255, v253, v12, v255
  v_dot2_f32_bf16 v255, v254, v13, v255
  buffer_load_dwordx3 v[252:254], v2, s[52:55], s62 offen nt
  s_add_u32 s62, s62, 6144
  s_nop 1
  v_permlane16_swap_b32 v227, v231
  v_permlane16_swap_b32 v235, v239
  v_permlane16_swap_b32 v243, v247
  v_permlane16_swap_b32 v251, v255
  s_nop 0
  v_add_f32 v227, v227, v231
  v_add_f32 v235, v235, v239
  v_add_f32 v243, v243, v247
  v_add_f32 v251, v251, v255
  s_nop 0
  v_add_f32_dpp v227, v227, v227 row_ror:8 row_mask:0xf bank_mask:0x3
  v_add_f32_dpp v243, v243, v243 row_ror:8 row_mask:0xf bank_mask:0x3
  v_add_f32_dpp v227, v235, v235 row_ror:8 row_mask:0xf bank_mask:0xc
  v_add_f32_dpp v243, v251, v251 row_ror:8 row_mask:0xf bank_mask:0xc
  s_nop 1
  v_add_f32_dpp v227, v227, v227 row_half_mirror row_mask:0xf bank_mask:0x5
  v_add_f32_dpp v227, v243, v243 row_half_mirror row_mask:0xf bank_mask:0xa
  s_nop 1
  v_add_f32_dpp v227, v227, v227 quad_perm:[1,0,3,2] row_mask:0xf bank_mask:0xf
  s_nop 1
  v_add_f32_dpp v227, v227, v227 quad_perm:[2,3,0,1] row_mask:0xf bank_mask:0xf
  v_cvt_pk_bf16_f32 v227, v227, v227
  v_lshlrev_b32 v227, 16, v227
  v_mul_f32 v227, s82, v227
  v_cvt_pk_bf16_f32 v227, v227, v227
  v_lshlrev_b32 v227, 16, v227
  v_max_f32 v4, v4, v227
  s_mov_b64 exec, s[80:81]
  ds_write_b32 v3, v227 offset:8288
  s_mov_b64 exec, -1
  v_add_u32 v3, 128, v3
  s_add_u32 s63, s63, 1
  s_cmp_lt_u32 s63, 4
  s_cbranch_scc1 L_K1
  v_subrev_u32 v3, 512, v3
  s_waitcnt lgkmcnt(0)
  ds_read_b128 v[28:31], v7 offset:8192
  s_nop 1
  v_max_f32_dpp v4, v4, v4 quad_perm:[1,0,3,2] row_mask:0xf bank_mask:0xf
  s_nop 1
  v_max_f32_dpp v4, v4, v4 quad_perm:[2,3,0,1] row_mask:0xf bank_mask:0xf
  s_nop 1
  v_max_f32_dpp v4, v4, v4 row_half_mirror row_mask:0xf bank_mask:0xf
  s_nop 1
  v_max_f32_dpp v4, v4, v4 row_mirror row_mask:0xf bank_mask:0xf
  v_mov_b32 v5, v4
  s_nop 1
  v_permlane16_swap_b32 v4, v5
  s_nop 1
  v_max_f32 v4, v4, v5
  v_mov_b32 v5, v4
  s_nop 1
  v_permlane32_swap_b32 v4, v5
  s_nop 1
  v_max_f32 v4, v4, v5
  s_waitcnt lgkmcnt(0)
  v_sub_f32 v28, v28, v4
  v_sub_f32 v29, v29, v4
  v_sub_f32 v30, v30, v4
  v_sub_f32 v31, v31, v4
  v_mul_f32 v28, s83, v28
  v_mul_f32 v29, s83, v29
  v_mul_f32 v30, s83, v30
  v_mul_f32 v31, s83, v31
  v_exp_f32 v28, v28
  v_exp_f32 v29, v29
  v_exp_f32 v30, v30
  v_exp_f32 v31, v31
  s_nop 0
  v_add_f32 v28, v28, v29
  v_add_f32 v30, v30, v31
  v_add_f32 v5, v28, v30
  s_nop 1
  v_add_f32_dpp v5, v5, v5 quad_perm:[1,0,3,2] row_mask:0xf bank_mask:0xf
  s_nop 1
  v_add_f32_dpp v5, v5, v5 quad_perm:[2,3,0,1] row_mask:0xf bank_mask:0xf
  s_nop 1
  v_add_f32_dpp v5, v5, v5 row_half_mirror row_mask:0xf bank_mask:0xf
  s_nop 1
  v_add_f32_dpp v5, v5, v5 row_mirror row_mask:0xf bank_mask:0xf
  v_mov_b32 v6, v5
  s_nop 1
  v_permlane16_swap_b32 v5, v6
  s_nop 1
  v_add_f32 v5, v5, v6
  v_mov_b32 v6, v5
  s_nop 1
  v_permlane32_swap_b32 v5, v6
  s_nop 1
  v_add_f32 v5, v5, v6
  s_lshl_b32 s64, s59, 3
  v_mov_b32 v6, s64
  s_mov_b64 exec, 1
  ds_write_b64 v6, v[4:5] offset:48448
  s_mov_b64 exec, -1
  v_mov_b32 v4, 0xff800000
  s_cmp_eq_u32 s59, 0
  s_cbranch_scc0 L_gs0
  v_mov_b32 v5, v124
  s_nop 1
  v_max_f32_dpp v5, v5, v5 quad_perm:[1,0,3,2] row_mask:0xf bank_mask:0xf
  s_nop 1
  v_max_f32_dpp v5, v5, v5 quad_perm:[2,3,0,1] row_mask:0xf bank_mask:0xf
  v_sub_f32 v124, v124, v5
  v_mul_f32 v124, s83, v124
  v_exp_f32 v124, v124
  s_nop 0
  v_mul_f32 v125, v125, v124
  s_nop 1
  v_add_f32_dpp v125, v125, v125 quad_perm:[1,0,3,2] row_mask:0xf bank_mask:0xf
  s_nop 1
  v_add_f32_dpp v125, v125, v125 quad_perm:[2,3,0,1] row_mask:0xf bank_mask:0xf
  v_mov_b32 v124, v5
  v_rcp_f32 v6, v125
  s_nop 0
  v_fma_f32 v5, -v125, v6, 1.0
  v_fma_f32 v125, v5, v6, v6
  v_mov_b32 v6, 0
  s_mov_b64 exec, 1
  ds_write_b64 v6, v[124:125] offset:48512
  s_mov_b64 exec, -1
L_gs0:
  v_mov_b32 v14, 0
  v_mov_b32 v15, 0
  v_mov_b32 v16, 0
  v_mov_b32 v17, 0
  v_mov_b32 v18, 0
  v_mov_b32 v19, 0
  v_mov_b32 v20, 0
  v_mov_b32 v21, 0
  v_mov_b32 v22, 0
  v_mov_b32 v23, 0
  v_mov_b32 v24, 0
  v_mov_b32 v25, 0
  ds_read_b128 v[26:29], v7 offset:8192
  v_lshlrev_b32 v5, 4, v1
  s_waitcnt lgkmcnt(0)
  buffer_store_dwordx4 v[26:29], v5, s[48:51], s10 offen sc0 sc1
  v_lshrrev_b32 v5, 5, v1
  v_lshlrev_b32 v5, 9, v5
  s_lshl_b32 s64, s59, 10
  v_add_u32 v3, s64, v5
  s_mov_b32 s63, 0
L_V0:
  s_waitcnt lgkmcnt(0)
  s_barrier
  s_cmp_eq_u32 s63, 0
  s_cbranch_scc0 L_V0_h0
  v_mov_b32 v6, 0
  ds_read_b128 v[26:29], v7 offset:0
  ds_read_b64 v[30:31], v6 offset:48512
  s_waitcnt lgkmcnt(0)
  v_sub_f32 v26, v26, v30
  v_sub_f32 v27, v27, v30
  v_sub_f32 v28, v28, v30
  v_sub_f32 v29, v29, v30
  v_mul_f32 v26, s83, v26
  v_mul_f32 v27, s83, v27
  v_mul_f32 v28, s83, v28
  v_mul_f32 v29, s83, v29
  v_exp_f32 v26, v26
  v_exp_f32 v27, v27
  v_exp_f32 v28, v28
  v_exp_f32 v29, v29
  s_nop 0
  v_mul_f32 v26, v26, v31
  v_mul_f32 v27, v27, v31
  v_mul_f32 v28, v28, v31
  v_mul_f32 v29, v29, v31
  v_cvt_pk_bf16_f32 v26, v26, v6
  v_cvt_pk_bf16_f32 v27, v27, v6
  v_cvt_pk_bf16_f32 v28, v28, v6
  v_cvt_pk_bf16_f32 v29, v29, v6
  ds_write_b128 v7, v[26:29] offset:0
  s_waitcnt lgkmcnt(0)
L_V0_h0:
  s_cmp_eq_u32 s63, 3
  s_cbranch_scc0 L_V0_h3
  s_mov_b32 s52, s32
  s_mov_b32 s53, s33
  s_mov_b32 s54, s34
  s_mov_b32 s55, s35
  s_mov_b32 s62, s61
  v_lshrrev_b32 v29, 5, v1
  v_lshlrev_b32 v29, 9, v29
  s_lshl_b32 s12, s58, 3
  s_add_u32 s13, s12, 1
  s_lshr_b32 s64, s12, 3
  s_lshl_b32 s64, s64, 13
  s_and_b32 s65, s12, 7
  s_lshl_b32 s65, s65, 6
  s_add_u32 s64, s64, s65
  s_add_u32 s64, s64, s9
  buffer_load_dwordx4 v[64:67], v29, s[48:51], s64 offen offset:0 sc0 sc1
  buffer_load_dwordx4 v[68:71], v29, s[48:51], s64 offen offset:16 sc0 sc1
  buffer_load_dwordx4 v[72:75], v29, s[48:51], s64 offen offset:32 sc0 sc1
  buffer_load_dwordx4 v[76:79], v29, s[48:51], s64 offen offset:48 sc0 sc1
  s_lshr_b32 s64, s13, 3
  s_lshl_b32 s64, s64, 13
  s_and_b32 s65, s13, 7
  s_lshl_b32 s65, s65, 6
  s_add_u32 s64, s64, s65
  s_add_u32 s64, s64, s9
  buffer_load_dwordx4 v[80:83], v29, s[48:51], s64 offen offset:0 sc0 sc1
  buffer_load_dwordx4 v[84:87], v29, s[48:51], s64 offen offset:16 sc0 sc1
  buffer_load_dwordx4 v[88:91], v29, s[48:51], s64 offen offset:32 sc0 sc1
  buffer_load_dwordx4 v[92:95], v29, s[48:51], s64 offen offset:48 sc0 sc1
L_V0_h3:
  s_cmp_eq_u32 s59, 0
  s_cbranch_scc0 L_V0_hx
  s_cmp_eq_u32 s63, 0
  s_cbranch_scc0 L_V0_a
  v_and_b32 v6, 7, v1
  v_lshlrev_b32 v6, 3, v6
  ds_read_b64 v[30:31], v6 offset:48448
  s_waitcnt lgkmcnt(0)
  v_mov_b32 v5, v30
  s_nop 1
  v_max_f32_dpp v5, v5, v5 quad_perm:[1,0,3,2] row_mask:0xf bank_mask:0xf
  s_nop 1
  v_max_f32_dpp v5, v5, v5 quad_perm:[2,3,0,1] row_mask:0xf bank_mask:0xf
  s_nop 1
  v_max_f32_dpp v5, v5, v5 row_half_mirror row_mask:0xf bank_mask:0xf
  v_sub_f32 v30, v30, v5
  v_mul_f32 v30, s83, v30
  v_exp_f32 v30, v30
  s_nop 0
  v_mul_f32 v31, v31, v30
  s_nop 1
  v_add_f32_dpp v31, v31, v31 quad_perm:[1,0,3,2] row_mask:0xf bank_mask:0xf
  s_nop 1
  v_add_f32_dpp v31, v31, v31 quad_perm:[2,3,0,1] row_mask:0xf bank_mask:0xf
  s_nop 1
  v_add_f32_dpp v31, v31, v31 row_half_mirror row_mask:0xf bank_mask:0xf
  v_mov_b32 v30, v5
  v_mov_b32 v6, 0
  s_mov_b64 exec, 1
  buffer_store_dwordx2 v[30:31], v6, s[48:51], s73 offen sc0 sc1
  s_mov_b64 exec, -1
  v_mov_b32 v6, 0
  buffer_load_dword v127, v6, s[44:47], 0 offen offset:160 sc0 sc1
  s_branch L_V0_hx
L_V0_a:
  s_cmp_eq_u32 s63, 1
  s_cbranch_scc0 L_V0_b
  v_mov_b32 v6, 0
  v_mov_b32 v5, s79
  s_mov_b64 exec, 1
  buffer_atomic_add v5, v6, s[44:47], s77 offen sc1
  s_mov_b64 exec, -1
L_zf:
  v_readfirstlane_b32 s64, v127
  s_nop 3
  s_cmp_eq_u32 s64, 1
  s_cbranch_scc1 L_zf_ok
  s_sleep 8
  v_mov_b32 v6, 0
  buffer_load_dword v127, v6, s[44:47], 0 offen offset:160 sc0 sc1
  s_waitcnt vmcnt(0)
  s_branch L_zf
L_zf_ok:
  v_mov_b32 v122, 1
  v_mov_b32 v6, 0
  s_mov_b64 exec, 1
  buffer_atomic_add v122, v6, s[48:51], s11 offen sc0 sc1
  s_mov_b64 exec, -1
  s_branch L_V0_hx
L_V0_b:
  s_cmp_eq_u32 s63, 2
  s_cbranch_scc0 L_V0_c
  v_mov_b32 v6, 0
  buffer_load_dword v126, v6, s[44:47], s77 offen sc0 sc1
  v_mov_b32 v123, 1
  v_mov_b32 v6, 0
  s_mov_b64 exec, 1
  buffer_atomic_add v123, v6, s[48:51], s11 offen sc0 sc1
  s_mov_b64 exec, -1
  s_branch L_V0_hx
L_V0_c:
  v_readfirstlane_b32 s64, v126
  s_nop 3
L_chk_V0:
  s_lshr_b32 s64, s64, s78
  s_and_b32 s64, s64, 0xff
  s_cmp_eq_u32 s64, 4
  s_cbranch_scc1 L_ok_V0
  s_sleep 8
  v_mov_b32 v6, 0
  buffer_load_dword v126, v6, s[44:47], s77 offen sc0 sc1
  s_waitcnt vmcnt(0)
  v_readfirstlane_b32 s64, v126
  s_nop 3
  s_branch L_chk_V0
L_ok_V0:
  v_and_b32 v6, 3, v1
  v_lshlrev_b32 v6, 3, v6
  buffer_load_dwordx2 v[124:125], v6, s[48:51], s75 offen sc0 sc1
L_V0_hx:
  ds_read_b128 v[32:35], v3 offset:0
  ds_read_b128 v[36:39], v3 offset:16
  ds_read_b128 v[40:43], v3 offset:32
  ds_read_b128 v[44:47], v3 offset:48
  ds_read_b128 v[48:51], v3 offset:64
  ds_read_b128 v[52:55], v3 offset:80
  ds_read_b128 v[56:59], v3 offset:96
  ds_read_b128 v[60:63], v3 offset:112
  s_waitcnt lgkmcnt(0)
  s_waitcnt vmcnt(31)
  v_lshlrev_b32 v26, 16, v32
  v_dot2c_f32_bf16 v14, v128, v32
  v_dot2c_f32_bf16 v16, v129, v32
  v_dot2c_f32_bf16 v18, v130, v32
  v_dot2c_f32_bf16 v15, v128, v26
  v_dot2c_f32_bf16 v17, v129, v26
  v_dot2c_f32_bf16 v19, v130, v26
  buffer_load_dwordx3 v[128:130], v2, s[52:55], s62 offen nt
  s_add_u32 s62, s62, 6144
  s_waitcnt vmcnt(31)
  v_lshlrev_b32 v27, 16, v33
  v_dot2c_f32_bf16 v14, v132, v33
  v_dot2c_f32_bf16 v16, v133, v33
  v_dot2c_f32_bf16 v18, v134, v33
  v_dot2c_f32_bf16 v15, v132, v27
  v_dot2c_f32_bf16 v17, v133, v27
  v_dot2c_f32_bf16 v19, v134, v27
  buffer_load_dwordx3 v[132:134], v2, s[52:55], s62 offen nt
  s_add_u32 s62, s62, 6144
  s_waitcnt vmcnt(31)
  v_lshlrev_b32 v26, 16, v34
  v_dot2c_f32_bf16 v14, v136, v34
  v_dot2c_f32_bf16 v16, v137, v34
  v_dot2c_f32_bf16 v18, v138, v34
  v_dot2c_f32_bf16 v15, v136, v26
  v_dot2c_f32_bf16 v17, v137, v26
  v_dot2c_f32_bf16 v19, v138, v26
  buffer_load_dwordx3 v[136:138], v2, s[52:55], s62 offen nt
  s_add_u32 s62, s62, 6144
  s_waitcnt vmcnt(31)
  v_lshlrev_b32 v27, 16, v35
  v_dot2c_f32_bf16 v14, v140, v35
  v_dot2c_f32_bf16 v16, v141, v35
  v_dot2c_f32_bf16 v18, v142, v35
  v_dot2c_f32_bf16 v15, v140, v27
  v_dot2c_f32_bf16 v17, v141, v27
  v_dot2c_f32_bf16 v19, v142, v27
  buffer_load_dwordx3 v[140:142], v2, s[52:55], s62 offen nt
  s_add_u32 s62, s62, 6144
  s_waitcnt vmcnt(31)
  v_lshlrev_b32 v26, 16, v36
  v_dot2c_f32_bf16 v14, v144, v36
  v_dot2c_f32_bf16 v16, v145, v36
  v_dot2c_f32_bf16 v18, v146, v36
  v_dot2c_f32_bf16 v15, v144, v26
  v_dot2c_f32_bf16 v17, v145, v26
  v_dot2c_f32_bf16 v19, v146, v26
  buffer_load_dwordx3 v[144:146], v2, s[52:55], s62 offen nt
  s_add_u32 s62, s62, 6144
  s_waitcnt vmcnt(31)
  v_lshlrev_b32 v27, 16, v37
  v_dot2c_f32_bf16 v14, v148, v37
  v_dot2c_f32_bf16 v16, v149, v37
  v_dot2c_f32_bf16 v18, v150, v37
  v_dot2c_f32_bf16 v15, v148, v27
  v_dot2c_f32_bf16 v17, v149, v27
  v_dot2c_f32_bf16 v19, v150, v27
  buffer_load_dwordx3 v[148:150], v2, s[52:55], s62 offen nt
  s_add_u32 s62, s62, 6144
  s_waitcnt vmcnt(31)
  v_lshlrev_b32 v26, 16, v38
  v_dot2c_f32_bf16 v14, v152, v38
  v_dot2c_f32_bf16 v16, v153, v38
  v_dot2c_f32_bf16 v18, v154, v38
  v_dot2c_f32_bf16 v15, v152, v26
  v_dot2c_f32_bf16 v17, v153, v26
  v_dot2c_f32_bf16 v19, v154, v26
  buffer_load_dwordx3 v[152:154], v2, s[52:55], s62 offen nt
  s_add_u32 s62, s62, 6144
  s_waitcnt vmcnt(31)
  v_lshlrev_b32 v27, 16, v39
  v_dot2c_f32_bf16 v14, v156, v39
  v_dot2c_f32_bf16 v16, v157, v39
  v_dot2c_f32_bf16 v18, v158, v39
  v_dot2c_f32_bf16 v15, v156, v27
  v_dot2c_f32_bf16 v17, v157, v27
  v_dot2c_f32_bf16 v19, v158, v27
  buffer_load_dwordx3 v[156:158], v2, s[52:55], s62 offen nt
  s_add_u32 s62, s62, 6144
  s_waitcnt vmcnt(31)
  v_lshlrev_b32 v26, 16, v40
  v_dot2c_f32_bf16 v14, v160, v40
  v_dot2c_f32_bf16 v16, v161, v40
  v_dot2c_f32_bf16 v18, v162, v40
  v_dot2c_f32_bf16 v15, v160, v26
  v_dot2c_f32_bf16 v17, v161, v26
  v_dot2c_f32_bf16 v19, v162, v26
  buffer_load_dwordx3 v[160:162], v2, s[52:55], s62 offen nt
  s_add_u32 s62, s62, 6144
  s_waitcnt vmcnt(31)
  v_lshlrev_b32 v27, 16, v41
  v_dot2c_f32_bf16 v14, v164, v41
  v_dot2c_f32_bf16 v16, v165, v41
  v_dot2c_f32_bf16 v18, v166, v41
  v_dot2c_f32_bf16 v15, v164, v27
  v_dot2c_f32_bf16 v17, v165, v27
  v_dot2c_f32_bf16 v19, v166, v27
  buffer_load_dwordx3 v[164:166], v2, s[52:55], s62 offen nt
  s_add_u32 s62, s62, 6144
  s_waitcnt vmcnt(31)
  v_lshlrev_b32 v26, 16, v42
  v_dot2c_f32_bf16 v14, v168, v42
  v_dot2c_f32_bf16 v16, v169, v42
  v_dot2c_f32_bf16 v18, v170, v42
  v_dot2c_f32_bf16 v15, v168, v26
  v_dot2c_f32_bf16 v17, v169, v26
  v_dot2c_f32_bf16 v19, v170, v26
  buffer_load_dwordx3 v[168:170], v2, s[52:55], s62 offen nt
  s_add_u32 s62, s62, 6144
  s_waitcnt vmcnt(31)
  v_lshlrev_b32 v27, 16, v43
  v_dot2c_f32_bf16 v14, v172, v43
  v_dot2c_f32_bf16 v16, v173, v43
  v_dot2c_f32_bf16 v18, v174, v43
  v_dot2c_f32_bf16 v15, v172, v27
  v_dot2c_f32_bf16 v17, v173, v27
  v_dot2c_f32_bf16 v19, v174, v27
  buffer_load_dwordx3 v[172:174], v2, s[52:55], s62 offen nt
  s_add_u32 s62, s62, 6144
  s_waitcnt vmcnt(31)
  v_lshlrev_b32 v26, 16, v44
  v_dot2c_f32_bf16 v14, v176, v44
  v_dot2c_f32_bf16 v16, v177, v44
  v_dot2c_f32_bf16 v18, v178, v44
  v_dot2c_f32_bf16 v15, v176, v26
  v_dot2c_f32_bf16 v17, v177, v26
  v_dot2c_f32_bf16 v19, v178, v26
  buffer_load_dwordx3 v[176:178], v2, s[52:55], s62 offen nt
  s_add_u32 s62, s62, 6144
  s_waitcnt vmcnt(31)
  v_lshlrev_b32 v27, 16, v45
  v_dot2c_f32_bf16 v14, v180, v45
  v_dot2c_f32_bf16 v16, v181, v45
  v_dot2c_f32_bf16 v18, v182, v45
  v_dot2c_f32_bf16 v15, v180, v27
  v_dot2c_f32_bf16 v17, v181, v27
  v_dot2c_f32_bf16 v19, v182, v27
  buffer_load_dwordx3 v[180:182], v2, s[52:55], s62 offen nt
  s_add_u32 s62, s62, 6144
  s_waitcnt vmcnt(31)
  v_lshlrev_b32 v26, 16, v46
  v_dot2c_f32_bf16 v14, v184, v46
  v_dot2c_f32_bf16 v16, v185, v46
  v_dot2c_f32_bf16 v18, v186, v46
  v_dot2c_f32_bf16 v15, v184, v26
  v_dot2c_f32_bf16 v17, v185, v26
  v_dot2c_f32_bf16 v19, v186, v26
  buffer_load_dwordx3 v[184:186], v2, s[52:55], s62 offen nt
  s_add_u32 s62, s62, 6144
  s_waitcnt vmcnt(31)
  v_lshlrev_b32 v27, 16, v47
  v_dot2c_f32_bf16 v14, v188, v47
  v_dot2c_f32_bf16 v16, v189, v47
  v_dot2c_f32_bf16 v18, v190, v47
  v_dot2c_f32_bf16 v15, v188, v27
  v_dot2c_f32_bf16 v17, v189, v27
  v_dot2c_f32_bf16 v19, v190, v27
  buffer_load_dwordx3 v[188:190], v2, s[52:55], s62 offen nt
  s_add_u32 s62, s62, 6144
  s_waitcnt vmcnt(31)
  v_lshlrev_b32 v26, 16, v48
  v_dot2c_f32_bf16 v14, v192, v48
  v_dot2c_f32_bf16 v16, v193, v48
  v_dot2c_f32_bf16 v18, v194, v48
  v_dot2c_f32_bf16 v15, v192, v26
  v_dot2c_f32_bf16 v17, v193, v26
  v_dot2c_f32_bf16 v19, v194, v26
  buffer_load_dwordx3 v[192:194], v2, s[52:55], s62 offen nt
  s_add_u32 s62, s62, 6144
  s_waitcnt vmcnt(31)
  v_lshlrev_b32 v27, 16, v49
  v_dot2c_f32_bf16 v14, v196, v49
  v_dot2c_f32_bf16 v16, v197, v49
  v_dot2c_f32_bf16 v18, v198, v49
  v_dot2c_f32_bf16 v15, v196, v27
  v_dot2c_f32_bf16 v17, v197, v27
  v_dot2c_f32_bf16 v19, v198, v27
  buffer_load_dwordx3 v[196:198], v2, s[52:55], s62 offen nt
  s_add_u32 s62, s62, 6144
  s_waitcnt vmcnt(31)
  v_lshlrev_b32 v26, 16, v50
  v_dot2c_f32_bf16 v14, v200, v50
  v_dot2c_f32_bf16 v16, v201, v50
  v_dot2c_f32_bf16 v18, v202, v50
  v_dot2c_f32_bf16 v15, v200, v26
  v_dot2c_f32_bf16 v17, v201, v26
  v_dot2c_f32_bf16 v19, v202, v26
  buffer_load_dwordx3 v[200:202], v2, s[52:55], s62 offen nt
  s_add_u32 s62, s62, 6144
  s_waitcnt vmcnt(31)
  v_lshlrev_b32 v27, 16, v51
  v_dot2c_f32_bf16 v14, v204, v51
  v_dot2c_f32_bf16 v16, v205, v51
  v_dot2c_f32_bf16 v18, v206, v51
  v_dot2c_f32_bf16 v15, v204, v27
  v_dot2c_f32_bf16 v17, v205, v27
  v_dot2c_f32_bf16 v19, v206, v27
  buffer_load_dwordx3 v[204:206], v2, s[52:55], s62 offen nt
  s_add_u32 s62, s62, 6144
  s_waitcnt vmcnt(31)
  v_lshlrev_b32 v26, 16, v52
  v_dot2c_f32_bf16 v14, v208, v52
  v_dot2c_f32_bf16 v16, v209, v52
  v_dot2c_f32_bf16 v18, v210, v52
  v_dot2c_f32_bf16 v15, v208, v26
  v_dot2c_f32_bf16 v17, v209, v26
  v_dot2c_f32_bf16 v19, v210, v26
  buffer_load_dwordx3 v[208:210], v2, s[52:55], s62 offen nt
  s_add_u32 s62, s62, 6144
  s_waitcnt vmcnt(31)
  v_lshlrev_b32 v27, 16, v53
  v_dot2c_f32_bf16 v14, v212, v53
  v_dot2c_f32_bf16 v16, v213, v53
  v_dot2c_f32_bf16 v18, v214, v53
  v_dot2c_f32_bf16 v15, v212, v27
  v_dot2c_f32_bf16 v17, v213, v27
  v_dot2c_f32_bf16 v19, v214, v27
  buffer_load_dwordx3 v[212:214], v2, s[52:55], s62 offen nt
  s_add_u32 s62, s62, 6144
  s_waitcnt vmcnt(31)
  v_lshlrev_b32 v26, 16, v54
  v_dot2c_f32_bf16 v14, v216, v54
  v_dot2c_f32_bf16 v16, v217, v54
  v_dot2c_f32_bf16 v18, v218, v54
  v_dot2c_f32_bf16 v15, v216, v26
  v_dot2c_f32_bf16 v17, v217, v26
  v_dot2c_f32_bf16 v19, v218, v26
  buffer_load_dwordx3 v[216:218], v2, s[52:55], s62 offen nt
  s_add_u32 s62, s62, 6144
  s_waitcnt vmcnt(31)
  v_lshlrev_b32 v27, 16, v55
  v_dot2c_f32_bf16 v14, v220, v55
  v_dot2c_f32_bf16 v16, v221, v55
  v_dot2c_f32_bf16 v18, v222, v55
  v_dot2c_f32_bf16 v15, v220, v27
  v_dot2c_f32_bf16 v17, v221, v27
  v_dot2c_f32_bf16 v19, v222, v27
  buffer_load_dwordx3 v[220:222], v2, s[52:55], s62 offen nt
  s_add_u32 s62, s62, 6144
  s_waitcnt vmcnt(31)
  v_lshlrev_b32 v26, 16, v56
  v_dot2c_f32_bf16 v14, v224, v56
  v_dot2c_f32_bf16 v16, v225, v56
  v_dot2c_f32_bf16 v18, v226, v56
  v_dot2c_f32_bf16 v15, v224, v26
  v_dot2c_f32_bf16 v17, v225, v26
  v_dot2c_f32_bf16 v19, v226, v26
  buffer_load_dwordx3 v[224:226], v2, s[52:55], s62 offen nt
  s_add_u32 s62, s62, 6144
  s_waitcnt vmcnt(31)
  v_lshlrev_b32 v27, 16, v57
  v_dot2c_f32_bf16 v14, v228, v57
  v_dot2c_f32_bf16 v16, v229, v57
  v_dot2c_f32_bf16 v18, v230, v57
  v_dot2c_f32_bf16 v15, v228, v27
  v_dot2c_f32_bf16 v17, v229, v27
  v_dot2c_f32_bf16 v19, v230, v27
  buffer_load_dwordx3 v[228:230], v2, s[52:55], s62 offen nt
  s_add_u32 s62, s62, 6144
  s_waitcnt vmcnt(31)
  v_lshlrev_b32 v26, 16, v58
  v_dot2c_f32_bf16 v14, v232, v58
  v_dot2c_f32_bf16 v16, v233, v58
  v_dot2c_f32_bf16 v18, v234, v58
  v_dot2c_f32_bf16 v15, v232, v26
  v_dot2c_f32_bf16 v17, v233, v26
  v_dot2c_f32_bf16 v19, v234, v26
  buffer_load_dwordx3 v[232:234], v2, s[52:55], s62 offen nt
  s_add_u32 s62, s62, 6144
  s_waitcnt vmcnt(31)
  v_lshlrev_b32 v27, 16, v59
  v_dot2c_f32_bf16 v14, v236, v59
  v_dot2c_f32_bf16 v16, v237, v59
  v_dot2c_f32_bf16 v18, v238, v59
  v_dot2c_f32_bf16 v15, v236, v27
  v_dot2c_f32_bf16 v17, v237, v27
  v_dot2c_f32_bf16 v19, v238, v27
  buffer_load_dwordx3 v[236:238], v2, s[52:55], s62 offen nt
  s_add_u32 s62, s62, 6144
  s_waitcnt vmcnt(31)
  v_lshlrev_b32 v26, 16, v60
  v_dot2c_f32_bf16 v14, v240, v60
  v_dot2c_f32_bf16 v16, v241, v60
  v_dot2c_f32_bf16 v18, v242, v60
  v_dot2c_f32_bf16 v15, v240, v26
  v_dot2c_f32_bf16 v17, v241, v26
  v_dot2c_f32_bf16 v19, v242, v26
  buffer_load_dwordx3 v[240:242], v2, s[52:55], s62 offen nt
  s_add_u32 s62, s62, 6144
  s_waitcnt vmcnt(31)
  v_lshlrev_b32 v27, 16, v61
  v_dot2c_f32_bf16 v14, v244, v61
  v_dot2c_f32_bf16 v16, v245, v61
  v_dot2c_f32_bf16 v18, v246, v61
  v_dot2c_f32_bf16 v15, v244, v27
  v_dot2c_f32_bf16 v17, v245, v27
  v_dot2c_f32_bf16 v19, v246, v27
  buffer_load_dwordx3 v[244:246], v2, s[52:55], s62 offen nt
  s_add_u32 s62, s62, 6144
  s_waitcnt vmcnt(31)
  v_lshlrev_b32 v26, 16, v62
  v_dot2c_f32_bf16 v14, v248, v62
  v_dot2c_f32_bf16 v16, v249, v62
  v_dot2c_f32_bf16 v18, v250, v62
  v_dot2c_f32_bf16 v15, v248, v26
  v_dot2c_f32_bf16 v17, v249, v26
  v_dot2c_f32_bf16 v19, v250, v26
  buffer_load_dwordx3 v[248:250], v2, s[52:55], s62 offen nt
  s_add_u32 s62, s62, 6144
  s_waitcnt vmcnt(31)
  v_lshlrev_b32 v27, 16, v63
  v_dot2c_f32_bf16 v14, v252, v63
  v_dot2c_f32_bf16 v16, v253, v63
  v_dot2c_f32_bf16 v18, v254, v63
  v_dot2c_f32_bf16 v15, v252, v27
  v_dot2c_f32_bf16 v17, v253, v27
  v_dot2c_f32_bf16 v19, v254, v27
  buffer_load_dwordx3 v[252:254], v2, s[52:55], s62 offen nt
  s_add_u32 s62, s62, 6144
  v_add_u32 v3, 128, v3
  s_add_u32 s63, s63, 1
  s_cmp_lt_u32 s63, 4
  s_cbranch_scc1 L_V0
  s_cmp_eq_u32 s59, 0
  s_cbranch_scc0 L_gs1
  v_mov_b32 v5, v124
  s_nop 1
  v_max_f32_dpp v5, v5, v5 quad_perm:[1,0,3,2] row_mask:0xf bank_mask:0xf
  s_nop 1
  v_max_f32_dpp v5, v5, v5 quad_perm:[2,3,0,1] row_mask:0xf bank_mask:0xf
  v_sub_f32 v124, v124, v5
  v_mul_f32 v124, s83, v124
  v_exp_f32 v124, v124
  s_nop 0
  v_mul_f32 v125, v125, v124
  s_nop 1
  v_add_f32_dpp v125, v125, v125 quad_perm:[1,0,3,2] row_mask:0xf bank_mask:0xf
  s_nop 1
  v_add_f32_dpp v125, v125, v125 quad_perm:[2,3,0,1] row_mask:0xf bank_mask:0xf
  v_mov_b32 v124, v5
  v_rcp_f32 v6, v125
  s_nop 0
  v_fma_f32 v5, -v125, v6, 1.0
  v_fma_f32 v125, v5, v6, v6
  v_mov_b32 v6, 0
  s_mov_b64 exec, 1
  ds_write_b64 v6, v[124:125] offset:48520
  s_mov_b64 exec, -1
L_gs1:
  s_mov_b32 s15, 0
L_V1:
  s_cmp_eq_u32 s59, 0
  s_cbranch_scc0 L_V1_w0
  s_waitcnt vmcnt(41)
  v_readfirstlane_b32 s64, v122
  s_nop 3
  s_mul_i32 s65, s64, 43
  s_lshr_b32 s65, s65, 8
  s_mul_i32 s68, s65, 6
  s_sub_u32 s68, s64, s68
  s_lshl_b32 s65, s65, 3
  s_add_u32 s65, s65, s68
  s_add_u32 s65, s65, 2
  s_cmp_lt_u32 s64, 24
  s_cselect_b32 s65, s65, 32
  v_mov_b32 v5, s65
  v_mov_b32 v6, 0
  s_mov_b64 exec, 1
  ds_write_b32 v6, v5 offset:48576
  s_mov_b64 exec, -1
  v_mov_b32 v122, 1
  v_mov_b32 v6, 0
  s_mov_b64 exec, 1
  buffer_atomic_add v122, v6, s[48:51], s11 offen sc0 sc1
  s_mov_b64 exec, -1
L_V1_w0:
  s_waitcnt lgkmcnt(0)
  s_barrier
  s_cmp_ge_u32 s12, 32
  s_cbranch_scc1 L_V1_done
  v_mov_b32 v6, 0
  ds_read_b32 v5, v6 offset:48576
  s_cmp_eq_u32 s15, 0
  s_cbranch_scc0 L_V1_ng0
  ds_read_b64 v[30:31], v6 offset:48520
L_V1_ng0:
  s_waitcnt vmcnt(36) lgkmcnt(0)
  v_readfirstlane_b32 s14, v5
  v_sub_f32 v32, v64, v30
  v_sub_f32 v33, v65, v30
  v_sub_f32 v34, v66, v30
  v_sub_f32 v35, v67, v30
  v_sub_f32 v36, v68, v30
  v_sub_f32 v37, v69, v30
  v_sub_f32 v38, v70, v30
  v_sub_f32 v39, v71, v30
  v_sub_f32 v40, v72, v30
  v_sub_f32 v41, v73, v30
  v_sub_f32 v42, v74, v30
  v_sub_f32 v43, v75, v30
  v_sub_f32 v44, v76, v30
  v_sub_f32 v45, v77, v30
  v_sub_f32 v46, v78, v30
  v_sub_f32 v47, v79, v30
  v_mul_f32 v32, s83, v32
  v_mul_f32 v33, s83, v33
  v_mul_f32 v34, s83, v34
  v_mul_f32 v35, s83, v35
  v_mul_f32 v36, s83, v36
  v_mul_f32 v37, s83, v37
  v_mul_f32 v38, s83, v38
  v_mul_f32 v39, s83, v39
  v_mul_f32 v40, s83, v40
  v_mul_f32 v41, s83, v41
  v_mul_f32 v42, s83, v42
  v_mul_f32 v43, s83, v43
  v_mul_f32 v44, s83, v44
  v_mul_f32 v45, s83, v45
  v_mul_f32 v46, s83, v46
  v_mul_f32 v47, s83, v47
  v_exp_f32 v32, v32
  v_exp_f32 v33, v33
  v_exp_f32 v34, v34
  v_exp_f32 v35, v35
  v_exp_f32 v36, v36
  v_exp_f32 v37, v37
  v_exp_f32 v38, v38
  v_exp_f32 v39, v39
  v_exp_f32 v40, v40
  v_exp_f32 v41, v41
  v_exp_f32 v42, v42
  v_exp_f32 v43, v43
  v_exp_f32 v44, v44
  v_exp_f32 v45, v45
  v_exp_f32 v46, v46
  v_exp_f32 v47, v47
  v_mov_b32 v6, 0
  v_mul_f32 v32, v32, v31
  v_mul_f32 v33, v33, v31
  v_mul_f32 v34, v34, v31
  v_mul_f32 v35, v35, v31
  v_mul_f32 v36, v36, v31
  v_mul_f32 v37, v37, v31
  v_mul_f32 v38, v38, v31
  v_mul_f32 v39, v39, v31
  v_mul_f32 v40, v40, v31
  v_mul_f32 v41, v41, v31
  v_mul_f32 v42, v42, v31
  v_mul_f32 v43, v43, v31
  v_mul_f32 v44, v44, v31
  v_mul_f32 v45, v45, v31
  v_mul_f32 v46, v46, v31
  v_mul_f32 v47, v47, v31
  v_cvt_pk_bf16_f32 v32, v32, v6
  v_cvt_pk_bf16_f32 v33, v33, v6
  v_cvt_pk_bf16_f32 v34, v34, v6
  v_cvt_pk_bf16_f32 v35, v35, v6
  v_cvt_pk_bf16_f32 v36, v36, v6
  v_cvt_pk_bf16_f32 v37, v37, v6
  v_cvt_pk_bf16_f32 v38, v38, v6
  v_cvt_pk_bf16_f32 v39, v39, v6
  v_cvt_pk_bf16_f32 v40, v40, v6
  v_cvt_pk_bf16_f32 v41, v41, v6
  v_cvt_pk_bf16_f32 v42, v42, v6
  v_cvt_pk_bf16_f32 v43, v43, v6
  v_cvt_pk_bf16_f32 v44, v44, v6
  v_cvt_pk_bf16_f32 v45, v45, v6
  v_cvt_pk_bf16_f32 v46, v46, v6
  v_cvt_pk_bf16_f32 v47, v47, v6
  s_lshr_b32 s64, s14, 3
  s_lshl_b32 s64, s64, 13
  s_and_b32 s65, s14, 7
  s_lshl_b32 s65, s65, 6
  s_add_u32 s64, s64, s65
  s_add_u32 s64, s64, s9
  buffer_load_dwordx4 v[64:67], v29, s[48:51], s64 offen offset:0 sc0 sc1
  buffer_load_dwordx4 v[68:71], v29, s[48:51], s64 offen offset:16 sc0 sc1
  buffer_load_dwordx4 v[72:75], v29, s[48:51], s64 offen offset:32 sc0 sc1
  buffer_load_dwordx4 v[76:79], v29, s[48:51], s64 offen offset:48 sc0 sc1
  s_mul_i32 s62, s14, 98304
  s_add_u32 s62, s62, s8
  s_cmp_lt_u32 s14, 32
  s_cselect_b32 s54, 402653184, 0
  s_waitcnt vmcnt(31)
  v_lshlrev_b32 v26, 16, v32
  v_dot2c_f32_bf16 v20, v128, v32
  v_dot2c_f32_bf16 v22, v129, v32
  v_dot2c_f32_bf16 v24, v130, v32
  v_dot2c_f32_bf16 v21, v128, v26
  v_dot2c_f32_bf16 v23, v129, v26
  v_dot2c_f32_bf16 v25, v130, v26
  buffer_load_dwordx3 v[128:130], v2, s[52:55], s62 offen nt
  s_add_u32 s62, s62, 6144
  s_waitcnt vmcnt(31)
  v_lshlrev_b32 v27, 16, v33
  v_dot2c_f32_bf16 v20, v132, v33
  v_dot2c_f32_bf16 v22, v133, v33
  v_dot2c_f32_bf16 v24, v134, v33
  v_dot2c_f32_bf16 v21, v132, v27
  v_dot2c_f32_bf16 v23, v133, v27
  v_dot2c_f32_bf16 v25, v134, v27
  buffer_load_dwordx3 v[132:134], v2, s[52:55], s62 offen nt
  s_add_u32 s62, s62, 6144
  s_waitcnt vmcnt(31)
  v_lshlrev_b32 v26, 16, v34
  v_dot2c_f32_bf16 v20, v136, v34
  v_dot2c_f32_bf16 v22, v137, v34
  v_dot2c_f32_bf16 v24, v138, v34
  v_dot2c_f32_bf16 v21, v136, v26
  v_dot2c_f32_bf16 v23, v137, v26
  v_dot2c_f32_bf16 v25, v138, v26
  buffer_load_dwordx3 v[136:138], v2, s[52:55], s62 offen nt
  s_add_u32 s62, s62, 6144
  s_waitcnt vmcnt(31)
  v_lshlrev_b32 v27, 16, v35
  v_dot2c_f32_bf16 v20, v140, v35
  v_dot2c_f32_bf16 v22, v141, v35
  v_dot2c_f32_bf16 v24, v142, v35
  v_dot2c_f32_bf16 v21, v140, v27
  v_dot2c_f32_bf16 v23, v141, v27
  v_dot2c_f32_bf16 v25, v142, v27
  buffer_load_dwordx3 v[140:142], v2, s[52:55], s62 offen nt
  s_add_u32 s62, s62, 6144
  s_waitcnt vmcnt(31)
  v_lshlrev_b32 v26, 16, v36
  v_dot2c_f32_bf16 v20, v144, v36
  v_dot2c_f32_bf16 v22, v145, v36
  v_dot2c_f32_bf16 v24, v146, v36
  v_dot2c_f32_bf16 v21, v144, v26
  v_dot2c_f32_bf16 v23, v145, v26
  v_dot2c_f32_bf16 v25, v146, v26
  buffer_load_dwordx3 v[144:146], v2, s[52:55], s62 offen nt
  s_add_u32 s62, s62, 6144
  s_waitcnt vmcnt(31)
  v_lshlrev_b32 v27, 16, v37
  v_dot2c_f32_bf16 v20, v148, v37
  v_dot2c_f32_bf16 v22, v149, v37
  v_dot2c_f32_bf16 v24, v150, v37
  v_dot2c_f32_bf16 v21, v148, v27
  v_dot2c_f32_bf16 v23, v149, v27
  v_dot2c_f32_bf16 v25, v150, v27
  buffer_load_dwordx3 v[148:150], v2, s[52:55], s62 offen nt
  s_add_u32 s62, s62, 6144
  s_waitcnt vmcnt(31)
  v_lshlrev_b32 v26, 16, v38
  v_dot2c_f32_bf16 v20, v152, v38
  v_dot2c_f32_bf16 v22, v153, v38
  v_dot2c_f32_bf16 v24, v154, v38
  v_dot2c_f32_bf16 v21, v152, v26
  v_dot2c_f32_bf16 v23, v153, v26
  v_dot2c_f32_bf16 v25, v154, v26
  buffer_load_dwordx3 v[152:154], v2, s[52:55], s62 offen nt
  s_add_u32 s62, s62, 6144
  s_waitcnt vmcnt(31)
  v_lshlrev_b32 v27, 16, v39
  v_dot2c_f32_bf16 v20, v156, v39
  v_dot2c_f32_bf16 v22, v157, v39
  v_dot2c_f32_bf16 v24, v158, v39
  v_dot2c_f32_bf16 v21, v156, v27
  v_dot2c_f32_bf16 v23, v157, v27
  v_dot2c_f32_bf16 v25, v158, v27
  buffer_load_dwordx3 v[156:158], v2, s[52:55], s62 offen nt
  s_add_u32 s62, s62, 6144
  s_waitcnt vmcnt(31)
  v_lshlrev_b32 v26, 16, v40
  v_dot2c_f32_bf16 v20, v160, v40
  v_dot2c_f32_bf16 v22, v161, v40
  v_dot2c_f32_bf16 v24, v162, v40
  v_dot2c_f32_bf16 v21, v160, v26
  v_dot2c_f32_bf16 v23, v161, v26
  v_dot2c_f32_bf16 v25, v162, v26
  buffer_load_dwordx3 v[160:162], v2, s[52:55], s62 offen nt
  s_add_u32 s62, s62, 6144
  s_waitcnt vmcnt(31)
  v_lshlrev_b32 v27, 16, v41
  v_dot2c_f32_bf16 v20, v164, v41
  v_dot2c_f32_bf16 v22, v165, v41
  v_dot2c_f32_bf16 v24, v166, v41
  v_dot2c_f32_bf16 v21, v164, v27
  v_dot2c_f32_bf16 v23, v165, v27
  v_dot2c_f32_bf16 v25, v166, v27
  buffer_load_dwordx3 v[164:166], v2, s[52:55], s62 offen nt
  s_add_u32 s62, s62, 6144
  s_waitcnt vmcnt(31)
  v_lshlrev_b32 v26, 16, v42
  v_dot2c_f32_bf16 v20, v168, v42
  v_dot2c_f32_bf16 v22, v169, v42
  v_dot2c_f32_bf16 v24, v170, v42
  v_dot2c_f32_bf16 v21, v168, v26
  v_dot2c_f32_bf16 v23, v169, v26
  v_dot2c_f32_bf16 v25, v170, v26
  buffer_load_dwordx3 v[168:170], v2, s[52:55], s62 offen nt
  s_add_u32 s62, s62, 6144
  s_waitcnt vmcnt(31)
  v_lshlrev_b32 v27, 16, v43
  v_dot2c_f32_bf16 v20, v172, v43
  v_dot2c_f32_bf16 v22, v173, v43
  v_dot2c_f32_bf16 v24, v174, v43
  v_dot2c_f32_bf16 v21, v172, v27
  v_dot2c_f32_bf16 v23, v173, v27
  v_dot2c_f32_bf16 v25, v174, v27
  buffer_load_dwordx3 v[172:174], v2, s[52:55], s62 offen nt
  s_add_u32 s62, s62, 6144
  s_waitcnt vmcnt(31)
  v_lshlrev_b32 v26, 16, v44
  v_dot2c_f32_bf16 v20, v176, v44
  v_dot2c_f32_bf16 v22, v177, v44
  v_dot2c_f32_bf16 v24, v178, v44
  v_dot2c_f32_bf16 v21, v176, v26
  v_dot2c_f32_bf16 v23, v177, v26
  v_dot2c_f32_bf16 v25, v178, v26
  buffer_load_dwordx3 v[176:178], v2, s[52:55], s62 offen nt
  s_add_u32 s62, s62, 6144
  s_waitcnt vmcnt(31)
  v_lshlrev_b32 v27, 16, v45
  v_dot2c_f32_bf16 v20, v180, v45
  v_dot2c_f32_bf16 v22, v181, v45
  v_dot2c_f32_bf16 v24, v182, v45
  v_dot2c_f32_bf16 v21, v180, v27
  v_dot2c_f32_bf16 v23, v181, v27
  v_dot2c_f32_bf16 v25, v182, v27
  buffer_load_dwordx3 v[180:182], v2, s[52:55], s62 offen nt
  s_add_u32 s62, s62, 6144
  s_waitcnt vmcnt(31)
  v_lshlrev_b32 v26, 16, v46
  v_dot2c_f32_bf16 v20, v184, v46
  v_dot2c_f32_bf16 v22, v185, v46
  v_dot2c_f32_bf16 v24, v186, v46
  v_dot2c_f32_bf16 v21, v184, v26
  v_dot2c_f32_bf16 v23, v185, v26
  v_dot2c_f32_bf16 v25, v186, v26
  buffer_load_dwordx3 v[184:186], v2, s[52:55], s62 offen nt
  s_add_u32 s62, s62, 6144
  s_waitcnt vmcnt(31)
  v_lshlrev_b32 v27, 16, v47
  v_dot2c_f32_bf16 v20, v188, v47
  v_dot2c_f32_bf16 v22, v189, v47
  v_dot2c_f32_bf16 v24, v190, v47
  v_dot2c_f32_bf16 v21, v188, v27
  v_dot2c_f32_bf16 v23, v189, v27
  v_dot2c_f32_bf16 v25, v190, v27
  buffer_load_dwordx3 v[188:190], v2, s[52:55], s62 offen nt
  s_add_u32 s62, s62, 6144
  s_mov_b32 s12, s13
  s_mov_b32 s13, s14
  s_add_u32 s15, s15, 1
  s_cmp_eq_u32 s59, 0
  s_cbranch_scc0 L_V1_w1
  s_waitcnt vmcnt(41)
  v_readfirstlane_b32 s64, v123
  s_nop 3
  s_mul_i32 s65, s64, 43
  s_lshr_b32 s65, s65, 8
  s_mul_i32 s68, s65, 6
  s_sub_u32 s68, s64, s68
  s_lshl_b32 s65, s65, 3
  s_add_u32 s65, s65, s68
  s_add_u32 s65, s65, 2
  s_cmp_lt_u32 s64, 24
  s_cselect_b32 s65, s65, 32
  v_mov_b32 v5, s65
  v_mov_b32 v6, 0
  s_mov_b64 exec, 1
  ds_write_b32 v6, v5 offset:48580
  s_mov_b64 exec, -1
  v_mov_b32 v123, 1
  v_mov_b32 v6, 0
  s_mov_b64 exec, 1
  buffer_atomic_add v123, v6, s[48:51], s11 offen sc0 sc1
  s_mov_b64 exec, -1
L_V1_w1:
  s_waitcnt lgkmcnt(0)
  s_barrier
  s_cmp_ge_u32 s12, 32
  s_cbranch_scc1 L_V1_done
  v_mov_b32 v6, 0
  ds_read_b32 v5, v6 offset:48580
  s_cmp_eq_u32 s15, 0
  s_cbranch_scc0 L_V1_ng1
  ds_read_b64 v[30:31], v6 offset:48520
L_V1_ng1:
  s_waitcnt vmcnt(36) lgkmcnt(0)
  v_readfirstlane_b32 s14, v5
  v_sub_f32 v32, v80, v30
  v_sub_f32 v33, v81, v30
  v_sub_f32 v34, v82, v30
  v_sub_f32 v35, v83, v30
  v_sub_f32 v36, v84, v30
  v_sub_f32 v37, v85, v30
  v_sub_f32 v38, v86, v30
  v_sub_f32 v39, v87, v30
  v_sub_f32 v40, v88, v30
  v_sub_f32 v41, v89, v30
  v_sub_f32 v42, v90, v30
  v_sub_f32 v43, v91, v30
  v_sub_f32 v44, v92, v30
  v_sub_f32 v45, v93, v30
  v_sub_f32 v46, v94, v30
  v_sub_f32 v47, v95, v30
  v_mul_f32 v32, s83, v32
  v_mul_f32 v33, s83, v33
  v_mul_f32 v34, s83, v34
  v_mul_f32 v35, s83, v35
  v_mul_f32 v36, s83, v36
  v_mul_f32 v37, s83, v37
  v_mul_f32 v38, s83, v38
  v_mul_f32 v39, s83, v39
  v_mul_f32 v40, s83, v40
  v_mul_f32 v41, s83, v41
  v_mul_f32 v42, s83, v42
  v_mul_f32 v43, s83, v43
  v_mul_f32 v44, s83, v44
  v_mul_f32 v45, s83, v45
  v_mul_f32 v46, s83, v46
  v_mul_f32 v47, s83, v47
  v_exp_f32 v32, v32
  v_exp_f32 v33, v33
  v_exp_f32 v34, v34
  v_exp_f32 v35, v35
  v_exp_f32 v36, v36
  v_exp_f32 v37, v37
  v_exp_f32 v38, v38
  v_exp_f32 v39, v39
  v_exp_f32 v40, v40
  v_exp_f32 v41, v41
  v_exp_f32 v42, v42
  v_exp_f32 v43, v43
  v_exp_f32 v44, v44
  v_exp_f32 v45, v45
  v_exp_f32 v46, v46
  v_exp_f32 v47, v47
  v_mov_b32 v6, 0
  v_mul_f32 v32, v32, v31
  v_mul_f32 v33, v33, v31
  v_mul_f32 v34, v34, v31
  v_mul_f32 v35, v35, v31
  v_mul_f32 v36, v36, v31
  v_mul_f32 v37, v37, v31
  v_mul_f32 v38, v38, v31
  v_mul_f32 v39, v39, v31
  v_mul_f32 v40, v40, v31
  v_mul_f32 v41, v41, v31
  v_mul_f32 v42, v42, v31
  v_mul_f32 v43, v43, v31
  v_mul_f32 v44, v44, v31
  v_mul_f32 v45, v45, v31
  v_mul_f32 v46, v46, v31
  v_mul_f32 v47, v47, v31
  v_cvt_pk_bf16_f32 v32, v32, v6
  v_cvt_pk_bf16_f32 v33, v33, v6
  v_cvt_pk_bf16_f32 v34, v34, v6
  v_cvt_pk_bf16_f32 v35, v35, v6
  v_cvt_pk_bf16_f32 v36, v36, v6
  v_cvt_pk_bf16_f32 v37, v37, v6
  v_cvt_pk_bf16_f32 v38, v38, v6
  v_cvt_pk_bf16_f32 v39, v39, v6
  v_cvt_pk_bf16_f32 v40, v40, v6
  v_cvt_pk_bf16_f32 v41, v41, v6
  v_cvt_pk_bf16_f32 v42, v42, v6
  v_cvt_pk_bf16_f32 v43, v43, v6
  v_cvt_pk_bf16_f32 v44, v44, v6
  v_cvt_pk_bf16_f32 v45, v45, v6
  v_cvt_pk_bf16_f32 v46, v46, v6
  v_cvt_pk_bf16_f32 v47, v47, v6
  s_lshr_b32 s64, s14, 3
  s_lshl_b32 s64, s64, 13
  s_and_b32 s65, s14, 7
  s_lshl_b32 s65, s65, 6
  s_add_u32 s64, s64, s65
  s_add_u32 s64, s64, s9
  buffer_load_dwordx4 v[80:83], v29, s[48:51], s64 offen offset:0 sc0 sc1
  buffer_load_dwordx4 v[84:87], v29, s[48:51], s64 offen offset:16 sc0 sc1
  buffer_load_dwordx4 v[88:91], v29, s[48:51], s64 offen offset:32 sc0 sc1
  buffer_load_dwordx4 v[92:95], v29, s[48:51], s64 offen offset:48 sc0 sc1
  s_mul_i32 s62, s14, 98304
  s_add_u32 s62, s62, s8
  s_cmp_lt_u32 s14, 32
  s_cselect_b32 s54, 402653184, 0
  s_waitcnt vmcnt(31)
  v_lshlrev_b32 v26, 16, v32
  v_dot2c_f32_bf16 v20, v192, v32
  v_dot2c_f32_bf16 v22, v193, v32
  v_dot2c_f32_bf16 v24, v194, v32
  v_dot2c_f32_bf16 v21, v192, v26
  v_dot2c_f32_bf16 v23, v193, v26
  v_dot2c_f32_bf16 v25, v194, v26
  buffer_load_dwordx3 v[192:194], v2, s[52:55], s62 offen nt
  s_add_u32 s62, s62, 6144
  s_waitcnt vmcnt(31)
  v_lshlrev_b32 v27, 16, v33
  v_dot2c_f32_bf16 v20, v196, v33
  v_dot2c_f32_bf16 v22, v197, v33
  v_dot2c_f32_bf16 v24, v198, v33
  v_dot2c_f32_bf16 v21, v196, v27
  v_dot2c_f32_bf16 v23, v197, v27
  v_dot2c_f32_bf16 v25, v198, v27
  buffer_load_dwordx3 v[196:198], v2, s[52:55], s62 offen nt
  s_add_u32 s62, s62, 6144
  s_waitcnt vmcnt(31)
  v_lshlrev_b32 v26, 16, v34
  v_dot2c_f32_bf16 v20, v200, v34
  v_dot2c_f32_bf16 v22, v201, v34
  v_dot2c_f32_bf16 v24, v202, v34
  v_dot2c_f32_bf16 v21, v200, v26
  v_dot2c_f32_bf16 v23, v201, v26
  v_dot2c_f32_bf16 v25, v202, v26
  buffer_load_dwordx3 v[200:202], v2, s[52:55], s62 offen nt
  s_add_u32 s62, s62, 6144
  s_waitcnt vmcnt(31)
  v_lshlrev_b32 v27, 16, v35
  v_dot2c_f32_bf16 v20, v204, v35
  v_dot2c_f32_bf16 v22, v205, v35
  v_dot2c_f32_bf16 v24, v206, v35
  v_dot2c_f32_bf16 v21, v204, v27
  v_dot2c_f32_bf16 v23, v205, v27
  v_dot2c_f32_bf16 v25, v206, v27
  buffer_load_dwordx3 v[204:206], v2, s[52:55], s62 offen nt
  s_add_u32 s62, s62, 6144
  s_waitcnt vmcnt(31)
  v_lshlrev_b32 v26, 16, v36
  v_dot2c_f32_bf16 v20, v208, v36
  v_dot2c_f32_bf16 v22, v209, v36
  v_dot2c_f32_bf16 v24, v210, v36
  v_dot2c_f32_bf16 v21, v208, v26
  v_dot2c_f32_bf16 v23, v209, v26
  v_dot2c_f32_bf16 v25, v210, v26
  buffer_load_dwordx3 v[208:210], v2, s[52:55], s62 offen nt
  s_add_u32 s62, s62, 6144
  s_waitcnt vmcnt(31)
  v_lshlrev_b32 v27, 16, v37
  v_dot2c_f32_bf16 v20, v212, v37
  v_dot2c_f32_bf16 v22, v213, v37
  v_dot2c_f32_bf16 v24, v214, v37
  v_dot2c_f32_bf16 v21, v212, v27
  v_dot2c_f32_bf16 v23, v213, v27
  v_dot2c_f32_bf16 v25, v214, v27
  buffer_load_dwordx3 v[212:214], v2, s[52:55], s62 offen nt
  s_add_u32 s62, s62, 6144
  s_waitcnt vmcnt(31)
  v_lshlrev_b32 v26, 16, v38
  v_dot2c_f32_bf16 v20, v216, v38
  v_dot2c_f32_bf16 v22, v217, v38
  v_dot2c_f32_bf16 v24, v218, v38
  v_dot2c_f32_bf16 v21, v216, v26
  v_dot2c_f32_bf16 v23, v217, v26
  v_dot2c_f32_bf16 v25, v218, v26
  buffer_load_dwordx3 v[216:218], v2, s[52:55], s62 offen nt
  s_add_u32 s62, s62, 6144
  s_waitcnt vmcnt(31)
  v_lshlrev_b32 v27, 16, v39
  v_dot2c_f32_bf16 v20, v220, v39
  v_dot2c_f32_bf16 v22, v221, v39
  v_dot2c_f32_bf16 v24, v222, v39
  v_dot2c_f32_bf16 v21, v220, v27
  v_dot2c_f32_bf16 v23, v221, v27
  v_dot2c_f32_bf16 v25, v222, v27
  buffer_load_dwordx3 v[220:222], v2, s[52:55], s62 offen nt
  s_add_u32 s62, s62, 6144
  s_waitcnt vmcnt(31)
  v_lshlrev_b32 v26, 16, v40
  v_dot2c_f32_bf16 v20, v224, v40
  v_dot2c_f32_bf16 v22, v225, v40
  v_dot2c_f32_bf16 v24, v226, v40
  v_dot2c_f32_bf16 v21, v224, v26
  v_dot2c_f32_bf16 v23, v225, v26
  v_dot2c_f32_bf16 v25, v226, v26
  buffer_load_dwordx3 v[224:226], v2, s[52:55], s62 offen nt
  s_add_u32 s62, s62, 6144
  s_waitcnt vmcnt(31)
  v_lshlrev_b32 v27, 16, v41
  v_dot2c_f32_bf16 v20, v228, v41
  v_dot2c_f32_bf16 v22, v229, v41
  v_dot2c_f32_bf16 v24, v230, v41
  v_dot2c_f32_bf16 v21, v228, v27
  v_dot2c_f32_bf16 v23, v229, v27
  v_dot2c_f32_bf16 v25, v230, v27
  buffer_load_dwordx3 v[228:230], v2, s[52:55], s62 offen nt
  s_add_u32 s62, s62, 6144
  s_waitcnt vmcnt(31)
  v_lshlrev_b32 v26, 16, v42
  v_dot2c_f32_bf16 v20, v232, v42
  v_dot2c_f32_bf16 v22, v233, v42
  v_dot2c_f32_bf16 v24, v234, v42
  v_dot2c_f32_bf16 v21, v232, v26
  v_dot2c_f32_bf16 v23, v233, v26
  v_dot2c_f32_bf16 v25, v234, v26
  buffer_load_dwordx3 v[232:234], v2, s[52:55], s62 offen nt
  s_add_u32 s62, s62, 6144
  s_waitcnt vmcnt(31)
  v_lshlrev_b32 v27, 16, v43
  v_dot2c_f32_bf16 v20, v236, v43
  v_dot2c_f32_bf16 v22, v237, v43
  v_dot2c_f32_bf16 v24, v238, v43
  v_dot2c_f32_bf16 v21, v236, v27
  v_dot2c_f32_bf16 v23, v237, v27
  v_dot2c_f32_bf16 v25, v238, v27
  buffer_load_dwordx3 v[236:238], v2, s[52:55], s62 offen nt
  s_add_u32 s62, s62, 6144
  s_waitcnt vmcnt(31)
  v_lshlrev_b32 v26, 16, v44
  v_dot2c_f32_bf16 v20, v240, v44
  v_dot2c_f32_bf16 v22, v241, v44
  v_dot2c_f32_bf16 v24, v242, v44
  v_dot2c_f32_bf16 v21, v240, v26
  v_dot2c_f32_bf16 v23, v241, v26
  v_dot2c_f32_bf16 v25, v242, v26
  buffer_load_dwordx3 v[240:242], v2, s[52:55], s62 offen nt
  s_add_u32 s62, s62, 6144
  s_waitcnt vmcnt(31)
  v_lshlrev_b32 v27, 16, v45
  v_dot2c_f32_bf16 v20, v244, v45
  v_dot2c_f32_bf16 v22, v245, v45
  v_dot2c_f32_bf16 v24, v246, v45
  v_dot2c_f32_bf16 v21, v244, v27
  v_dot2c_f32_bf16 v23, v245, v27
  v_dot2c_f32_bf16 v25, v246, v27
  buffer_load_dwordx3 v[244:246], v2, s[52:55], s62 offen nt
  s_add_u32 s62, s62, 6144
  s_waitcnt vmcnt(31)
  v_lshlrev_b32 v26, 16, v46
  v_dot2c_f32_bf16 v20, v248, v46
  v_dot2c_f32_bf16 v22, v249, v46
  v_dot2c_f32_bf16 v24, v250, v46
  v_dot2c_f32_bf16 v21, v248, v26
  v_dot2c_f32_bf16 v23, v249, v26
  v_dot2c_f32_bf16 v25, v250, v26
  buffer_load_dwordx3 v[248:250], v2, s[52:55], s62 offen nt
  s_add_u32 s62, s62, 6144
  s_waitcnt vmcnt(31)
  v_lshlrev_b32 v27, 16, v47
  v_dot2c_f32_bf16 v20, v252, v47
  v_dot2c_f32_bf16 v22, v253, v47
  v_dot2c_f32_bf16 v24, v254, v47
  v_dot2c_f32_bf16 v21, v252, v27
  v_dot2c_f32_bf16 v23, v253, v27
  v_dot2c_f32_bf16 v25, v254, v27
  buffer_load_dwordx3 v[252:254], v2, s[52:55], s62 offen nt
  s_add_u32 s62, s62, 6144
  s_mov_b32 s12, s13
  s_mov_b32 s13, s14
  s_add_u32 s15, s15, 1
  s_branch L_V1
L_V1_done:
  s_waitcnt vmcnt(0)
  s_mul_i32 s64, s56, 192
  s_mul_i32 s68, s59, 24
  s_add_u32 s64, s64, s68
  s_mul_i32 s64, s64, 1280
  v_lshlrev_b32 v5, 4, v1
  v_lshlrev_b32 v6, 2, v1
  buffer_load_dwordx4 v[32:35], v5, s[40:43], s64 offen
  buffer_load_dword v128, v6, s[40:43], s64 offen offset:1024
  s_add_u32 s64, s64, 1280
  buffer_load_dwordx4 v[36:39], v5, s[40:43], s64 offen
  buffer_load_dword v129, v6, s[40:43], s64 offen offset:1024
  s_add_u32 s64, s64, 1280
  buffer_load_dwordx4 v[40:43], v5, s[40:43], s64 offen
  buffer_load_dword v130, v6, s[40:43], s64 offen offset:1024
  s_add_u32 s64, s64, 1280
  buffer_load_dwordx4 v[44:47], v5, s[40:43], s64 offen
  buffer_load_dword v131, v6, s[40:43], s64 offen offset:1024
  s_add_u32 s64, s64, 1280
  buffer_load_dwordx4 v[48:51], v5, s[40:43], s64 offen
  buffer_load_dword v132, v6, s[40:43], s64 offen offset:1024
  s_add_u32 s64, s64, 1280
  buffer_load_dwordx4 v[52:55], v5, s[40:43], s64 offen
  buffer_load_dword v133, v6, s[40:43], s64 offen offset:1024
  s_add_u32 s64, s64, 1280
  buffer_load_dwordx4 v[56:59], v5, s[40:43], s64 offen
  buffer_load_dword v134, v6, s[40:43], s64 offen offset:1024
  s_add_u32 s64, s64, 1280
  buffer_load_dwordx4 v[60:63], v5, s[40:43], s64 offen
  buffer_load_dword v135, v6, s[40:43], s64 offen offset:1024
  s_add_u32 s64, s64, 1280
  buffer_load_dwordx4 v[64:67], v5, s[40:43], s64 offen
  buffer_load_dword v136, v6, s[40:43], s64 offen offset:1024
  s_add_u32 s64, s64, 1280
  buffer_load_dwordx4 v[68:71], v5, s[40:43], s64 offen
  buffer_load_dword v137, v6, s[40:43], s64 offen offset:1024
  s_add_u32 s64, s64, 1280
  buffer_load_dwordx4 v[72:75], v5, s[40:43], s64 offen
  buffer_load_dword v138, v6, s[40:43], s64 offen offset:1024
  s_add_u32 s64, s64, 1280
  buffer_load_dwordx4 v[76:79], v5, s[40:43], s64 offen
  buffer_load_dword v139, v6, s[40:43], s64 offen offset:1024
  s_add_u32 s64, s64, 1280
  buffer_load_dwordx4 v[80:83], v5, s[40:43], s64 offen
  buffer_load_dword v140, v6, s[40:43], s64 offen offset:1024
  s_add_u32 s64, s64, 1280
  buffer_load_dwordx4 v[84:87], v5, s[40:43], s64 offen
  buffer_load_dword v141, v6, s[40:43], s64 offen offset:1024
  s_add_u32 s64, s64, 1280
  buffer_load_dwordx4 v[88:91], v5, s[40:43], s64 offen
  buffer_load_dword v142, v6, s[40:43], s64 offen offset:1024
  s_add_u32 s64, s64, 1280
  buffer_load_dwordx4 v[92:95], v5, s[40:43], s64 offen
  buffer_load_dword v143, v6, s[40:43], s64 offen offset:1024
  s_add_u32 s64, s64, 1280
  buffer_load_dwordx4 v[96:99], v5, s[40:43], s64 offen
  buffer_load_dword v144, v6, s[40:43], s64 offen offset:1024
  s_add_u32 s64, s64, 1280
  buffer_load_dwordx4 v[100:103], v5, s[40:43], s64 offen
  buffer_load_dword v145, v6, s[40:43], s64 offen offset:1024
  s_add_u32 s64, s64, 1280
  buffer_load_dwordx4 v[104:107], v5, s[40:43], s64 offen
  buffer_load_dword v146, v6, s[40:43], s64 offen offset:1024
  s_add_u32 s64, s64, 1280
  buffer_load_dwordx4 v[108:111], v5, s[40:43], s64 offen
  buffer_load_dword v147, v6, s[40:43], s64 offen offset:1024
  s_add_u32 s64, s64, 1280
  buffer_load_dwordx4 v[112:115], v5, s[40:43], s64 offen
  buffer_load_dword v148, v6, s[40:43], s64 offen offset:1024
  s_add_u32 s64, s64, 1280
  buffer_load_dwordx4 v[116:119], v5, s[40:43], s64 offen
  buffer_load_dword v149, v6, s[40:43], s64 offen offset:1024
  s_add_u32 s64, s64, 1280
  buffer_load_dwordx4 v[120:123], v5, s[40:43], s64 offen
  buffer_load_dword v150, v6, s[40:43], s64 offen offset:1024
  s_add_u32 s64, s64, 1280
  buffer_load_dwordx4 v[124:127], v5, s[40:43], s64 offen
  buffer_load_dword v151, v6, s[40:43], s64 offen offset:1024
  s_add_u32 s64, s64, 1280
  v_lshrrev_b32 v5, 5, v1
  s_lshl_b32 s64, s59, 1
  v_add_u32 v5, s64, v5
  v_mul_u32_u24 v5, 768, v5
  v_and_b32 v6, 31, v1
  v_mul_u32_u24 v6, 24, v6
  v_add_u32 v5, v5, v6
  ds_write_b64 v5, v[14:15] offset:21504
  ds_write_b64 v5, v[16:17] offset:21512
  ds_write_b64 v5, v[18:19] offset:21520
  ds_write_b64 v5, v[20:21] offset:33792
  ds_write_b64 v5, v[22:23] offset:33800
  ds_write_b64 v5, v[24:25] offset:33808
  s_waitcnt lgkmcnt(0)
  s_barrier
  v_cmp_gt_u32 vcc, 384, v0
  s_and_saveexec_b64 s[64:65], vcc
  s_cbranch_execz L_cw_o
  v_cmp_le_u32 vcc, 192, v0
  v_mov_b32 v6, 0
  v_mov_b32 v5, 11520
  s_nop 0
  v_cndmask_b32 v6, v6, v5, vcc
  v_lshlrev_b32 v5, 2, v0
  v_add_u32 v5, v5, v6
  ds_read_b32 v240, v5 offset:21504
  ds_read_b32 v241, v5 offset:22272
  ds_read_b32 v242, v5 offset:23040
  ds_read_b32 v243, v5 offset:23808
  ds_read_b32 v244, v5 offset:24576
  ds_read_b32 v245, v5 offset:25344
  ds_read_b32 v246, v5 offset:26112
  ds_read_b32 v247, v5 offset:26880
  ds_read_b32 v248, v5 offset:27648
  ds_read_b32 v249, v5 offset:28416
  ds_read_b32 v250, v5 offset:29184
  ds_read_b32 v251, v5 offset:29952
  ds_read_b32 v252, v5 offset:30720
  ds_read_b32 v253, v5 offset:31488
  ds_read_b32 v254, v5 offset:32256
  ds_read_b32 v255, v5 offset:33024
  s_waitcnt lgkmcnt(0)
  v_add_f32 v240, v240, v248
  v_add_f32 v241, v241, v249
  v_add_f32 v242, v242, v250
  v_add_f32 v243, v243, v251
  v_add_f32 v244, v244, v252
  v_add_f32 v245, v245, v253
  v_add_f32 v246, v246, v254
  v_add_f32 v247, v247, v255
  v_add_f32 v240, v240, v244
  v_add_f32 v241, v241, v245
  v_add_f32 v242, v242, v246
  v_add_f32 v243, v243, v247
  v_add_f32 v240, v240, v242
  v_add_f32 v241, v241, v243
  v_add_f32 v240, v240, v241
  v_lshlrev_b32 v5, 3, v0
  v_mov_b32 v6, 0
  v_mov_b32 v241, 1532
  v_cndmask_b32 v6, v6, v241, vcc
  v_sub_u32 v5, v5, v6
  ds_write_b32 v5, v240 offset:46848
L_cw_o:
  s_mov_b64 exec, -1
  s_waitcnt lgkmcnt(0)
  s_barrier
  s_mul_i32 s64, s59, 192
  v_mov_b32 v7, s64
  ds_read_b128 v[176:179], v7 offset:46848
  ds_read_b128 v[180:183], v7 offset:46864
  ds_read_b128 v[184:187], v7 offset:46880
  ds_read_b128 v[188:191], v7 offset:46896
  ds_read_b128 v[192:195], v7 offset:46912
  ds_read_b128 v[196:199], v7 offset:46928
  ds_read_b128 v[200:203], v7 offset:46944
  ds_read_b128 v[204:207], v7 offset:46960
  ds_read_b128 v[208:211], v7 offset:46976
  ds_read_b128 v[212:215], v7 offset:46992
  ds_read_b128 v[216:219], v7 offset:47008
  ds_read_b128 v[220:223], v7 offset:47024
  v_mov_b32 v224, 0
  v_mov_b32 v225, 0
  v_mov_b32 v226, 0
  v_mov_b32 v227, 0
  v_mov_b32 v228, 0
  v_mov_b32 v229, 0
  v_mov_b32 v230, 0
  v_mov_b32 v231, 0
  v_mov_b32 v232, 0
  v_mov_b32 v233, 0
  v_mov_b32 v234, 0
  v_mov_b32 v235, 0
  v_mov_b32 v236, 0
  v_mov_b32 v237, 0
  v_mov_b32 v238, 0
  v_mov_b32 v239, 0
  v_mov_b32 v240, 0
  v_mov_b32 v241, 0
  v_mov_b32 v242, 0
  v_mov_b32 v243, 0
  s_waitcnt vmcnt(0) lgkmcnt(0)
  v_lshlrev_b32 v5, 16, v32
  v_and_b32 v6, 0xffff0000, v32
  v_fmac_f32 v224, v5, v176
  v_fmac_f32 v225, v6, v176
  v_fmac_f32 v234, v5, v177
  v_fmac_f32 v235, v6, v177
  v_lshlrev_b32 v5, 16, v33
  v_and_b32 v6, 0xffff0000, v33
  v_fmac_f32 v226, v5, v176
  v_fmac_f32 v227, v6, v176
  v_fmac_f32 v236, v5, v177
  v_fmac_f32 v237, v6, v177
  v_lshlrev_b32 v5, 16, v34
  v_and_b32 v6, 0xffff0000, v34
  v_fmac_f32 v228, v5, v176
  v_fmac_f32 v229, v6, v176
  v_fmac_f32 v238, v5, v177
  v_fmac_f32 v239, v6, v177
  v_lshlrev_b32 v5, 16, v35
  v_and_b32 v6, 0xffff0000, v35
  v_fmac_f32 v230, v5, v176
  v_fmac_f32 v231, v6, v176
  v_fmac_f32 v240, v5, v177
  v_fmac_f32 v241, v6, v177
  v_lshlrev_b32 v5, 16, v128
  v_and_b32 v6, 0xffff0000, v128
  v_fmac_f32 v232, v5, v176
  v_fmac_f32 v233, v6, v176
  v_fmac_f32 v242, v5, v177
  v_fmac_f32 v243, v6, v177
  v_lshlrev_b32 v5, 16, v36
  v_and_b32 v6, 0xffff0000, v36
  v_fmac_f32 v224, v5, v178
  v_fmac_f32 v225, v6, v178
  v_fmac_f32 v234, v5, v179
  v_fmac_f32 v235, v6, v179
  v_lshlrev_b32 v5, 16, v37
  v_and_b32 v6, 0xffff0000, v37
  v_fmac_f32 v226, v5, v178
  v_fmac_f32 v227, v6, v178
  v_fmac_f32 v236, v5, v179
  v_fmac_f32 v237, v6, v179
  v_lshlrev_b32 v5, 16, v38
  v_and_b32 v6, 0xffff0000, v38
  v_fmac_f32 v228, v5, v178
  v_fmac_f32 v229, v6, v178
  v_fmac_f32 v238, v5, v179
  v_fmac_f32 v239, v6, v179
  v_lshlrev_b32 v5, 16, v39
  v_and_b32 v6, 0xffff0000, v39
  v_fmac_f32 v230, v5, v178
  v_fmac_f32 v231, v6, v178
  v_fmac_f32 v240, v5, v179
  v_fmac_f32 v241, v6, v179
  v_lshlrev_b32 v5, 16, v129
  v_and_b32 v6, 0xffff0000, v129
  v_fmac_f32 v232, v5, v178
  v_fmac_f32 v233, v6, v178
  v_fmac_f32 v242, v5, v179
  v_fmac_f32 v243, v6, v179
  v_lshlrev_b32 v5, 16, v40
  v_and_b32 v6, 0xffff0000, v40
  v_fmac_f32 v224, v5, v180
  v_fmac_f32 v225, v6, v180
  v_fmac_f32 v234, v5, v181
  v_fmac_f32 v235, v6, v181
  v_lshlrev_b32 v5, 16, v41
  v_and_b32 v6, 0xffff0000, v41
  v_fmac_f32 v226, v5, v180
  v_fmac_f32 v227, v6, v180
  v_fmac_f32 v236, v5, v181
  v_fmac_f32 v237, v6, v181
  v_lshlrev_b32 v5, 16, v42
  v_and_b32 v6, 0xffff0000, v42
  v_fmac_f32 v228, v5, v180
  v_fmac_f32 v229, v6, v180
  v_fmac_f32 v238, v5, v181
  v_fmac_f32 v239, v6, v181
  v_lshlrev_b32 v5, 16, v43
  v_and_b32 v6, 0xffff0000, v43
  v_fmac_f32 v230, v5, v180
  v_fmac_f32 v231, v6, v180
  v_fmac_f32 v240, v5, v181
  v_fmac_f32 v241, v6, v181
  v_lshlrev_b32 v5, 16, v130
  v_and_b32 v6, 0xffff0000, v130
  v_fmac_f32 v232, v5, v180
  v_fmac_f32 v233, v6, v180
  v_fmac_f32 v242, v5, v181
  v_fmac_f32 v243, v6, v181
  v_lshlrev_b32 v5, 16, v44
  v_and_b32 v6, 0xffff0000, v44
  v_fmac_f32 v224, v5, v182
  v_fmac_f32 v225, v6, v182
  v_fmac_f32 v234, v5, v183
  v_fmac_f32 v235, v6, v183
  v_lshlrev_b32 v5, 16, v45
  v_and_b32 v6, 0xffff0000, v45
  v_fmac_f32 v226, v5, v182
  v_fmac_f32 v227, v6, v182
  v_fmac_f32 v236, v5, v183
  v_fmac_f32 v237, v6, v183
  v_lshlrev_b32 v5, 16, v46
  v_and_b32 v6, 0xffff0000, v46
  v_fmac_f32 v228, v5, v182
  v_fmac_f32 v229, v6, v182
  v_fmac_f32 v238, v5, v183
  v_fmac_f32 v239, v6, v183
  v_lshlrev_b32 v5, 16, v47
  v_and_b32 v6, 0xffff0000, v47
  v_fmac_f32 v230, v5, v182
  v_fmac_f32 v231, v6, v182
  v_fmac_f32 v240, v5, v183
  v_fmac_f32 v241, v6, v183
  v_lshlrev_b32 v5, 16, v131
  v_and_b32 v6, 0xffff0000, v131
  v_fmac_f32 v232, v5, v182
  v_fmac_f32 v233, v6, v182
  v_fmac_f32 v242, v5, v183
  v_fmac_f32 v243, v6, v183
  v_lshlrev_b32 v5, 16, v48
  v_and_b32 v6, 0xffff0000, v48
  v_fmac_f32 v224, v5, v184
  v_fmac_f32 v225, v6, v184
  v_fmac_f32 v234, v5, v185
  v_fmac_f32 v235, v6, v185
  v_lshlrev_b32 v5, 16, v49
  v_and_b32 v6, 0xffff0000, v49
  v_fmac_f32 v226, v5, v184
  v_fmac_f32 v227, v6, v184
  v_fmac_f32 v236, v5, v185
  v_fmac_f32 v237, v6, v185
  v_lshlrev_b32 v5, 16, v50
  v_and_b32 v6, 0xffff0000, v50
  v_fmac_f32 v228, v5, v184
  v_fmac_f32 v229, v6, v184
  v_fmac_f32 v238, v5, v185
  v_fmac_f32 v239, v6, v185
  v_lshlrev_b32 v5, 16, v51
  v_and_b32 v6, 0xffff0000, v51
  v_fmac_f32 v230, v5, v184
  v_fmac_f32 v231, v6, v184
  v_fmac_f32 v240, v5, v185
  v_fmac_f32 v241, v6, v185
  v_lshlrev_b32 v5, 16, v132
  v_and_b32 v6, 0xffff0000, v132
  v_fmac_f32 v232, v5, v184
  v_fmac_f32 v233, v6, v184
  v_fmac_f32 v242, v5, v185
  v_fmac_f32 v243, v6, v185
  v_lshlrev_b32 v5, 16, v52
  v_and_b32 v6, 0xffff0000, v52
  v_fmac_f32 v224, v5, v186
  v_fmac_f32 v225, v6, v186
  v_fmac_f32 v234, v5, v187
  v_fmac_f32 v235, v6, v187
  v_lshlrev_b32 v5, 16, v53
  v_and_b32 v6, 0xffff0000, v53
  v_fmac_f32 v226, v5, v186
  v_fmac_f32 v227, v6, v186
  v_fmac_f32 v236, v5, v187
  v_fmac_f32 v237, v6, v187
  v_lshlrev_b32 v5, 16, v54
  v_and_b32 v6, 0xffff0000, v54
  v_fmac_f32 v228, v5, v186
  v_fmac_f32 v229, v6, v186
  v_fmac_f32 v238, v5, v187
  v_fmac_f32 v239, v6, v187
  v_lshlrev_b32 v5, 16, v55
  v_and_b32 v6, 0xffff0000, v55
  v_fmac_f32 v230, v5, v186
  v_fmac_f32 v231, v6, v186
  v_fmac_f32 v240, v5, v187
  v_fmac_f32 v241, v6, v187
  v_lshlrev_b32 v5, 16, v133
  v_and_b32 v6, 0xffff0000, v133
  v_fmac_f32 v232, v5, v186
  v_fmac_f32 v233, v6, v186
  v_fmac_f32 v242, v5, v187
  v_fmac_f32 v243, v6, v187
  v_lshlrev_b32 v5, 16, v56
  v_and_b32 v6, 0xffff0000, v56
  v_fmac_f32 v224, v5, v188
  v_fmac_f32 v225, v6, v188
  v_fmac_f32 v234, v5, v189
  v_fmac_f32 v235, v6, v189
  v_lshlrev_b32 v5, 16, v57
  v_and_b32 v6, 0xffff0000, v57
  v_fmac_f32 v226, v5, v188
  v_fmac_f32 v227, v6, v188
  v_fmac_f32 v236, v5, v189
  v_fmac_f32 v237, v6, v189
  v_lshlrev_b32 v5, 16, v58
  v_and_b32 v6, 0xffff0000, v58
  v_fmac_f32 v228, v5, v188
  v_fmac_f32 v229, v6, v188
  v_fmac_f32 v238, v5, v189
  v_fmac_f32 v239, v6, v189
  v_lshlrev_b32 v5, 16, v59
  v_and_b32 v6, 0xffff0000, v59
  v_fmac_f32 v230, v5, v188
  v_fmac_f32 v231, v6, v188
  v_fmac_f32 v240, v5, v189
  v_fmac_f32 v241, v6, v189
  v_lshlrev_b32 v5, 16, v134
  v_and_b32 v6, 0xffff0000, v134
  v_fmac_f32 v232, v5, v188
  v_fmac_f32 v233, v6, v188
  v_fmac_f32 v242, v5, v189
  v_fmac_f32 v243, v6, v189
  v_lshlrev_b32 v5, 16, v60
  v_and_b32 v6, 0xffff0000, v60
  v_fmac_f32 v224, v5, v190
  v_fmac_f32 v225, v6, v190
  v_fmac_f32 v234, v5, v191
  v_fmac_f32 v235, v6, v191
  v_lshlrev_b32 v5, 16, v61
  v_and_b32 v6, 0xffff0000, v61
  v_fmac_f32 v226, v5, v190
  v_fmac_f32 v227, v6, v190
  v_fmac_f32 v236, v5, v191
  v_fmac_f32 v237, v6, v191
  v_lshlrev_b32 v5, 16, v62
  v_and_b32 v6, 0xffff0000, v62
  v_fmac_f32 v228, v5, v190
  v_fmac_f32 v229, v6, v190
  v_fmac_f32 v238, v5, v191
  v_fmac_f32 v239, v6, v191
  v_lshlrev_b32 v5, 16, v63
  v_and_b32 v6, 0xffff0000, v63
  v_fmac_f32 v230, v5, v190
  v_fmac_f32 v231, v6, v190
  v_fmac_f32 v240, v5, v191
  v_fmac_f32 v241, v6, v191
  v_lshlrev_b32 v5, 16, v135
  v_and_b32 v6, 0xffff0000, v135
  v_fmac_f32 v232, v5, v190
  v_fmac_f32 v233, v6, v190
  v_fmac_f32 v242, v5, v191
  v_fmac_f32 v243, v6, v191
  v_lshlrev_b32 v5, 16, v64
  v_and_b32 v6, 0xffff0000, v64
  v_fmac_f32 v224, v5, v192
  v_fmac_f32 v225, v6, v192
  v_fmac_f32 v234, v5, v193
  v_fmac_f32 v235, v6, v193
  v_lshlrev_b32 v5, 16, v65
  v_and_b32 v6, 0xffff0000, v65
  v_fmac_f32 v226, v5, v192
  v_fmac_f32 v227, v6, v192
  v_fmac_f32 v236, v5, v193
  v_fmac_f32 v237, v6, v193
  v_lshlrev_b32 v5, 16, v66
  v_and_b32 v6, 0xffff0000, v66
  v_fmac_f32 v228, v5, v192
  v_fmac_f32 v229, v6, v192
  v_fmac_f32 v238, v5, v193
  v_fmac_f32 v239, v6, v193
  v_lshlrev_b32 v5, 16, v67
  v_and_b32 v6, 0xffff0000, v67
  v_fmac_f32 v230, v5, v192
  v_fmac_f32 v231, v6, v192
  v_fmac_f32 v240, v5, v193
  v_fmac_f32 v241, v6, v193
  v_lshlrev_b32 v5, 16, v136
  v_and_b32 v6, 0xffff0000, v136
  v_fmac_f32 v232, v5, v192
  v_fmac_f32 v233, v6, v192
  v_fmac_f32 v242, v5, v193
  v_fmac_f32 v243, v6, v193
  v_lshlrev_b32 v5, 16, v68
  v_and_b32 v6, 0xffff0000, v68
  v_fmac_f32 v224, v5, v194
  v_fmac_f32 v225, v6, v194
  v_fmac_f32 v234, v5, v195
  v_fmac_f32 v235, v6, v195
  v_lshlrev_b32 v5, 16, v69
  v_and_b32 v6, 0xffff0000, v69
  v_fmac_f32 v226, v5, v194
  v_fmac_f32 v227, v6, v194
  v_fmac_f32 v236, v5, v195
  v_fmac_f32 v237, v6, v195
  v_lshlrev_b32 v5, 16, v70
  v_and_b32 v6, 0xffff0000, v70
  v_fmac_f32 v228, v5, v194
  v_fmac_f32 v229, v6, v194
  v_fmac_f32 v238, v5, v195
  v_fmac_f32 v239, v6, v195
  v_lshlrev_b32 v5, 16, v71
  v_and_b32 v6, 0xffff0000, v71
  v_fmac_f32 v230, v5, v194
  v_fmac_f32 v231, v6, v194
  v_fmac_f32 v240, v5, v195
  v_fmac_f32 v241, v6, v195
  v_lshlrev_b32 v5, 16, v137
  v_and_b32 v6, 0xffff0000, v137
  v_fmac_f32 v232, v5, v194
  v_fmac_f32 v233, v6, v194
  v_fmac_f32 v242, v5, v195
  v_fmac_f32 v243, v6, v195
  v_lshlrev_b32 v5, 16, v72
  v_and_b32 v6, 0xffff0000, v72
  v_fmac_f32 v224, v5, v196
  v_fmac_f32 v225, v6, v196
  v_fmac_f32 v234, v5, v197
  v_fmac_f32 v235, v6, v197
  v_lshlrev_b32 v5, 16, v73
  v_and_b32 v6, 0xffff0000, v73
  v_fmac_f32 v226, v5, v196
  v_fmac_f32 v227, v6, v196
  v_fmac_f32 v236, v5, v197
  v_fmac_f32 v237, v6, v197
  v_lshlrev_b32 v5, 16, v74
  v_and_b32 v6, 0xffff0000, v74
  v_fmac_f32 v228, v5, v196
  v_fmac_f32 v229, v6, v196
  v_fmac_f32 v238, v5, v197
  v_fmac_f32 v239, v6, v197
  v_lshlrev_b32 v5, 16, v75
  v_and_b32 v6, 0xffff0000, v75
  v_fmac_f32 v230, v5, v196
  v_fmac_f32 v231, v6, v196
  v_fmac_f32 v240, v5, v197
  v_fmac_f32 v241, v6, v197
  v_lshlrev_b32 v5, 16, v138
  v_and_b32 v6, 0xffff0000, v138
  v_fmac_f32 v232, v5, v196
  v_fmac_f32 v233, v6, v196
  v_fmac_f32 v242, v5, v197
  v_fmac_f32 v243, v6, v197
  v_lshlrev_b32 v5, 16, v76
  v_and_b32 v6, 0xffff0000, v76
  v_fmac_f32 v224, v5, v198
  v_fmac_f32 v225, v6, v198
  v_fmac_f32 v234, v5, v199
  v_fmac_f32 v235, v6, v199
  v_lshlrev_b32 v5, 16, v77
  v_and_b32 v6, 0xffff0000, v77
  v_fmac_f32 v226, v5, v198
  v_fmac_f32 v227, v6, v198
  v_fmac_f32 v236, v5, v199
  v_fmac_f32 v237, v6, v199
  v_lshlrev_b32 v5, 16, v78
  v_and_b32 v6, 0xffff0000, v78
  v_fmac_f32 v228, v5, v198
  v_fmac_f32 v229, v6, v198
  v_fmac_f32 v238, v5, v199
  v_fmac_f32 v239, v6, v199
  v_lshlrev_b32 v5, 16, v79
  v_and_b32 v6, 0xffff0000, v79
  v_fmac_f32 v230, v5, v198
  v_fmac_f32 v231, v6, v198
  v_fmac_f32 v240, v5, v199
  v_fmac_f32 v241, v6, v199
  v_lshlrev_b32 v5, 16, v139
  v_and_b32 v6, 0xffff0000, v139
  v_fmac_f32 v232, v5, v198
  v_fmac_f32 v233, v6, v198
  v_fmac_f32 v242, v5, v199
  v_fmac_f32 v243, v6, v199
  v_lshlrev_b32 v5, 16, v80
  v_and_b32 v6, 0xffff0000, v80
  v_fmac_f32 v224, v5, v200
  v_fmac_f32 v225, v6, v200
  v_fmac_f32 v234, v5, v201
  v_fmac_f32 v235, v6, v201
  v_lshlrev_b32 v5, 16, v81
  v_and_b32 v6, 0xffff0000, v81
  v_fmac_f32 v226, v5, v200
  v_fmac_f32 v227, v6, v200
  v_fmac_f32 v236, v5, v201
  v_fmac_f32 v237, v6, v201
  v_lshlrev_b32 v5, 16, v82
  v_and_b32 v6, 0xffff0000, v82
  v_fmac_f32 v228, v5, v200
  v_fmac_f32 v229, v6, v200
  v_fmac_f32 v238, v5, v201
  v_fmac_f32 v239, v6, v201
  v_lshlrev_b32 v5, 16, v83
  v_and_b32 v6, 0xffff0000, v83
  v_fmac_f32 v230, v5, v200
  v_fmac_f32 v231, v6, v200
  v_fmac_f32 v240, v5, v201
  v_fmac_f32 v241, v6, v201
  v_lshlrev_b32 v5, 16, v140
  v_and_b32 v6, 0xffff0000, v140
  v_fmac_f32 v232, v5, v200
  v_fmac_f32 v233, v6, v200
  v_fmac_f32 v242, v5, v201
  v_fmac_f32 v243, v6, v201
  v_lshlrev_b32 v5, 16, v84
  v_and_b32 v6, 0xffff0000, v84
  v_fmac_f32 v224, v5, v202
  v_fmac_f32 v225, v6, v202
  v_fmac_f32 v234, v5, v203
  v_fmac_f32 v235, v6, v203
  v_lshlrev_b32 v5, 16, v85
  v_and_b32 v6, 0xffff0000, v85
  v_fmac_f32 v226, v5, v202
  v_fmac_f32 v227, v6, v202
  v_fmac_f32 v236, v5, v203
  v_fmac_f32 v237, v6, v203
  v_lshlrev_b32 v5, 16, v86
  v_and_b32 v6, 0xffff0000, v86
  v_fmac_f32 v228, v5, v202
  v_fmac_f32 v229, v6, v202
  v_fmac_f32 v238, v5, v203
  v_fmac_f32 v239, v6, v203
  v_lshlrev_b32 v5, 16, v87
  v_and_b32 v6, 0xffff0000, v87
  v_fmac_f32 v230, v5, v202
  v_fmac_f32 v231, v6, v202
  v_fmac_f32 v240, v5, v203
  v_fmac_f32 v241, v6, v203
  v_lshlrev_b32 v5, 16, v141
  v_and_b32 v6, 0xffff0000, v141
  v_fmac_f32 v232, v5, v202
  v_fmac_f32 v233, v6, v202
  v_fmac_f32 v242, v5, v203
  v_fmac_f32 v243, v6, v203
  v_lshlrev_b32 v5, 16, v88
  v_and_b32 v6, 0xffff0000, v88
  v_fmac_f32 v224, v5, v204
  v_fmac_f32 v225, v6, v204
  v_fmac_f32 v234, v5, v205
  v_fmac_f32 v235, v6, v205
  v_lshlrev_b32 v5, 16, v89
  v_and_b32 v6, 0xffff0000, v89
  v_fmac_f32 v226, v5, v204
  v_fmac_f32 v227, v6, v204
  v_fmac_f32 v236, v5, v205
  v_fmac_f32 v237, v6, v205
  v_lshlrev_b32 v5, 16, v90
  v_and_b32 v6, 0xffff0000, v90
  v_fmac_f32 v228, v5, v204
  v_fmac_f32 v229, v6, v204
  v_fmac_f32 v238, v5, v205
  v_fmac_f32 v239, v6, v205
  v_lshlrev_b32 v5, 16, v91
  v_and_b32 v6, 0xffff0000, v91
  v_fmac_f32 v230, v5, v204
  v_fmac_f32 v231, v6, v204
  v_fmac_f32 v240, v5, v205
  v_fmac_f32 v241, v6, v205
  v_lshlrev_b32 v5, 16, v142
  v_and_b32 v6, 0xffff0000, v142
  v_fmac_f32 v232, v5, v204
  v_fmac_f32 v233, v6, v204
  v_fmac_f32 v242, v5, v205
  v_fmac_f32 v243, v6, v205
  v_lshlrev_b32 v5, 16, v92
  v_and_b32 v6, 0xffff0000, v92
  v_fmac_f32 v224, v5, v206
  v_fmac_f32 v225, v6, v206
  v_fmac_f32 v234, v5, v207
  v_fmac_f32 v235, v6, v207
  v_lshlrev_b32 v5, 16, v93
  v_and_b32 v6, 0xffff0000, v93
  v_fmac_f32 v226, v5, v206
  v_fmac_f32 v227, v6, v206
  v_fmac_f32 v236, v5, v207
  v_fmac_f32 v237, v6, v207
  v_lshlrev_b32 v5, 16, v94
  v_and_b32 v6, 0xffff0000, v94
  v_fmac_f32 v228, v5, v206
  v_fmac_f32 v229, v6, v206
  v_fmac_f32 v238, v5, v207
  v_fmac_f32 v239, v6, v207
  v_lshlrev_b32 v5, 16, v95
  v_and_b32 v6, 0xffff0000, v95
  v_fmac_f32 v230, v5, v206
  v_fmac_f32 v231, v6, v206
  v_fmac_f32 v240, v5, v207
  v_fmac_f32 v241, v6, v207
  v_lshlrev_b32 v5, 16, v143
  v_and_b32 v6, 0xffff0000, v143
  v_fmac_f32 v232, v5, v206
  v_fmac_f32 v233, v6, v206
  v_fmac_f32 v242, v5, v207
  v_fmac_f32 v243, v6, v207
  v_lshlrev_b32 v5, 16, v96
  v_and_b32 v6, 0xffff0000, v96
  v_fmac_f32 v224, v5, v208
  v_fmac_f32 v225, v6, v208
  v_fmac_f32 v234, v5, v209
  v_fmac_f32 v235, v6, v209
  v_lshlrev_b32 v5, 16, v97
  v_and_b32 v6, 0xffff0000, v97
  v_fmac_f32 v226, v5, v208
  v_fmac_f32 v227, v6, v208
  v_fmac_f32 v236, v5, v209
  v_fmac_f32 v237, v6, v209
  v_lshlrev_b32 v5, 16, v98
  v_and_b32 v6, 0xffff0000, v98
  v_fmac_f32 v228, v5, v208
  v_fmac_f32 v229, v6, v208
  v_fmac_f32 v238, v5, v209
  v_fmac_f32 v239, v6, v209
  v_lshlrev_b32 v5, 16, v99
  v_and_b32 v6, 0xffff0000, v99
  v_fmac_f32 v230, v5, v208
  v_fmac_f32 v231, v6, v208
  v_fmac_f32 v240, v5, v209
  v_fmac_f32 v241, v6, v209
  v_lshlrev_b32 v5, 16, v144
  v_and_b32 v6, 0xffff0000, v144
  v_fmac_f32 v232, v5, v208
  v_fmac_f32 v233, v6, v208
  v_fmac_f32 v242, v5, v209
  v_fmac_f32 v243, v6, v209
  v_lshlrev_b32 v5, 16, v100
  v_and_b32 v6, 0xffff0000, v100
  v_fmac_f32 v224, v5, v210
  v_fmac_f32 v225, v6, v210
  v_fmac_f32 v234, v5, v211
  v_fmac_f32 v235, v6, v211
  v_lshlrev_b32 v5, 16, v101
  v_and_b32 v6, 0xffff0000, v101
  v_fmac_f32 v226, v5, v210
  v_fmac_f32 v227, v6, v210
  v_fmac_f32 v236, v5, v211
  v_fmac_f32 v237, v6, v211
  v_lshlrev_b32 v5, 16, v102
  v_and_b32 v6, 0xffff0000, v102
  v_fmac_f32 v228, v5, v210
  v_fmac_f32 v229, v6, v210
  v_fmac_f32 v238, v5, v211
  v_fmac_f32 v239, v6, v211
  v_lshlrev_b32 v5, 16, v103
  v_and_b32 v6, 0xffff0000, v103
  v_fmac_f32 v230, v5, v210
  v_fmac_f32 v231, v6, v210
  v_fmac_f32 v240, v5, v211
  v_fmac_f32 v241, v6, v211
  v_lshlrev_b32 v5, 16, v145
  v_and_b32 v6, 0xffff0000, v145
  v_fmac_f32 v232, v5, v210
  v_fmac_f32 v233, v6, v210
  v_fmac_f32 v242, v5, v211
  v_fmac_f32 v243, v6, v211
  v_lshlrev_b32 v5, 16, v104
  v_and_b32 v6, 0xffff0000, v104
  v_fmac_f32 v224, v5, v212
  v_fmac_f32 v225, v6, v212
  v_fmac_f32 v234, v5, v213
  v_fmac_f32 v235, v6, v213
  v_lshlrev_b32 v5, 16, v105
  v_and_b32 v6, 0xffff0000, v105
  v_fmac_f32 v226, v5, v212
  v_fmac_f32 v227, v6, v212
  v_fmac_f32 v236, v5, v213
  v_fmac_f32 v237, v6, v213
  v_lshlrev_b32 v5, 16, v106
  v_and_b32 v6, 0xffff0000, v106
  v_fmac_f32 v228, v5, v212
  v_fmac_f32 v229, v6, v212
  v_fmac_f32 v238, v5, v213
  v_fmac_f32 v239, v6, v213
  v_lshlrev_b32 v5, 16, v107
  v_and_b32 v6, 0xffff0000, v107
  v_fmac_f32 v230, v5, v212
  v_fmac_f32 v231, v6, v212
  v_fmac_f32 v240, v5, v213
  v_fmac_f32 v241, v6, v213
  v_lshlrev_b32 v5, 16, v146
  v_and_b32 v6, 0xffff0000, v146
  v_fmac_f32 v232, v5, v212
  v_fmac_f32 v233, v6, v212
  v_fmac_f32 v242, v5, v213
  v_fmac_f32 v243, v6, v213
  v_lshlrev_b32 v5, 16, v108
  v_and_b32 v6, 0xffff0000, v108
  v_fmac_f32 v224, v5, v214
  v_fmac_f32 v225, v6, v214
  v_fmac_f32 v234, v5, v215
  v_fmac_f32 v235, v6, v215
  v_lshlrev_b32 v5, 16, v109
  v_and_b32 v6, 0xffff0000, v109
  v_fmac_f32 v226, v5, v214
  v_fmac_f32 v227, v6, v214
  v_fmac_f32 v236, v5, v215
  v_fmac_f32 v237, v6, v215
  v_lshlrev_b32 v5, 16, v110
  v_and_b32 v6, 0xffff0000, v110
  v_fmac_f32 v228, v5, v214
  v_fmac_f32 v229, v6, v214
  v_fmac_f32 v238, v5, v215
  v_fmac_f32 v239, v6, v215
  v_lshlrev_b32 v5, 16, v111
  v_and_b32 v6, 0xffff0000, v111
  v_fmac_f32 v230, v5, v214
  v_fmac_f32 v231, v6, v214
  v_fmac_f32 v240, v5, v215
  v_fmac_f32 v241, v6, v215
  v_lshlrev_b32 v5, 16, v147
  v_and_b32 v6, 0xffff0000, v147
  v_fmac_f32 v232, v5, v214
  v_fmac_f32 v233, v6, v214
  v_fmac_f32 v242, v5, v215
  v_fmac_f32 v243, v6, v215
  v_lshlrev_b32 v5, 16, v112
  v_and_b32 v6, 0xffff0000, v112
  v_fmac_f32 v224, v5, v216
  v_fmac_f32 v225, v6, v216
  v_fmac_f32 v234, v5, v217
  v_fmac_f32 v235, v6, v217
  v_lshlrev_b32 v5, 16, v113
  v_and_b32 v6, 0xffff0000, v113
  v_fmac_f32 v226, v5, v216
  v_fmac_f32 v227, v6, v216
  v_fmac_f32 v236, v5, v217
  v_fmac_f32 v237, v6, v217
  v_lshlrev_b32 v5, 16, v114
  v_and_b32 v6, 0xffff0000, v114
  v_fmac_f32 v228, v5, v216
  v_fmac_f32 v229, v6, v216
  v_fmac_f32 v238, v5, v217
  v_fmac_f32 v239, v6, v217
  v_lshlrev_b32 v5, 16, v115
  v_and_b32 v6, 0xffff0000, v115
  v_fmac_f32 v230, v5, v216
  v_fmac_f32 v231, v6, v216
  v_fmac_f32 v240, v5, v217
  v_fmac_f32 v241, v6, v217
  v_lshlrev_b32 v5, 16, v148
  v_and_b32 v6, 0xffff0000, v148
  v_fmac_f32 v232, v5, v216
  v_fmac_f32 v233, v6, v216
  v_fmac_f32 v242, v5, v217
  v_fmac_f32 v243, v6, v217
  v_lshlrev_b32 v5, 16, v116
  v_and_b32 v6, 0xffff0000, v116
  v_fmac_f32 v224, v5, v218
  v_fmac_f32 v225, v6, v218
  v_fmac_f32 v234, v5, v219
  v_fmac_f32 v235, v6, v219
  v_lshlrev_b32 v5, 16, v117
  v_and_b32 v6, 0xffff0000, v117
  v_fmac_f32 v226, v5, v218
  v_fmac_f32 v227, v6, v218
  v_fmac_f32 v236, v5, v219
  v_fmac_f32 v237, v6, v219
  v_lshlrev_b32 v5, 16, v118
  v_and_b32 v6, 0xffff0000, v118
  v_fmac_f32 v228, v5, v218
  v_fmac_f32 v229, v6, v218
  v_fmac_f32 v238, v5, v219
  v_fmac_f32 v239, v6, v219
  v_lshlrev_b32 v5, 16, v119
  v_and_b32 v6, 0xffff0000, v119
  v_fmac_f32 v230, v5, v218
  v_fmac_f32 v231, v6, v218
  v_fmac_f32 v240, v5, v219
  v_fmac_f32 v241, v6, v219
  v_lshlrev_b32 v5, 16, v149
  v_and_b32 v6, 0xffff0000, v149
  v_fmac_f32 v232, v5, v218
  v_fmac_f32 v233, v6, v218
  v_fmac_f32 v242, v5, v219
  v_fmac_f32 v243, v6, v219
  v_lshlrev_b32 v5, 16, v120
  v_and_b32 v6, 0xffff0000, v120
  v_fmac_f32 v224, v5, v220
  v_fmac_f32 v225, v6, v220
  v_fmac_f32 v234, v5, v221
  v_fmac_f32 v235, v6, v221
  v_lshlrev_b32 v5, 16, v121
  v_and_b32 v6, 0xffff0000, v121
  v_fmac_f32 v226, v5, v220
  v_fmac_f32 v227, v6, v220
  v_fmac_f32 v236, v5, v221
  v_fmac_f32 v237, v6, v221
  v_lshlrev_b32 v5, 16, v122
  v_and_b32 v6, 0xffff0000, v122
  v_fmac_f32 v228, v5, v220
  v_fmac_f32 v229, v6, v220
  v_fmac_f32 v238, v5, v221
  v_fmac_f32 v239, v6, v221
  v_lshlrev_b32 v5, 16, v123
  v_and_b32 v6, 0xffff0000, v123
  v_fmac_f32 v230, v5, v220
  v_fmac_f32 v231, v6, v220
  v_fmac_f32 v240, v5, v221
  v_fmac_f32 v241, v6, v221
  v_lshlrev_b32 v5, 16, v150
  v_and_b32 v6, 0xffff0000, v150
  v_fmac_f32 v232, v5, v220
  v_fmac_f32 v233, v6, v220
  v_fmac_f32 v242, v5, v221
  v_fmac_f32 v243, v6, v221
  v_lshlrev_b32 v5, 16, v124
  v_and_b32 v6, 0xffff0000, v124
  v_fmac_f32 v224, v5, v222
  v_fmac_f32 v225, v6, v222
  v_fmac_f32 v234, v5, v223
  v_fmac_f32 v235, v6, v223
  v_lshlrev_b32 v5, 16, v125
  v_and_b32 v6, 0xffff0000, v125
  v_fmac_f32 v226, v5, v222
  v_fmac_f32 v227, v6, v222
  v_fmac_f32 v236, v5, v223
  v_fmac_f32 v237, v6, v223
  v_lshlrev_b32 v5, 16, v126
  v_and_b32 v6, 0xffff0000, v126
  v_fmac_f32 v228, v5, v222
  v_fmac_f32 v229, v6, v222
  v_fmac_f32 v238, v5, v223
  v_fmac_f32 v239, v6, v223
  v_lshlrev_b32 v5, 16, v127
  v_and_b32 v6, 0xffff0000, v127
  v_fmac_f32 v230, v5, v222
  v_fmac_f32 v231, v6, v222
  v_fmac_f32 v240, v5, v223
  v_fmac_f32 v241, v6, v223
  v_lshlrev_b32 v5, 16, v151
  v_and_b32 v6, 0xffff0000, v151
  v_fmac_f32 v232, v5, v222
  v_fmac_f32 v233, v6, v222
  v_fmac_f32 v242, v5, v223
  v_fmac_f32 v243, v6, v223
  s_mul_i32 s64, s59, 5120
  v_lshlrev_b32 v5, 5, v1
  v_add_u32 v5, s64, v5
  v_lshlrev_b32 v6, 3, v1
  v_add_u32 v6, s64, v6
  ds_write_b128 v5, v[224:227] offset:0
  ds_write_b128 v5, v[228:231] offset:16
  ds_write_b64 v6, v[232:233] offset:2048
  ds_write_b128 v5, v[234:237] offset:2560
  ds_write_b128 v5, v[238:241] offset:2576
  ds_write_b64 v6, v[242:243] offset:4608
  s_waitcnt lgkmcnt(0)
  s_barrier
  s_mul_i32 s64, s57, 5120
  s_add_u32 s64, s64, 0
  v_lshlrev_b32 v5, 2, v0
  ds_read_b32 v8, v5 offset:0
  ds_read_b32 v9, v5 offset:5120
  ds_read_b32 v10, v5 offset:10240
  ds_read_b32 v11, v5 offset:15360
  ds_read_b32 v12, v5 offset:20480
  ds_read_b32 v13, v5 offset:25600
  ds_read_b32 v14, v5 offset:30720
  ds_read_b32 v15, v5 offset:35840
  ds_read_b32 v16, v5 offset:2048
  ds_read_b32 v17, v5 offset:7168
  ds_read_b32 v18, v5 offset:12288
  ds_read_b32 v19, v5 offset:17408
  ds_read_b32 v20, v5 offset:22528
  ds_read_b32 v21, v5 offset:27648
  ds_read_b32 v22, v5 offset:32768
  ds_read_b32 v23, v5 offset:37888
  ds_read_b32 v24, v5 offset:4096
  ds_read_b32 v25, v5 offset:9216
  ds_read_b32 v26, v5 offset:14336
  ds_read_b32 v27, v5 offset:19456
  ds_read_b32 v28, v5 offset:24576
  ds_read_b32 v29, v5 offset:29696
  ds_read_b32 v30, v5 offset:34816
  ds_read_b32 v31, v5 offset:39936
  s_waitcnt lgkmcnt(0)
  v_add_f32 v8, v8, v12
  v_add_f32 v9, v9, v13
  v_add_f32 v10, v10, v14
  v_add_f32 v11, v11, v15
  v_add_f32 v8, v8, v10
  v_add_f32 v9, v9, v11
  v_add_f32 v8, v8, v9
  v_add_f32 v16, v16, v20
  v_add_f32 v17, v17, v21
  v_add_f32 v18, v18, v22
  v_add_f32 v19, v19, v23
  v_add_f32 v16, v16, v18
  v_add_f32 v17, v17, v19
  v_add_f32 v16, v16, v17
  v_add_f32 v24, v24, v28
  v_add_f32 v25, v25, v29
  v_add_f32 v26, v26, v30
  v_add_f32 v27, v27, v31
  v_add_f32 v24, v24, v26
  v_add_f32 v25, v25, v27
  v_add_f32 v24, v24, v25
  buffer_atomic_add_f32 v8, v5, s[48:51], s64 offen
  buffer_atomic_add_f32 v16, v5, s[48:51], s64 offen offset:2048
  v_cmp_gt_u32 vcc, 256, v0
  s_and_saveexec_b64 s[66:67], vcc
  s_cbranch_execz L_endA2
  s_add_u32 s64, s64, 4096
  s_nop 3
  buffer_atomic_add_f32 v24, v5, s[48:51], s64 offen
L_endA2:
  s_mov_b64 exec, -1
L_endA:
  s_endpgm
.globl mlp_kernel
.p2align 8
.type mlp_kernel,@function
mlp_kernel:
  s_cmp_ge_u32 s2, 48
  s_cbranch_scc1 L_endB
  s_load_dwordx2 s[8:9], s[0:1], 0
  s_load_dwordx8 s[12:19], s[0:1], 48
  s_load_dwordx4 s[20:23], s[0:1], 80
  s_load_dwordx2 s[10:11], s[0:1], 96
  v_and_b32 v1, 63, v0
  v_lshrrev_b32 v5, 6, v0
  s_nop 0
  v_readfirstlane_b32 s59, v5
  s_mov_b32 s83, 0x3fb8aa3b
  s_waitcnt lgkmcnt(0)
  s_mov_b32 s24, s8
  s_mov_b32 s25, s9
  s_mov_b32 s26, 5120
  s_mov_b32 s27, 0x00020000
  s_mov_b32 s28, s12
  s_mov_b32 s29, s13
  s_mov_b32 s30, 1280
  s_mov_b32 s31, 0x00020000
  s_mov_b32 s32, s14
  s_mov_b32 s33, s15
  s_mov_b32 s34, 1966080
  s_mov_b32 s35, 0x00020000
  s_mov_b32 s36, s16
  s_mov_b32 s37, s17
  s_mov_b32 s38, 1966080
  s_mov_b32 s39, 0x00020000
  s_mov_b32 s40, s18
  s_mov_b32 s41, s19
  s_mov_b32 s42, 1966080
  s_mov_b32 s43, 0x00020000
  s_mov_b32 s44, s22
  s_mov_b32 s45, s23
  s_mov_b32 s46, 256
  s_mov_b32 s47, 0x00020000
  s_mov_b32 s48, s10
  s_mov_b32 s49, s11
  s_mov_b32 s50, 16777216
  s_mov_b32 s51, 0x00020000
  s_mov_b32 s72, s20
  s_mov_b32 s73, s21
  s_mov_b32 s74, 5120
  s_mov_b32 s75, 0x00020000
  s_cmp_lt_u32 s59, 4
  s_cbranch_scc0 L_b_noln0
  s_mul_i32 s64, s59, 2560
  s_add_u32 s64, s64, 0
  s_mul_i32 s65, s59, 1280
  v_lshlrev_b32 v5, 5, v1
  v_lshlrev_b32 v6, 3, v1
  v_lshlrev_b32 v7, 4, v1
  v_lshlrev_b32 v8, 2, v1
  buffer_load_dwordx4 v[100:103], v5, s[48:51], s64 offen
  buffer_load_dwordx4 v[104:107], v5, s[48:51], s64 offen offset:16
  buffer_load_dwordx2 v[108:109], v6, s[48:51], s64 offen offset:2048
  buffer_load_dwordx4 v[110:113], v7, s[24:27], s65 offen
  buffer_load_dword v114, v8, s[24:27], s65 offen offset:1024
  buffer_load_dwordx4 v[116:119], v7, s[28:31], 0 offen
  buffer_load_dword v120, v8, s[28:31], 0 offen offset:1024
L_b_noln0:
  s_and_b32 s60, s59, 1
  s_lshr_b32 s61, s59, 1
  s_cmp_eq_u32 s60, 0
  s_cselect_b32 s52, s32, s36
  s_cselect_b32 s53, s33, s37
  s_mov_b32 s54, s34
  s_mov_b32 s55, s35
  v_lshrrev_b32 v5, 2, v1
  v_mul_u32_u24 v5, 3072, v5
  v_and_b32 v6, 3, v1
  v_lshlrev_b32 v6, 4, v6
  v_add_u32 v9, v5, v6
  s_mul_i32 s64, s61, 49152
  s_lshl_b32 s65, s2, 6
  s_add_u32 s64, s64, s65
  buffer_load_dwordx4 v[32:35], v9, s[52:55], s64 offen
  s_add_u32 s64, s64, 393216
  buffer_load_dwordx4 v[36:39], v9, s[52:55], s64 offen
  s_add_u32 s64, s64, 393216
  buffer_load_dwordx4 v[40:43], v9, s[52:55], s64 offen
  s_add_u32 s64, s64, 393216
  buffer_load_dwordx4 v[44:47], v9, s[52:55], s64 offen
  s_add_u32 s64, s64, 393216
  buffer_load_dwordx4 v[48:51], v9, s[52:55], s64 offen
  s_add_u32 s64, s64, 393216
  s_cmp_lt_u32 s59, 8
  s_cbranch_scc0 L_b_nodown0
  s_lshl_b32 s64, s2, 5
  s_lshl_b32 s65, s59, 2
  s_add_u32 s64, s64, s65
  s_mul_i32 s64, s64, 1280
  v_lshlrev_b32 v7, 4, v1
  v_lshlrev_b32 v8, 2, v1
  buffer_load_dwordx4 v[52:55], v7, s[40:43], s64 offen
  buffer_load_dword v68, v8, s[40:43], s64 offen offset:1024
  s_add_u32 s64, s64, 1280
  buffer_load_dwordx4 v[56:59], v7, s[40:43], s64 offen
  buffer_load_dword v69, v8, s[40:43], s64 offen offset:1024
  s_add_u32 s64, s64, 1280
  buffer_load_dwordx4 v[60:63], v7, s[40:43], s64 offen
  buffer_load_dword v70, v8, s[40:43], s64 offen offset:1024
  s_add_u32 s64, s64, 1280
  buffer_load_dwordx4 v[64:67], v7, s[40:43], s64 offen
  buffer_load_dword v71, v8, s[40:43], s64 offen offset:1024
  s_add_u32 s64, s64, 1280
L_b_nodown0:
  s_cmp_lt_u32 s59, 4
  s_cbranch_scc0 L_b_noln1
  s_waitcnt vmcnt(13)
  v_cvt_pk_bf16_f32 v100, v100, v100
  v_lshlrev_b32 v100, 16, v100
  v_cvt_pk_bf16_f32 v101, v101, v101
  v_lshlrev_b32 v101, 16, v101
  v_cvt_pk_bf16_f32 v102, v102, v102
  v_lshlrev_b32 v102, 16, v102
  v_cvt_pk_bf16_f32 v103, v103, v103
  v_lshlrev_b32 v103, 16, v103
  v_cvt_pk_bf16_f32 v104, v104, v104
  v_lshlrev_b32 v104, 16, v104
  v_cvt_pk_bf16_f32 v105, v105, v105
  v_lshlrev_b32 v105, 16, v105
  v_cvt_pk_bf16_f32 v106, v106, v106
  v_lshlrev_b32 v106, 16, v106
  v_cvt_pk_bf16_f32 v107, v107, v107
  v_lshlrev_b32 v107, 16, v107
  v_cvt_pk_bf16_f32 v108, v108, v108
  v_lshlrev_b32 v108, 16, v108
  v_cvt_pk_bf16_f32 v109, v109, v109
  v_lshlrev_b32 v109, 16, v109
  v_lshlrev_b32 v12, 16, v110
  v_and_b32 v13, 0xffff0000, v110
  v_lshlrev_b32 v14, 16, v111
  v_and_b32 v15, 0xffff0000, v111
  v_lshlrev_b32 v16, 16, v112
  v_and_b32 v17, 0xffff0000, v112
  v_lshlrev_b32 v18, 16, v113
  v_and_b32 v19, 0xffff0000, v113
  v_lshlrev_b32 v20, 16, v114
  v_and_b32 v21, 0xffff0000, v114
  v_add_f32 v12, v12, v100
  v_cvt_pk_bf16_f32 v12, v12, v12
  v_lshlrev_b32 v12, 16, v12
  v_add_f32 v13, v13, v101
  v_cvt_pk_bf16_f32 v13, v13, v13
  v_lshlrev_b32 v13, 16, v13
  v_add_f32 v14, v14, v102
  v_cvt_pk_bf16_f32 v14, v14, v14
  v_lshlrev_b32 v14, 16, v14
  v_add_f32 v15, v15, v103
  v_cvt_pk_bf16_f32 v15, v15, v15
  v_lshlrev_b32 v15, 16, v15
  v_add_f32 v16, v16, v104
  v_cvt_pk_bf16_f32 v16, v16, v16
  v_lshlrev_b32 v16, 16, v16
  v_add_f32 v17, v17, v105
  v_cvt_pk_bf16_f32 v17, v17, v17
  v_lshlrev_b32 v17, 16, v17
  v_add_f32 v18, v18, v106
  v_cvt_pk_bf16_f32 v18, v18, v18
  v_lshlrev_b32 v18, 16, v18
  v_add_f32 v19, v19, v107
  v_cvt_pk_bf16_f32 v19, v19, v19
  v_lshlrev_b32 v19, 16, v19
  v_add_f32 v20, v20, v108
  v_cvt_pk_bf16_f32 v20, v20, v20
  v_lshlrev_b32 v20, 16, v20
  v_add_f32 v21, v21, v109
  v_cvt_pk_bf16_f32 v21, v21, v21
  v_lshlrev_b32 v21, 16, v21
  s_mul_i32 s64, s59, 2560
  v_lshlrev_b32 v5, 5, v1
  v_add_u32 v5, s64, v5
  v_lshlrev_b32 v6, 3, v1
  v_add_u32 v6, s64, v6
  ds_write_b128 v5, v[12:15] offset:10240
  ds_write_b128 v5, v[16:19] offset:10256
  ds_write_b64 v6, v[20:21] offset:12288
  s_nop 1
  v_add_f32 v22, v12, v13
  v_add_f32 v22, v22, v14
  v_add_f32 v22, v22, v15
  v_add_f32 v22, v22, v16
  v_add_f32 v22, v22, v17
  v_add_f32 v22, v22, v18
  v_add_f32 v22, v22, v19
  v_add_f32 v22, v22, v20
  v_add_f32 v22, v22, v21
  s_nop 1
  v_add_f32_dpp v22, v22, v22 quad_perm:[1,0,3,2] row_mask:0xf bank_mask:0xf
  s_nop 1
  v_add_f32_dpp v22, v22, v22 quad_perm:[2,3,0,1] row_mask:0xf bank_mask:0xf
  s_nop 1
  v_add_f32_dpp v22, v22, v22 row_half_mirror row_mask:0xf bank_mask:0xf
  s_nop 1
  v_add_f32_dpp v22, v22, v22 row_mirror row_mask:0xf bank_mask:0xf
  v_mov_b32 v23, v22
  s_nop 1
  v_permlane16_swap_b32 v22, v23
  s_nop 1
  v_add_f32 v22, v22, v23
  v_mov_b32 v23, v22
  s_nop 1
  v_permlane32_swap_b32 v22, v23
  s_nop 1
  v_add_f32 v22, v22, v23
  v_mul_f32 v24, 0x3acccccd, v22
  v_sub_f32 v23, v12, v24
  v_mul_f32 v22, v23, v23
  v_sub_f32 v23, v13, v24
  v_fmac_f32 v22, v23, v23
  v_sub_f32 v23, v14, v24
  v_fmac_f32 v22, v23, v23
  v_sub_f32 v23, v15, v24
  v_fmac_f32 v22, v23, v23
  v_sub_f32 v23, v16, v24
  v_fmac_f32 v22, v23, v23
  v_sub_f32 v23, v17, v24
  v_fmac_f32 v22, v23, v23
  v_sub_f32 v23, v18, v24
  v_fmac_f32 v22, v23, v23
  v_sub_f32 v23, v19, v24
  v_fmac_f32 v22, v23, v23
  v_sub_f32 v23, v20, v24
  v_fmac_f32 v22, v23, v23
  v_sub_f32 v23, v21, v24
  v_fmac_f32 v22, v23, v23
  s_nop 1
  v_add_f32_dpp v22, v22, v22 quad_perm:[1,0,3,2] row_mask:0xf bank_mask:0xf
  s_nop 1
  v_add_f32_dpp v22, v22, v22 quad_perm:[2,3,0,1] row_mask:0xf bank_mask:0xf
  s_nop 1
  v_add_f32_dpp v22, v22, v22 row_half_mirror row_mask:0xf bank_mask:0xf
  s_nop 1
  v_add_f32_dpp v22, v22, v22 row_mirror row_mask:0xf bank_mask:0xf
  v_mov_b32 v23, v22
  s_nop 1
  v_permlane16_swap_b32 v22, v23
  s_nop 1
  v_add_f32 v22, v22, v23
  v_mov_b32 v23, v22
  s_nop 1
  v_permlane32_swap_b32 v22, v23
  s_nop 1
  v_add_f32 v22, v22, v23
  v_mul_f32 v25, 0x3acccccd, v22
  v_cvt_pk_bf16_f32 v24, v24, v24
  v_lshlrev_b32 v24, 16, v24
  v_cvt_pk_bf16_f32 v25, v25, v25
  v_lshlrev_b32 v25, 16, v25
  v_add_f32 v25, 0x3727c5ac, v25
  v_cvt_pk_bf16_f32 v25, v25, v25
  v_lshlrev_b32 v25, 16, v25
  v_sqrt_f32 v25, v25
  s_nop 0
  v_cvt_pk_bf16_f32 v25, v25, v25
  v_lshlrev_b32 v25, 16, v25
  v_rcp_f32 v26, v25
  s_nop 0
  v_sub_f32 v12, v12, v24
  v_cvt_pk_bf16_f32 v12, v12, v12
  v_lshlrev_b32 v12, 16, v12
  v_mul_f32 v22, v12, v26
  v_fma_f32 v23, -v22, v25, v12
  v_fma_f32 v12, v23, v26, v22
  v_cvt_pk_bf16_f32 v12, v12, v12
  v_lshlrev_b32 v12, 16, v12
  v_sub_f32 v13, v13, v24
  v_cvt_pk_bf16_f32 v13, v13, v13
  v_lshlrev_b32 v13, 16, v13
  v_mul_f32 v22, v13, v26
  v_fma_f32 v23, -v22, v25, v13
  v_fma_f32 v13, v23, v26, v22
  v_cvt_pk_bf16_f32 v13, v13, v13
  v_lshlrev_b32 v13, 16, v13
  v_sub_f32 v14, v14, v24
  v_cvt_pk_bf16_f32 v14, v14, v14
  v_lshlrev_b32 v14, 16, v14
  v_mul_f32 v22, v14, v26
  v_fma_f32 v23, -v22, v25, v14
  v_fma_f32 v14, v23, v26, v22
  v_cvt_pk_bf16_f32 v14, v14, v14
  v_lshlrev_b32 v14, 16, v14
  v_sub_f32 v15, v15, v24
  v_cvt_pk_bf16_f32 v15, v15, v15
  v_lshlrev_b32 v15, 16, v15
  v_mul_f32 v22, v15, v26
  v_fma_f32 v23, -v22, v25, v15
  v_fma_f32 v15, v23, v26, v22
  v_cvt_pk_bf16_f32 v15, v15, v15
  v_lshlrev_b32 v15, 16, v15
  v_sub_f32 v16, v16, v24
  v_cvt_pk_bf16_f32 v16, v16, v16
  v_lshlrev_b32 v16, 16, v16
  v_mul_f32 v22, v16, v26
  v_fma_f32 v23, -v22, v25, v16
  v_fma_f32 v16, v23, v26, v22
  v_cvt_pk_bf16_f32 v16, v16, v16
  v_lshlrev_b32 v16, 16, v16
  v_sub_f32 v17, v17, v24
  v_cvt_pk_bf16_f32 v17, v17, v17
  v_lshlrev_b32 v17, 16, v17
  v_mul_f32 v22, v17, v26
  v_fma_f32 v23, -v22, v25, v17
  v_fma_f32 v17, v23, v26, v22
  v_cvt_pk_bf16_f32 v17, v17, v17
  v_lshlrev_b32 v17, 16, v17
  v_sub_f32 v18, v18, v24
  v_cvt_pk_bf16_f32 v18, v18, v18
  v_lshlrev_b32 v18, 16, v18
  v_mul_f32 v22, v18, v26
  v_fma_f32 v23, -v22, v25, v18
  v_fma_f32 v18, v23, v26, v22
  v_cvt_pk_bf16_f32 v18, v18, v18
  v_lshlrev_b32 v18, 16, v18
  v_sub_f32 v19, v19, v24
  v_cvt_pk_bf16_f32 v19, v19, v19
  v_lshlrev_b32 v19, 16, v19
  v_mul_f32 v22, v19, v26
  v_fma_f32 v23, -v22, v25, v19
  v_fma_f32 v19, v23, v26, v22
  v_cvt_pk_bf16_f32 v19, v19, v19
  v_lshlrev_b32 v19, 16, v19
  v_sub_f32 v20, v20, v24
  v_cvt_pk_bf16_f32 v20, v20, v20
  v_lshlrev_b32 v20, 16, v20
  v_mul_f32 v22, v20, v26
  v_fma_f32 v23, -v22, v25, v20
  v_fma_f32 v20, v23, v26, v22
  v_cvt_pk_bf16_f32 v20, v20, v20
  v_lshlrev_b32 v20, 16, v20
  v_sub_f32 v21, v21, v24
  v_cvt_pk_bf16_f32 v21, v21, v21
  v_lshlrev_b32 v21, 16, v21
  v_mul_f32 v22, v21, v26
  v_fma_f32 v23, -v22, v25, v21
  v_fma_f32 v21, v23, v26, v22
  v_cvt_pk_bf16_f32 v21, v21, v21
  v_lshlrev_b32 v21, 16, v21
  s_lshl_b32 s64, s59, 2
  v_lshlrev_b32 v5, 7, v1
  v_add_u32 v5, s64, v5
  v_lshlrev_b32 v6, 5, v1
  v_add_u32 v6, s64, v6
  ds_write_b32 v5, v12 offset:0
  ds_write_b32 v5, v13 offset:16
  ds_write_b32 v5, v14 offset:32
  ds_write_b32 v5, v15 offset:48
  ds_write_b32 v5, v16 offset:64
  ds_write_b32 v5, v17 offset:80
  ds_write_b32 v5, v18 offset:96
  ds_write_b32 v5, v19 offset:112
  ds_write_b32 v6, v20 offset:8192
  ds_write_b32 v6, v21 offset:8208
  v_lshlrev_b32 v100, 16, v116
  v_and_b32 v101, 0xffff0000, v116
  v_lshlrev_b32 v102, 16, v117
  v_and_b32 v103, 0xffff0000, v117
  v_lshlrev_b32 v104, 16, v118
  v_and_b32 v105, 0xffff0000, v118
  v_lshlrev_b32 v106, 16, v119
  v_and_b32 v107, 0xffff0000, v119
  v_lshlrev_b32 v108, 16, v120
  v_and_b32 v109, 0xffff0000, v120
  v_mul_f32 v22, v12, v100
  v_fmac_f32 v22, v13, v101
  v_fmac_f32 v22, v14, v102
  v_fmac_f32 v22, v15, v103
  v_fmac_f32 v22, v16, v104
  v_fmac_f32 v22, v17, v105
  v_fmac_f32 v22, v18, v106
  v_fmac_f32 v22, v19, v107
  v_fmac_f32 v22, v20, v108
  v_fmac_f32 v22, v21, v109
  s_nop 1
  v_add_f32_dpp v22, v22, v22 quad_perm:[1,0,3,2] row_mask:0xf bank_mask:0xf
  s_nop 1
  v_add_f32_dpp v22, v22, v22 quad_perm:[2,3,0,1] row_mask:0xf bank_mask:0xf
  s_nop 1
  v_add_f32_dpp v22, v22, v22 row_half_mirror row_mask:0xf bank_mask:0xf
  s_nop 1
  v_add_f32_dpp v22, v22, v22 row_mirror row_mask:0xf bank_mask:0xf
  v_mov_b32 v23, v22
  s_nop 1
  v_permlane16_swap_b32 v22, v23
  s_nop 1
  v_add_f32 v22, v22, v23
  v_mov_b32 v23, v22
  s_nop 1
  v_permlane32_swap_b32 v22, v23
  s_nop 1
  v_add_f32 v22, v22, v23
  v_cvt_pk_bf16_f32 v22, v22, v22
  v_lshlrev_b32 v22, 16, v22
  v_mul_f32 v23, s83, v22
  v_sub_f32 v23, 0, v23
  v_exp_f32 v23, v23
  s_nop 0
  v_add_f32 v23, 1.0, v23
  v_rcp_f32 v24, v23
  s_nop 0
  v_fma_f32 v23, -v23, v24, 1.0
  v_fma_f32 v24, v23, v24, v24
  v_cvt_pk_bf16_f32 v24, v24, v24
  v_lshlrev_b32 v24, 16, v24
  v_mov_b32 v5, s64
  s_mov_b64 exec, 1
  ds_write_b32 v5, v24 offset:22016
  s_mov_b64 exec, -1
L_b_noln1:
  s_waitcnt lgkmcnt(0)
  s_barrier
  s_lshl_b32 s64, s61, 8
  v_lshrrev_b32 v5, 2, v1
  v_lshlrev_b32 v5, 4, v5
  v_add_u32 v5, s64, v5
  ds_read_b128 v[72:75], v5 offset:0
  ds_read_b128 v[76:79], v5 offset:2048
  ds_read_b128 v[80:83], v5 offset:4096
  ds_read_b128 v[84:87], v5 offset:6144
  ds_read_b128 v[88:91], v5 offset:8192
  v_mov_b32 v96, 0
  v_mov_b32 v97, 0
  v_mov_b32 v98, 0
  v_mov_b32 v99, 0
  v_mov_b32 v100, 0
  v_mov_b32 v101, 0
  v_mov_b32 v102, 0
  v_mov_b32 v103, 0
  v_mov_b32 v104, 0
  v_mov_b32 v105, 0
  v_mov_b32 v106, 0
  v_mov_b32 v107, 0
  v_mov_b32 v108, 0
  v_mov_b32 v109, 0
  v_mov_b32 v110, 0
  v_mov_b32 v111, 0
  v_mov_b32 v112, 0
  v_mov_b32 v113, 0
  v_mov_b32 v114, 0
  v_mov_b32 v115, 0
  v_mov_b32 v116, 0
  v_mov_b32 v117, 0
  v_mov_b32 v118, 0
  v_mov_b32 v119, 0
  v_mov_b32 v120, 0
  v_mov_b32 v121, 0
  v_mov_b32 v122, 0
  v_mov_b32 v123, 0
  v_mov_b32 v124, 0
  v_mov_b32 v125, 0
  v_mov_b32 v126, 0
  v_mov_b32 v127, 0
  s_waitcnt vmcnt(8) lgkmcnt(0)
  s_cmp_lt_u32 s59, 8
  s_cbranch_scc1 L_b_w8
  s_waitcnt vmcnt(0)
L_b_w8:
  v_lshlrev_b32 v5, 16, v32
  v_and_b32 v6, 0xffff0000, v32
  v_fmac_f32 v96, v5, v72
  v_fmac_f32 v97, v6, v72
  v_fmac_f32 v104, v5, v73
  v_fmac_f32 v105, v6, v73
  v_fmac_f32 v112, v5, v74
  v_fmac_f32 v113, v6, v74
  v_fmac_f32 v120, v5, v75
  v_fmac_f32 v121, v6, v75
  v_lshlrev_b32 v5, 16, v33
  v_and_b32 v6, 0xffff0000, v33
  v_fmac_f32 v98, v5, v72
  v_fmac_f32 v99, v6, v72
  v_fmac_f32 v106, v5, v73
  v_fmac_f32 v107, v6, v73
  v_fmac_f32 v114, v5, v74
  v_fmac_f32 v115, v6, v74
  v_fmac_f32 v122, v5, v75
  v_fmac_f32 v123, v6, v75
  v_lshlrev_b32 v5, 16, v34
  v_and_b32 v6, 0xffff0000, v34
  v_fmac_f32 v100, v5, v72
  v_fmac_f32 v101, v6, v72
  v_fmac_f32 v108, v5, v73
  v_fmac_f32 v109, v6, v73
  v_fmac_f32 v116, v5, v74
  v_fmac_f32 v117, v6, v74
  v_fmac_f32 v124, v5, v75
  v_fmac_f32 v125, v6, v75
  v_lshlrev_b32 v5, 16, v35
  v_and_b32 v6, 0xffff0000, v35
  v_fmac_f32 v102, v5, v72
  v_fmac_f32 v103, v6, v72
  v_fmac_f32 v110, v5, v73
  v_fmac_f32 v111, v6, v73
  v_fmac_f32 v118, v5, v74
  v_fmac_f32 v119, v6, v74
  v_fmac_f32 v126, v5, v75
  v_fmac_f32 v127, v6, v75
  v_lshlrev_b32 v5, 16, v36
  v_and_b32 v6, 0xffff0000, v36
  v_fmac_f32 v96, v5, v76
  v_fmac_f32 v97, v6, v76
  v_fmac_f32 v104, v5, v77
  v_fmac_f32 v105, v6, v77
  v_fmac_f32 v112, v5, v78
  v_fmac_f32 v113, v6, v78
  v_fmac_f32 v120, v5, v79
  v_fmac_f32 v121, v6, v79
  v_lshlrev_b32 v5, 16, v37
  v_and_b32 v6, 0xffff0000, v37
  v_fmac_f32 v98, v5, v76
  v_fmac_f32 v99, v6, v76
  v_fmac_f32 v106, v5, v77
  v_fmac_f32 v107, v6, v77
  v_fmac_f32 v114, v5, v78
  v_fmac_f32 v115, v6, v78
  v_fmac_f32 v122, v5, v79
  v_fmac_f32 v123, v6, v79
  v_lshlrev_b32 v5, 16, v38
  v_and_b32 v6, 0xffff0000, v38
  v_fmac_f32 v100, v5, v76
  v_fmac_f32 v101, v6, v76
  v_fmac_f32 v108, v5, v77
  v_fmac_f32 v109, v6, v77
  v_fmac_f32 v116, v5, v78
  v_fmac_f32 v117, v6, v78
  v_fmac_f32 v124, v5, v79
  v_fmac_f32 v125, v6, v79
  v_lshlrev_b32 v5, 16, v39
  v_and_b32 v6, 0xffff0000, v39
  v_fmac_f32 v102, v5, v76
  v_fmac_f32 v103, v6, v76
  v_fmac_f32 v110, v5, v77
  v_fmac_f32 v111, v6, v77
  v_fmac_f32 v118, v5, v78
  v_fmac_f32 v119, v6, v78
  v_fmac_f32 v126, v5, v79
  v_fmac_f32 v127, v6, v79
  v_lshlrev_b32 v5, 16, v40
  v_and_b32 v6, 0xffff0000, v40
  v_fmac_f32 v96, v5, v80
  v_fmac_f32 v97, v6, v80
  v_fmac_f32 v104, v5, v81
  v_fmac_f32 v105, v6, v81
  v_fmac_f32 v112, v5, v82
  v_fmac_f32 v113, v6, v82
  v_fmac_f32 v120, v5, v83
  v_fmac_f32 v121, v6, v83
  v_lshlrev_b32 v5, 16, v41
  v_and_b32 v6, 0xffff0000, v41
  v_fmac_f32 v98, v5, v80
  v_fmac_f32 v99, v6, v80
  v_fmac_f32 v106, v5, v81
  v_fmac_f32 v107, v6, v81
  v_fmac_f32 v114, v5, v82
  v_fmac_f32 v115, v6, v82
  v_fmac_f32 v122, v5, v83
  v_fmac_f32 v123, v6, v83
  v_lshlrev_b32 v5, 16, v42
  v_and_b32 v6, 0xffff0000, v42
  v_fmac_f32 v100, v5, v80
  v_fmac_f32 v101, v6, v80
  v_fmac_f32 v108, v5, v81
  v_fmac_f32 v109, v6, v81
  v_fmac_f32 v116, v5, v82
  v_fmac_f32 v117, v6, v82
  v_fmac_f32 v124, v5, v83
  v_fmac_f32 v125, v6, v83
  v_lshlrev_b32 v5, 16, v43
  v_and_b32 v6, 0xffff0000, v43
  v_fmac_f32 v102, v5, v80
  v_fmac_f32 v103, v6, v80
  v_fmac_f32 v110, v5, v81
  v_fmac_f32 v111, v6, v81
  v_fmac_f32 v118, v5, v82
  v_fmac_f32 v119, v6, v82
  v_fmac_f32 v126, v5, v83
  v_fmac_f32 v127, v6, v83
  v_lshlrev_b32 v5, 16, v44
  v_and_b32 v6, 0xffff0000, v44
  v_fmac_f32 v96, v5, v84
  v_fmac_f32 v97, v6, v84
  v_fmac_f32 v104, v5, v85
  v_fmac_f32 v105, v6, v85
  v_fmac_f32 v112, v5, v86
  v_fmac_f32 v113, v6, v86
  v_fmac_f32 v120, v5, v87
  v_fmac_f32 v121, v6, v87
  v_lshlrev_b32 v5, 16, v45
  v_and_b32 v6, 0xffff0000, v45
  v_fmac_f32 v98, v5, v84
  v_fmac_f32 v99, v6, v84
  v_fmac_f32 v106, v5, v85
  v_fmac_f32 v107, v6, v85
  v_fmac_f32 v114, v5, v86
  v_fmac_f32 v115, v6, v86
  v_fmac_f32 v122, v5, v87
  v_fmac_f32 v123, v6, v87
  v_lshlrev_b32 v5, 16, v46
  v_and_b32 v6, 0xffff0000, v46
  v_fmac_f32 v100, v5, v84
  v_fmac_f32 v101, v6, v84
  v_fmac_f32 v108, v5, v85
  v_fmac_f32 v109, v6, v85
  v_fmac_f32 v116, v5, v86
  v_fmac_f32 v117, v6, v86
  v_fmac_f32 v124, v5, v87
  v_fmac_f32 v125, v6, v87
  v_lshlrev_b32 v5, 16, v47
  v_and_b32 v6, 0xffff0000, v47
  v_fmac_f32 v102, v5, v84
  v_fmac_f32 v103, v6, v84
  v_fmac_f32 v110, v5, v85
  v_fmac_f32 v111, v6, v85
  v_fmac_f32 v118, v5, v86
  v_fmac_f32 v119, v6, v86
  v_fmac_f32 v126, v5, v87
  v_fmac_f32 v127, v6, v87
  v_lshlrev_b32 v5, 16, v48
  v_and_b32 v6, 0xffff0000, v48
  v_fmac_f32 v96, v5, v88
  v_fmac_f32 v97, v6, v88
  v_fmac_f32 v104, v5, v89
  v_fmac_f32 v105, v6, v89
  v_fmac_f32 v112, v5, v90
  v_fmac_f32 v113, v6, v90
  v_fmac_f32 v120, v5, v91
  v_fmac_f32 v121, v6, v91
  v_lshlrev_b32 v5, 16, v49
  v_and_b32 v6, 0xffff0000, v49
  v_fmac_f32 v98, v5, v88
  v_fmac_f32 v99, v6, v88
  v_fmac_f32 v106, v5, v89
  v_fmac_f32 v107, v6, v89
  v_fmac_f32 v114, v5, v90
  v_fmac_f32 v115, v6, v90
  v_fmac_f32 v122, v5, v91
  v_fmac_f32 v123, v6, v91
  v_lshlrev_b32 v5, 16, v50
  v_and_b32 v6, 0xffff0000, v50
  v_fmac_f32 v100, v5, v88
  v_fmac_f32 v101, v6, v88
  v_fmac_f32 v108, v5, v89
  v_fmac_f32 v109, v6, v89
  v_fmac_f32 v116, v5, v90
  v_fmac_f32 v117, v6, v90
  v_fmac_f32 v124, v5, v91
  v_fmac_f32 v125, v6, v91
  v_lshlrev_b32 v5, 16, v51
  v_and_b32 v6, 0xffff0000, v51
  v_fmac_f32 v102, v5, v88
  v_fmac_f32 v103, v6, v88
  v_fmac_f32 v110, v5, v89
  v_fmac_f32 v111, v6, v89
  v_fmac_f32 v118, v5, v90
  v_fmac_f32 v119, v6, v90
  v_fmac_f32 v126, v5, v91
  v_fmac_f32 v127, v6, v91
  s_nop 1
  v_permlane32_swap_b32 v96, v112
  v_permlane32_swap_b32 v97, v113
  v_permlane32_swap_b32 v98, v114
  v_permlane32_swap_b32 v99, v115
  v_permlane32_swap_b32 v100, v116
  v_permlane32_swap_b32 v101, v117
  v_permlane32_swap_b32 v102, v118
  v_permlane32_swap_b32 v103, v119
  v_permlane32_swap_b32 v104, v120
  v_permlane32_swap_b32 v105, v121
  v_permlane32_swap_b32 v106, v122
  v_permlane32_swap_b32 v107, v123
  v_permlane32_swap_b32 v108, v124
  v_permlane32_swap_b32 v109, v125
  v_permlane32_swap_b32 v110, v126
  v_permlane32_swap_b32 v111, v127
  s_nop 0
  v_add_f32 v96, v96, v112
  v_add_f32 v97, v97, v113
  v_add_f32 v98, v98, v114
  v_add_f32 v99, v99, v115
  v_add_f32 v100, v100, v116
  v_add_f32 v101, v101, v117
  v_add_f32 v102, v102, v118
  v_add_f32 v103, v103, v119
  v_add_f32 v104, v104, v120
  v_add_f32 v105, v105, v121
  v_add_f32 v106, v106, v122
  v_add_f32 v107, v107, v123
  v_add_f32 v108, v108, v124
  v_add_f32 v109, v109, v125
  v_add_f32 v110, v110, v126
  v_add_f32 v111, v111, v127
  s_nop 1
  v_permlane16_swap_b32 v96, v104
  v_permlane16_swap_b32 v97, v105
  v_permlane16_swap_b32 v98, v106
  v_permlane16_swap_b32 v99, v107
  v_permlane16_swap_b32 v100, v108
  v_permlane16_swap_b32 v101, v109
  v_permlane16_swap_b32 v102, v110
  v_permlane16_swap_b32 v103, v111
  s_nop 0
  v_add_f32 v96, v96, v104
  v_add_f32 v97, v97, v105
  v_add_f32 v98, v98, v106
  v_add_f32 v99, v99, v107
  v_add_f32 v100, v100, v108
  v_add_f32 v101, v101, v109
  v_add_f32 v102, v102, v110
  v_add_f32 v103, v103, v111
  s_nop 1
  v_add_f32_dpp v96, v96, v96 row_ror:8 row_mask:0xf bank_mask:0x3
  v_add_f32_dpp v97, v97, v97 row_ror:8 row_mask:0xf bank_mask:0x3
  v_add_f32_dpp v98, v98, v98 row_ror:8 row_mask:0xf bank_mask:0x3
  v_add_f32_dpp v99, v99, v99 row_ror:8 row_mask:0xf bank_mask:0x3
  v_add_f32_dpp v96, v100, v100 row_ror:8 row_mask:0xf bank_mask:0xc
  v_add_f32_dpp v97, v101, v101 row_ror:8 row_mask:0xf bank_mask:0xc
  v_add_f32_dpp v98, v102, v102 row_ror:8 row_mask:0xf bank_mask:0xc
  v_add_f32_dpp v99, v103, v103 row_ror:8 row_mask:0xf bank_mask:0xc
  s_nop 1
  v_add_f32_dpp v96, v96, v96 row_shl:4 row_mask:0xf bank_mask:0x5
  v_add_f32_dpp v97, v97, v97 row_shl:4 row_mask:0xf bank_mask:0x5
  v_add_f32_dpp v96, v98, v98 row_shr:4 row_mask:0xf bank_mask:0xa
  v_add_f32_dpp v97, v99, v99 row_shr:4 row_mask:0xf bank_mask:0xa
  v_lshrrev_b32 v5, 4, v1
  v_lshlrev_b32 v5, 7, v5
  v_and_b32 v6, 3, v1
  v_lshlrev_b32 v6, 5, v6
  v_add_u32 v5, v5, v6
  v_bfe_u32 v6, v1, 2, 2
  v_lshlrev_b32 v6, 3, v6
  v_add_u32 v5, v5, v6
  s_lshl_b32 s64, s60, 9
  v_add_u32 v5, s64, v5
  s_lshl_b32 s64, s61, 10
  v_add_u32 v5, s64, v5
  ds_write_b64 v5, v[96:97] offset:22528
  s_waitcnt lgkmcnt(0)
  s_barrier
  s_cmp_lt_u32 s59, 2
  s_cbranch_scc0 L_b_noact
  v_lshlrev_b32 v5, 2, v0
  ds_read_b32 v32, v5 offset:22528
  ds_read_b32 v40, v5 offset:23040
  ds_read_b32 v33, v5 offset:23552
  ds_read_b32 v41, v5 offset:24064
  ds_read_b32 v34, v5 offset:24576
  ds_read_b32 v42, v5 offset:25088
  ds_read_b32 v35, v5 offset:25600
  ds_read_b32 v43, v5 offset:26112
  ds_read_b32 v36, v5 offset:26624
  ds_read_b32 v44, v5 offset:27136
  ds_read_b32 v37, v5 offset:27648
  ds_read_b32 v45, v5 offset:28160
  ds_read_b32 v38, v5 offset:28672
  ds_read_b32 v46, v5 offset:29184
  ds_read_b32 v39, v5 offset:29696
  ds_read_b32 v47, v5 offset:30208
  s_waitcnt lgkmcnt(0)
  v_add_f32 v32, v32, v36
  v_add_f32 v33, v33, v37
  v_add_f32 v34, v34, v38
  v_add_f32 v35, v35, v39
  v_add_f32 v32, v32, v34
  v_add_f32 v33, v33, v35
  v_add_f32 v12, v32, v33
  v_add_f32 v40, v40, v44
  v_add_f32 v41, v41, v45
  v_add_f32 v42, v42, v46
  v_add_f32 v43, v43, v47
  v_add_f32 v40, v40, v42
  v_add_f32 v41, v41, v43
  v_add_f32 v13, v40, v41
  v_cvt_pk_bf16_f32 v12, v12, v12
  v_lshlrev_b32 v12, 16, v12
  v_cvt_pk_bf16_f32 v13, v13, v13
  v_lshlrev_b32 v13, 16, v13
  v_mul_f32 v15, s83, v12
  v_sub_f32 v15, 0, v15
  v_exp_f32 v15, v15
  s_nop 0
  v_add_f32 v15, 1.0, v15
  v_rcp_f32 v14, v15
  s_nop 0
  v_fma_f32 v15, -v15, v14, 1.0
  v_fma_f32 v14, v15, v14, v14
  v_mul_f32 v14, v14, v12
  v_cvt_pk_bf16_f32 v14, v14, v14
  v_lshlrev_b32 v14, 16, v14
  v_mul_f32 v14, v14, v13
  v_cvt_pk_bf16_f32 v14, v14, v14
  v_lshlrev_b32 v14, 16, v14
  v_and_b32 v5, 31, v0
  v_lshlrev_b32 v5, 4, v5
  v_lshrrev_b32 v6, 5, v0
  v_lshlrev_b32 v6, 2, v6
  v_add_u32 v5, v5, v6
  ds_write_b32 v5, v14 offset:21504
L_b_noact:
  s_waitcnt lgkmcnt(0)
  s_barrier
  s_cmp_lt_u32 s59, 8
  s_cbranch_scc0 L_b_nodown1
  s_lshl_b32 s64, s59, 6
  v_mov_b32 v5, s64
  ds_read_b128 v[72:75], v5 offset:21504
  ds_read_b128 v[76:79], v5 offset:21520
  ds_read_b128 v[80:83], v5 offset:21536
  ds_read_b128 v[84:87], v5 offset:21552
  v_mov_b32 v88, 0
  v_mov_b32 v89, 0
  v_mov_b32 v90, 0
  v_mov_b32 v91, 0
  v_mov_b32 v92, 0
  v_mov_b32 v93, 0
  v_mov_b32 v94, 0
  v_mov_b32 v95, 0
  v_mov_b32 v96, 0
  v_mov_b32 v97, 0
  v_mov_b32 v98, 0
  v_mov_b32 v99, 0
  v_mov_b32 v100, 0
  v_mov_b32 v101, 0
  v_mov_b32 v102, 0
  v_mov_b32 v103, 0
  v_mov_b32 v104, 0
  v_mov_b32 v105, 0
  v_mov_b32 v106, 0
  v_mov_b32 v107, 0
  v_mov_b32 v108, 0
  v_mov_b32 v109, 0
  v_mov_b32 v110, 0
  v_mov_b32 v111, 0
  v_mov_b32 v112, 0
  v_mov_b32 v113, 0
  v_mov_b32 v114, 0
  v_mov_b32 v115, 0
  v_mov_b32 v116, 0
  v_mov_b32 v117, 0
  v_mov_b32 v118, 0
  v_mov_b32 v119, 0
  v_mov_b32 v120, 0
  v_mov_b32 v121, 0
  v_mov_b32 v122, 0
  v_mov_b32 v123, 0
  v_mov_b32 v124, 0
  v_mov_b32 v125, 0
  v_mov_b32 v126, 0
  v_mov_b32 v127, 0
  s_waitcnt vmcnt(0) lgkmcnt(0)
  v_lshlrev_b32 v5, 16, v52
  v_and_b32 v6, 0xffff0000, v52
  v_fmac_f32 v88, v5, v72
  v_fmac_f32 v89, v6, v72
  v_fmac_f32 v98, v5, v73
  v_fmac_f32 v99, v6, v73
  v_fmac_f32 v108, v5, v74
  v_fmac_f32 v109, v6, v74
  v_fmac_f32 v118, v5, v75
  v_fmac_f32 v119, v6, v75
  v_lshlrev_b32 v5, 16, v53
  v_and_b32 v6, 0xffff0000, v53
  v_fmac_f32 v90, v5, v72
  v_fmac_f32 v91, v6, v72
  v_fmac_f32 v100, v5, v73
  v_fmac_f32 v101, v6, v73
  v_fmac_f32 v110, v5, v74
  v_fmac_f32 v111, v6, v74
  v_fmac_f32 v120, v5, v75
  v_fmac_f32 v121, v6, v75
  v_lshlrev_b32 v5, 16, v54
  v_and_b32 v6, 0xffff0000, v54
  v_fmac_f32 v92, v5, v72
  v_fmac_f32 v93, v6, v72
  v_fmac_f32 v102, v5, v73
  v_fmac_f32 v103, v6, v73
  v_fmac_f32 v112, v5, v74
  v_fmac_f32 v113, v6, v74
  v_fmac_f32 v122, v5, v75
  v_fmac_f32 v123, v6, v75
  v_lshlrev_b32 v5, 16, v55
  v_and_b32 v6, 0xffff0000, v55
  v_fmac_f32 v94, v5, v72
  v_fmac_f32 v95, v6, v72
  v_fmac_f32 v104, v5, v73
  v_fmac_f32 v105, v6, v73
  v_fmac_f32 v114, v5, v74
  v_fmac_f32 v115, v6, v74
  v_fmac_f32 v124, v5, v75
  v_fmac_f32 v125, v6, v75
  v_lshlrev_b32 v5, 16, v68
  v_and_b32 v6, 0xffff0000, v68
  v_fmac_f32 v96, v5, v72
  v_fmac_f32 v97, v6, v72
  v_fmac_f32 v106, v5, v73
  v_fmac_f32 v107, v6, v73
  v_fmac_f32 v116, v5, v74
  v_fmac_f32 v117, v6, v74
  v_fmac_f32 v126, v5, v75
  v_fmac_f32 v127, v6, v75
  v_lshlrev_b32 v5, 16, v56
  v_and_b32 v6, 0xffff0000, v56
  v_fmac_f32 v88, v5, v76
  v_fmac_f32 v89, v6, v76
  v_fmac_f32 v98, v5, v77
  v_fmac_f32 v99, v6, v77
  v_fmac_f32 v108, v5, v78
  v_fmac_f32 v109, v6, v78
  v_fmac_f32 v118, v5, v79
  v_fmac_f32 v119, v6, v79
  v_lshlrev_b32 v5, 16, v57
  v_and_b32 v6, 0xffff0000, v57
  v_fmac_f32 v90, v5, v76
  v_fmac_f32 v91, v6, v76
  v_fmac_f32 v100, v5, v77
  v_fmac_f32 v101, v6, v77
  v_fmac_f32 v110, v5, v78
  v_fmac_f32 v111, v6, v78
  v_fmac_f32 v120, v5, v79
  v_fmac_f32 v121, v6, v79
  v_lshlrev_b32 v5, 16, v58
  v_and_b32 v6, 0xffff0000, v58
  v_fmac_f32 v92, v5, v76
  v_fmac_f32 v93, v6, v76
  v_fmac_f32 v102, v5, v77
  v_fmac_f32 v103, v6, v77
  v_fmac_f32 v112, v5, v78
  v_fmac_f32 v113, v6, v78
  v_fmac_f32 v122, v5, v79
  v_fmac_f32 v123, v6, v79
  v_lshlrev_b32 v5, 16, v59
  v_and_b32 v6, 0xffff0000, v59
  v_fmac_f32 v94, v5, v76
  v_fmac_f32 v95, v6, v76
  v_fmac_f32 v104, v5, v77
  v_fmac_f32 v105, v6, v77
  v_fmac_f32 v114, v5, v78
  v_fmac_f32 v115, v6, v78
  v_fmac_f32 v124, v5, v79
  v_fmac_f32 v125, v6, v79
  v_lshlrev_b32 v5, 16, v69
  v_and_b32 v6, 0xffff0000, v69
  v_fmac_f32 v96, v5, v76
  v_fmac_f32 v97, v6, v76
  v_fmac_f32 v106, v5, v77
  v_fmac_f32 v107, v6, v77
  v_fmac_f32 v116, v5, v78
  v_fmac_f32 v117, v6, v78
  v_fmac_f32 v126, v5, v79
  v_fmac_f32 v127, v6, v79
  v_lshlrev_b32 v5, 16, v60
  v_and_b32 v6, 0xffff0000, v60
  v_fmac_f32 v88, v5, v80
  v_fmac_f32 v89, v6, v80
  v_fmac_f32 v98, v5, v81
  v_fmac_f32 v99, v6, v81
  v_fmac_f32 v108, v5, v82
  v_fmac_f32 v109, v6, v82
  v_fmac_f32 v118, v5, v83
  v_fmac_f32 v119, v6, v83
  v_lshlrev_b32 v5, 16, v61
  v_and_b32 v6, 0xffff0000, v61
  v_fmac_f32 v90, v5, v80
  v_fmac_f32 v91, v6, v80
  v_fmac_f32 v100, v5, v81
  v_fmac_f32 v101, v6, v81
  v_fmac_f32 v110, v5, v82
  v_fmac_f32 v111, v6, v82
  v_fmac_f32 v120, v5, v83
  v_fmac_f32 v121, v6, v83
  v_lshlrev_b32 v5, 16, v62
  v_and_b32 v6, 0xffff0000, v62
  v_fmac_f32 v92, v5, v80
  v_fmac_f32 v93, v6, v80
  v_fmac_f32 v102, v5, v81
  v_fmac_f32 v103, v6, v81
  v_fmac_f32 v112, v5, v82
  v_fmac_f32 v113, v6, v82
  v_fmac_f32 v122, v5, v83
  v_fmac_f32 v123, v6, v83
  v_lshlrev_b32 v5, 16, v63
  v_and_b32 v6, 0xffff0000, v63
  v_fmac_f32 v94, v5, v80
  v_fmac_f32 v95, v6, v80
  v_fmac_f32 v104, v5, v81
  v_fmac_f32 v105, v6, v81
  v_fmac_f32 v114, v5, v82
  v_fmac_f32 v115, v6, v82
  v_fmac_f32 v124, v5, v83
  v_fmac_f32 v125, v6, v83
  v_lshlrev_b32 v5, 16, v70
  v_and_b32 v6, 0xffff0000, v70
  v_fmac_f32 v96, v5, v80
  v_fmac_f32 v97, v6, v80
  v_fmac_f32 v106, v5, v81
  v_fmac_f32 v107, v6, v81
  v_fmac_f32 v116, v5, v82
  v_fmac_f32 v117, v6, v82
  v_fmac_f32 v126, v5, v83
  v_fmac_f32 v127, v6, v83
  v_lshlrev_b32 v5, 16, v64
  v_and_b32 v6, 0xffff0000, v64
  v_fmac_f32 v88, v5, v84
  v_fmac_f32 v89, v6, v84
  v_fmac_f32 v98, v5, v85
  v_fmac_f32 v99, v6, v85
  v_fmac_f32 v108, v5, v86
  v_fmac_f32 v109, v6, v86
  v_fmac_f32 v118, v5, v87
  v_fmac_f32 v119, v6, v87
  v_lshlrev_b32 v5, 16, v65
  v_and_b32 v6, 0xffff0000, v65
  v_fmac_f32 v90, v5, v84
  v_fmac_f32 v91, v6, v84
  v_fmac_f32 v100, v5, v85
  v_fmac_f32 v101, v6, v85
  v_fmac_f32 v110, v5, v86
  v_fmac_f32 v111, v6, v86
  v_fmac_f32 v120, v5, v87
  v_fmac_f32 v121, v6, v87
  v_lshlrev_b32 v5, 16, v66
  v_and_b32 v6, 0xffff0000, v66
  v_fmac_f32 v92, v5, v84
  v_fmac_f32 v93, v6, v84
  v_fmac_f32 v102, v5, v85
  v_fmac_f32 v103, v6, v85
  v_fmac_f32 v112, v5, v86
  v_fmac_f32 v113, v6, v86
  v_fmac_f32 v122, v5, v87
  v_fmac_f32 v123, v6, v87
  v_lshlrev_b32 v5, 16, v67
  v_and_b32 v6, 0xffff0000, v67
  v_fmac_f32 v94, v5, v84
  v_fmac_f32 v95, v6, v84
  v_fmac_f32 v104, v5, v85
  v_fmac_f32 v105, v6, v85
  v_fmac_f32 v114, v5, v86
  v_fmac_f32 v115, v6, v86
  v_fmac_f32 v124, v5, v87
  v_fmac_f32 v125, v6, v87
  v_lshlrev_b32 v5, 16, v71
  v_and_b32 v6, 0xffff0000, v71
  v_fmac_f32 v96, v5, v84
  v_fmac_f32 v97, v6, v84
  v_fmac_f32 v106, v5, v85
  v_fmac_f32 v107, v6, v85
  v_fmac_f32 v116, v5, v86
  v_fmac_f32 v117, v6, v86
  v_fmac_f32 v126, v5, v87
  v_fmac_f32 v127, v6, v87
  s_mul_i32 s64, s59, 10240
  v_lshlrev_b32 v5, 5, v1
  v_add_u32 v5, s64, v5
  v_lshlrev_b32 v6, 3, v1
  v_add_u32 v6, s64, v6
  ds_write_b128 v5, v[88:91] offset:30720
  ds_write_b128 v5, v[92:95] offset:30736
  ds_write_b64 v6, v[96:97] offset:32768
  ds_write_b128 v5, v[98:101] offset:33280
  ds_write_b128 v5, v[102:105] offset:33296
  ds_write_b64 v6, v[106:107] offset:35328
  ds_write_b128 v5, v[108:111] offset:35840
  ds_write_b128 v5, v[112:115] offset:35856
  ds_write_b64 v6, v[116:117] offset:37888
  ds_write_b128 v5, v[118:121] offset:38400
  ds_write_b128 v5, v[122:125] offset:38416
  ds_write_b64 v6, v[126:127] offset:40448
L_b_nodown1:
  s_waitcnt lgkmcnt(0)
  s_barrier
  s_mov_b32 s64, 16384
  v_lshlrev_b32 v5, 2, v0
  v_add_u32 v6, 30720, v5
  ds_read_b32 v32, v6 offset:0
  ds_read_b32 v33, v6 offset:10240
  ds_read_b32 v34, v6 offset:20480
  ds_read_b32 v35, v6 offset:30720
  ds_read_b32 v36, v6 offset:40960
  ds_read_b32 v37, v6 offset:51200
  v_add_u32 v7, 61440, v6
  ds_read_b32 v38, v7
  v_add_u32 v7, 71680, v6
  ds_read_b32 v39, v7
  v_add_u32 v6, 34816, v5
  ds_read_b32 v40, v6 offset:0
  ds_read_b32 v41, v6 offset:10240
  ds_read_b32 v42, v6 offset:20480
  ds_read_b32 v43, v6 offset:30720
  ds_read_b32 v44, v6 offset:40960
  ds_read_b32 v45, v6 offset:51200
  v_add_u32 v7, 61440, v6
  ds_read_b32 v46, v7
  v_add_u32 v7, 71680, v6
  ds_read_b32 v47, v7
  v_add_u32 v6, 38912, v5
  ds_read_b32 v48, v6 offset:0
  ds_read_b32 v49, v6 offset:10240
  ds_read_b32 v50, v6 offset:20480
  ds_read_b32 v51, v6 offset:30720
  ds_read_b32 v52, v6 offset:40960
  ds_read_b32 v53, v6 offset:51200
  v_add_u32 v7, 61440, v6
  ds_read_b32 v54, v7
  v_add_u32 v7, 71680, v6
  ds_read_b32 v55, v7
  s_waitcnt lgkmcnt(0)
  v_add_f32 v32, v32, v36
  v_add_f32 v33, v33, v37
  v_add_f32 v34, v34, v38
  v_add_f32 v35, v35, v39
  v_add_f32 v32, v32, v34
  v_add_f32 v33, v33, v35
  v_add_f32 v12, v32, v33
  v_add_f32 v40, v40, v44
  v_add_f32 v41, v41, v45
  v_add_f32 v42, v42, v46
  v_add_f32 v43, v43, v47
  v_add_f32 v40, v40, v42
  v_add_f32 v41, v41, v43
  v_add_f32 v13, v40, v41
  v_add_f32 v48, v48, v52
  v_add_f32 v49, v49, v53
  v_add_f32 v50, v50, v54
  v_add_f32 v51, v51, v55
  v_add_f32 v48, v48, v50
  v_add_f32 v49, v49, v51
  v_add_f32 v14, v48, v49
  buffer_atomic_add_f32 v12, v5, s[48:51], s64 offen
  s_mov_b32 s64, 20480
  s_nop 0
  buffer_atomic_add_f32 v13, v5, s[48:51], s64 offen
  s_cmp_lt_u32 s59, 8
  s_cbranch_scc0 L_b_noat
  s_mov_b32 s64, 24576
  s_nop 0
  buffer_atomic_add_f32 v14, v5, s[48:51], s64 offen
L_b_noat:
  s_waitcnt vmcnt(0)
  s_barrier
  s_cmp_eq_u32 s59, 0
  s_cbranch_scc0 L_b_noctr
  v_mov_b32 v5, 1
  v_mov_b32 v6, 0
  s_mov_b64 exec, 1
  buffer_atomic_add v5, v6, s[44:47], 0 offen sc0 sc1
  s_waitcnt vmcnt(0)
  ds_write_b32 v6, v5 offset:22032
  s_mov_b64 exec, -1
L_b_noctr:
  s_waitcnt lgkmcnt(0)
  s_barrier
  v_mov_b32 v6, 0
  ds_read_b32 v5, v6 offset:22032
  s_waitcnt lgkmcnt(0)
  v_readfirstlane_b32 s64, v5
  s_nop 3
  s_cmp_eq_u32 s64, 47
  s_cbranch_scc0 L_endB
  v_add_u32 v20, 0, v0
  v_lshlrev_b32 v5, 2, v20
  s_mov_b32 s64, 16384
  s_nop 0
  buffer_load_dword v12, v5, s[48:51], s64 offen sc0 sc1
  ds_read_b32 v13, v5 offset:10240
  v_mov_b32 v6, 0
  v_cmp_le_u32 vcc, 640, v20
  s_nop 1
  v_addc_co_u32 v6, vcc, 0, v6, vcc
  v_cmp_le_u32 vcc, 1280, v20
  s_nop 1
  v_addc_co_u32 v6, vcc, 0, v6, vcc
  v_cmp_le_u32 vcc, 1920, v20
  s_nop 1
  v_addc_co_u32 v6, vcc, 0, v6, vcc
  v_mul_u32_u24 v7, 640, v6
  v_sub_u32 v7, v20, v7
  v_lshlrev_b32 v7, 4, v7
  v_lshlrev_b32 v6, 2, v6
  v_add_u32 v7, v7, v6
  ds_read_b32 v14, v7 offset:0
  ds_read_b32 v15, v6 offset:22016
  s_waitcnt vmcnt(0) lgkmcnt(0)
  v_cvt_pk_bf16_f32 v12, v12, v12
  v_lshlrev_b32 v12, 16, v12
  v_mul_f32 v12, v12, v15
  v_cvt_pk_bf16_f32 v12, v12, v12
  v_lshlrev_b32 v12, 16, v12
  v_add_f32 v12, v12, v14
  v_cvt_pk_bf16_f32 v12, v12, v12
  v_lshlrev_b32 v12, 16, v12
  v_add_f32 v12, v12, v13
  v_cvt_pk_bf16_f32 v12, v12, v12
  v_lshlrev_b32 v5, 1, v20
  buffer_store_short v12, v5, s[72:75], 0 offen
  v_add_u32 v20, 1024, v0
  v_lshlrev_b32 v5, 2, v20
  s_mov_b32 s64, 16384
  s_nop 0
  buffer_load_dword v12, v5, s[48:51], s64 offen sc0 sc1
  ds_read_b32 v13, v5 offset:10240
  v_mov_b32 v6, 0
  v_cmp_le_u32 vcc, 640, v20
  s_nop 1
  v_addc_co_u32 v6, vcc, 0, v6, vcc
  v_cmp_le_u32 vcc, 1280, v20
  s_nop 1
  v_addc_co_u32 v6, vcc, 0, v6, vcc
  v_cmp_le_u32 vcc, 1920, v20
  s_nop 1
  v_addc_co_u32 v6, vcc, 0, v6, vcc
  v_mul_u32_u24 v7, 640, v6
  v_sub_u32 v7, v20, v7
  v_lshlrev_b32 v7, 4, v7
  v_lshlrev_b32 v6, 2, v6
  v_add_u32 v7, v7, v6
  ds_read_b32 v14, v7 offset:0
  ds_read_b32 v15, v6 offset:22016
  s_waitcnt vmcnt(0) lgkmcnt(0)
  v_cvt_pk_bf16_f32 v12, v12, v12
  v_lshlrev_b32 v12, 16, v12
  v_mul_f32 v12, v12, v15
  v_cvt_pk_bf16_f32 v12, v12, v12
  v_lshlrev_b32 v12, 16, v12
  v_add_f32 v12, v12, v14
  v_cvt_pk_bf16_f32 v12, v12, v12
  v_lshlrev_b32 v12, 16, v12
  v_add_f32 v12, v12, v13
  v_cvt_pk_bf16_f32 v12, v12, v12
  v_lshlrev_b32 v5, 1, v20
  buffer_store_short v12, v5, s[72:75], 0 offen
  s_cmp_lt_u32 s59, 8
  s_cbranch_scc0 L_endB
  v_add_u32 v20, 2048, v0
  v_lshlrev_b32 v5, 2, v20
  s_mov_b32 s64, 16384
  s_nop 0
  buffer_load_dword v12, v5, s[48:51], s64 offen sc0 sc1
  ds_read_b32 v13, v5 offset:10240
  v_mov_b32 v6, 0
  v_cmp_le_u32 vcc, 640, v20
  s_nop 1
  v_addc_co_u32 v6, vcc, 0, v6, vcc
  v_cmp_le_u32 vcc, 1280, v20
  s_nop 1
  v_addc_co_u32 v6, vcc, 0, v6, vcc
  v_cmp_le_u32 vcc, 1920, v20
  s_nop 1
  v_addc_co_u32 v6, vcc, 0, v6, vcc
  v_mul_u32_u24 v7, 640, v6
  v_sub_u32 v7, v20, v7
  v_lshlrev_b32 v7, 4, v7
  v_lshlrev_b32 v6, 2, v6
  v_add_u32 v7, v7, v6
  ds_read_b32 v14, v7 offset:0
  ds_read_b32 v15, v6 offset:22016
  s_waitcnt vmcnt(0) lgkmcnt(0)
  v_cvt_pk_bf16_f32 v12, v12, v12
  v_lshlrev_b32 v12, 16, v12
  v_mul_f32 v12, v12, v15
  v_cvt_pk_bf16_f32 v12, v12, v12
  v_lshlrev_b32 v12, 16, v12
  v_add_f32 v12, v12, v14
  v_cvt_pk_bf16_f32 v12, v12, v12
  v_lshlrev_b32 v12, 16, v12
  v_add_f32 v12, v12, v13
  v_cvt_pk_bf16_f32 v12, v12, v12
  v_lshlrev_b32 v5, 1, v20
  buffer_store_short v12, v5, s[72:75], 0 offen
L_endB:
  s_endpgm
.section .rodata,"a"
.p2align 6
.amdhsa_kernel attn_kernel
  .amdhsa_next_free_vgpr 256
  .amdhsa_next_free_sgpr 100
  .amdhsa_accum_offset 256
  .amdhsa_group_segment_fixed_size 0
  .amdhsa_kernarg_size 104
  .amdhsa_user_sgpr_count 2
  .amdhsa_user_sgpr_kernarg_segment_ptr 1
  .amdhsa_system_sgpr_workgroup_id_x 1
.end_amdhsa_kernel

.p2align 6
.amdhsa_kernel mlp_kernel
  .amdhsa_next_free_vgpr 128
  .amdhsa_next_free_sgpr 100
  .amdhsa_accum_offset 128
  .amdhsa_group_segment_fixed_size 0
  .amdhsa_kernarg_size 104
  .amdhsa_user_sgpr_count 2
  .amdhsa_user_sgpr_kernarg_segment_ptr 1
  .amdhsa_system_sgpr_workgroup_id_x 1
.end_amdhsa_kernel
```

```asm
; @launch kernel=attn_kernel grid=(256,1,1) block=(512,1,1) lds=150016
.amdgcn_target "amdgcn-amd-amdhsa--gfx950"
.text
.globl attn_kernel
.p2align 8
.type attn_kernel,@function
attn_kernel:
  s_cmp_ge_u32 s2, 256
  s_cbranch_scc1 L_endA
  s_load_dwordx8 s[8:15], s[0:1], 0
  s_load_dwordx2 s[16:17], s[0:1], 32
  s_load_dwordx4 s[20:23], s[0:1], 88
  v_and_b32 v1, 63, v0
  v_lshrrev_b32 v5, 6, v0
  s_nop 0
  v_readfirstlane_b32 s59, v5
  s_and_b32 s64, s2, 1
  s_lshr_b32 s56, s2, 4
  s_lshl_b32 s56, s56, 1
  s_add_u32 s56, s56, s64
  s_bfe_u32 s57, s2, 0x10003
  s_bfe_u32 s58, s2, 0x20001
  v_mul_u32_u24 v2, 12, v1
  s_mov_b32 s82, 0x3d93cd3a
  s_mov_b32 s83, 0x3fb8aa3b
  s_mov_b32 s80, 0x11111111
  s_mov_b32 s81, 0x11111111
  s_lshl_b32 s65, s57, 6
  s_add_u32 s65, s65, s56
  s_add_u32 s66, s65, 32
  s_mul_i32 s67, s58, 786432
  s_mul_i32 s68, s59, 768
  s_add_u32 s67, s67, s68
  s_mul_i32 s60, s65, 3145728
  s_add_u32 s60, s60, s67
  s_add_u32 s61, s60, 100663296
  s_lshl_b32 s68, s58, 3
  s_lshl_b32 s74, s65, 7
  s_add_u32 s74, s74, 32768
  s_add_u32 s75, s74, 4096
  s_add_u32 s72, s74, s68
  s_add_u32 s73, s75, s68
  s_lshr_b32 s76, s65, 2
  s_lshl_b32 s76, s76, 2
  s_add_u32 s77, s76, 32
  s_and_b32 s78, s56, 3
  s_lshl_b32 s78, s78, 3
  s_lshl_b32 s79, 1, s78
  s_waitcnt lgkmcnt(0)
  s_mov_b32 s24, s8
  s_mov_b32 s25, s9
  s_mov_b32 s26, 5120
  s_mov_b32 s27, 0x00020000
  s_mov_b32 s28, s10
  s_mov_b32 s29, s11
  s_mov_b32 s30, 402653184
  s_mov_b32 s31, 0x00020000
  s_mov_b32 s32, s12
  s_mov_b32 s33, s13
  s_mov_b32 s34, 402653184
  s_mov_b32 s35, 0x00020000
  s_mov_b32 s36, s14
  s_mov_b32 s37, s15
  s_mov_b32 s38, 7864320
  s_mov_b32 s39, 0x00020000
  s_mov_b32 s40, s16
  s_mov_b32 s41, s17
  s_mov_b32 s42, 7864320
  s_mov_b32 s43, 0x00020000
  s_mov_b32 s44, s20
  s_mov_b32 s45, s21
  s_mov_b32 s46, 256
  s_mov_b32 s47, 0x00020000
  s_mov_b32 s48, s22
  s_mov_b32 s49, s23
  s_mov_b32 s50, 16777216
  s_mov_b32 s51, 0x00020000
  s_mul_i32 s8, s66, 3145728
  s_mul_i32 s64, s59, 768
  s_add_u32 s8, s8, s64
  s_lshl_b32 s64, s56, 1
  s_add_u32 s64, s64, s57
  s_lshl_b32 s9, s64, 15
  s_lshl_b32 s68, s59, 10
  s_add_u32 s9, s9, s68
  s_add_u32 s9, s9, 131072
  s_lshl_b32 s68, s58, 13
  s_add_u32 s10, s9, s68
  s_lshl_b32 s11, s64, 7
  s_add_u32 s11, s11, 65536
  s_cmp_eq_u32 s2, 0
  s_cbranch_scc0 L_nozero
  s_cmp_eq_u32 s59, 7
  s_cbranch_scc0 L_nozero
  v_mov_b32 v8, 0
  v_mov_b32 v9, 0
  v_mov_b32 v10, 0
  v_mov_b32 v11, 0
  v_lshlrev_b32 v5, 4, v1
  buffer_store_dwordx4 v[8:11], v5, s[48:51], 0 offen offset:0 sc0 sc1
  buffer_store_dwordx4 v[8:11], v5, s[48:51], 0 offen offset:1024 sc0 sc1
  buffer_store_dwordx4 v[8:11], v5, s[48:51], 0 offen offset:2048 sc0 sc1
  buffer_store_dwordx4 v[8:11], v5, s[48:51], 0 offen offset:3072 sc0 sc1
  s_mov_b32 s64, 4096
  buffer_store_dwordx4 v[8:11], v5, s[48:51], s64 offen sc0 sc1
  s_mov_b32 s64, 5120
  buffer_store_dwordx4 v[8:11], v5, s[48:51], s64 offen sc0 sc1
  s_mov_b32 s64, 6144
  buffer_store_dwordx4 v[8:11], v5, s[48:51], s64 offen sc0 sc1
  s_mov_b32 s64, 7168
  buffer_store_dwordx4 v[8:11], v5, s[48:51], s64 offen sc0 sc1
  s_mov_b32 s64, 8192
  buffer_store_dwordx4 v[8:11], v5, s[48:51], s64 offen sc0 sc1
  s_mov_b32 s64, 9216
  buffer_store_dwordx4 v[8:11], v5, s[48:51], s64 offen sc0 sc1
  s_mov_b32 s64, 16384
  buffer_store_dwordx4 v[8:11], v5, s[48:51], s64 offen sc0 sc1
  s_mov_b32 s64, 17408
  buffer_store_dwordx4 v[8:11], v5, s[48:51], s64 offen sc0 sc1
  s_mov_b32 s64, 18432
  buffer_store_dwordx4 v[8:11], v5, s[48:51], s64 offen sc0 sc1
  s_mov_b32 s64, 19456
  buffer_store_dwordx4 v[8:11], v5, s[48:51], s64 offen sc0 sc1
  s_mov_b32 s64, 20480
  buffer_store_dwordx4 v[8:11], v5, s[48:51], s64 offen sc0 sc1
  s_mov_b32 s64, 21504
  buffer_store_dwordx4 v[8:11], v5, s[48:51], s64 offen sc0 sc1
  s_mov_b32 s64, 22528
  buffer_store_dwordx4 v[8:11], v5, s[48:51], s64 offen sc0 sc1
  s_mov_b32 s64, 23552
  buffer_store_dwordx4 v[8:11], v5, s[48:51], s64 offen sc0 sc1
  s_mov_b32 s64, 24576
  buffer_store_dwordx4 v[8:11], v5, s[48:51], s64 offen sc0 sc1
  s_mov_b32 s64, 25600
  buffer_store_dwordx4 v[8:11], v5, s[48:51], s64 offen sc0 sc1
  s_mov_b32 s64, 65536
  buffer_store_dwordx4 v[8:11], v5, s[48:51], s64 offen sc0 sc1
  s_mov_b32 s64, 66560
  buffer_store_dwordx4 v[8:11], v5, s[48:51], s64 offen sc0 sc1
  s_mov_b32 s64, 67584
  buffer_store_dwordx4 v[8:11], v5, s[48:51], s64 offen sc0 sc1
  s_mov_b32 s64, 68608
  buffer_store_dwordx4 v[8:11], v5, s[48:51], s64 offen sc0 sc1
  s_mov_b32 s64, 69632
  buffer_store_dwordx4 v[8:11], v5, s[48:51], s64 offen sc0 sc1
  s_mov_b32 s64, 70656
  buffer_store_dwordx4 v[8:11], v5, s[48:51], s64 offen sc0 sc1
  s_mov_b32 s64, 71680
  buffer_store_dwordx4 v[8:11], v5, s[48:51], s64 offen sc0 sc1
  s_mov_b32 s64, 72704
  buffer_store_dwordx4 v[8:11], v5, s[48:51], s64 offen sc0 sc1
L_nozero:
  v_lshrrev_b32 v5, 4, v1
  v_bfe_u32 v6, v1, 2, 2
  v_and_b32 v7, 1, v6
  v_lshlrev_b32 v7, 1, v7
  v_lshrrev_b32 v6, 1, v6
  v_add_u32 v6, v6, v7
  v_lshlrev_b32 v6, 1, v6
  v_and_b32 v7, 1, v5
  v_add_u32 v6, v6, v7
  v_lshrrev_b32 v5, 1, v5
  v_lshlrev_b32 v5, 9, v5
  v_lshlrev_b32 v6, 2, v6
  v_add_u32 v3, v5, v6
  s_lshl_b32 s64, s59, 10
  v_add_u32 v3, s64, v3
  v_lshlrev_b32 v7, 4, v1
  v_add_u32 v7, s64, v7
  v_mov_b32 v4, 0xff800000
  v_lshrrev_b32 v5, 5, v1
  v_mul_u32_u24 v5, 12288, v5
  v_and_b32 v6, 31, v1
  v_mul_u32_u24 v6, 12, v6
  v_add_u32 v26, v5, v6
  s_mul_i32 s69, s56, 384
  s_mul_i32 s68, s59, 24576
  s_add_u32 s69, s69, s68
  s_cmp_lt_u32 s59, 2
  s_cbranch_scc0 L_ln_done
  s_lshl_b32 s68, s57, 1
  s_add_u32 s64, s59, s68
  s_mul_i32 s64, s64, 1280
  v_lshlrev_b32 v5, 4, v1
  v_lshlrev_b32 v6, 2, v1
  buffer_load_dwordx4 v[28:31], v5, s[24:27], s64 offen
  buffer_load_dword v25, v6, s[24:27], s64 offen offset:1024
  s_waitcnt vmcnt(0)
  v_lshlrev_b32 v8, 16, v28
  v_and_b32 v9, 0xffff0000, v28
  v_lshlrev_b32 v10, 16, v29
  v_and_b32 v11, 0xffff0000, v29
  v_lshlrev_b32 v12, 16, v30
  v_and_b32 v13, 0xffff0000, v30
  v_lshlrev_b32 v14, 16, v31
  v_and_b32 v15, 0xffff0000, v31
  v_lshlrev_b32 v16, 16, v25
  v_and_b32 v17, 0xffff0000, v25
  v_add_f32 v18, v8, v9
  v_add_f32 v18, v18, v10
  v_add_f32 v18, v18, v11
  v_add_f32 v18, v18, v12
  v_add_f32 v18, v18, v13
  v_add_f32 v18, v18, v14
  v_add_f32 v18, v18, v15
  v_add_f32 v18, v18, v16
  v_add_f32 v18, v18, v17
  s_nop 1
  v_add_f32_dpp v18, v18, v18 quad_perm:[1,0,3,2] row_mask:0xf bank_mask:0xf
  s_nop 1
  v_add_f32_dpp v18, v18, v18 quad_perm:[2,3,0,1] row_mask:0xf bank_mask:0xf
  s_nop 1
  v_add_f32_dpp v18, v18, v18 row_half_mirror row_mask:0xf bank_mask:0xf
  s_nop 1
  v_add_f32_dpp v18, v18, v18 row_mirror row_mask:0xf bank_mask:0xf
  v_mov_b32 v19, v18
  s_nop 1
  v_permlane16_swap_b32 v18, v19
  s_nop 1
  v_add_f32 v18, v18, v19
  v_mov_b32 v19, v18
  s_nop 1
  v_permlane32_swap_b32 v18, v19
  s_nop 1
  v_add_f32 v18, v18, v19
  v_mul_f32 v20, 0x3acccccd, v18
  v_sub_f32 v19, v8, v20
  v_mul_f32 v18, v19, v19
  v_sub_f32 v19, v9, v20
  v_fmac_f32 v18, v19, v19
  v_sub_f32 v19, v10, v20
  v_fmac_f32 v18, v19, v19
  v_sub_f32 v19, v11, v20
  v_fmac_f32 v18, v19, v19
  v_sub_f32 v19, v12, v20
  v_fmac_f32 v18, v19, v19
  v_sub_f32 v19, v13, v20
  v_fmac_f32 v18, v19, v19
  v_sub_f32 v19, v14, v20
  v_fmac_f32 v18, v19, v19
  v_sub_f32 v19, v15, v20
  v_fmac_f32 v18, v19, v19
  v_sub_f32 v19, v16, v20
  v_fmac_f32 v18, v19, v19
  v_sub_f32 v19, v17, v20
  v_fmac_f32 v18, v19, v19
  s_nop 1
  v_add_f32_dpp v18, v18, v18 quad_perm:[1,0,3,2] row_mask:0xf bank_mask:0xf
  s_nop 1
  v_add_f32_dpp v18, v18, v18 quad_perm:[2,3,0,1] row_mask:0xf bank_mask:0xf
  s_nop 1
  v_add_f32_dpp v18, v18, v18 row_half_mirror row_mask:0xf bank_mask:0xf
  s_nop 1
  v_add_f32_dpp v18, v18, v18 row_mirror row_mask:0xf bank_mask:0xf
  v_mov_b32 v19, v18
  s_nop 1
  v_permlane16_swap_b32 v18, v19
  s_nop 1
  v_add_f32 v18, v18, v19
  v_mov_b32 v19, v18
  s_nop 1
  v_permlane32_swap_b32 v18, v19
  s_nop 1
  v_add_f32 v18, v18, v19
  v_mul_f32 v21, 0x3acccccd, v18
  v_cvt_pk_bf16_f32 v20, v20, v20
  v_lshlrev_b32 v20, 16, v20
  v_cvt_pk_bf16_f32 v21, v21, v21
  v_lshlrev_b32 v21, 16, v21
  v_add_f32 v21, 0x3727c5ac, v21
  v_cvt_pk_bf16_f32 v21, v21, v21
  v_lshlrev_b32 v21, 16, v21
  v_sqrt_f32 v21, v21
  s_nop 0
  v_cvt_pk_bf16_f32 v21, v21, v21
  v_lshlrev_b32 v21, 16, v21
  v_rcp_f32 v22, v21
  s_nop 0
  v_sub_f32 v8, v8, v20
  v_cvt_pk_bf16_f32 v8, v8, v8
  v_lshlrev_b32 v8, 16, v8
  v_mul_f32 v18, v8, v22
  v_fma_f32 v19, -v18, v21, v8
  v_fma_f32 v8, v19, v22, v18
  v_cvt_pk_bf16_f32 v8, v8, v8
  v_lshlrev_b32 v8, 16, v8
  v_sub_f32 v9, v9, v20
  v_cvt_pk_bf16_f32 v9, v9, v9
  v_lshlrev_b32 v9, 16, v9
  v_mul_f32 v18, v9, v22
  v_fma_f32 v19, -v18, v21, v9
  v_fma_f32 v9, v19, v22, v18
  v_cvt_pk_bf16_f32 v9, v9, v9
  v_lshlrev_b32 v9, 16, v9
  v_sub_f32 v10, v10, v20
  v_cvt_pk_bf16_f32 v10, v10, v10
  v_lshlrev_b32 v10, 16, v10
  v_mul_f32 v18, v10, v22
  v_fma_f32 v19, -v18, v21, v10
  v_fma_f32 v10, v19, v22, v18
  v_cvt_pk_bf16_f32 v10, v10, v10
  v_lshlrev_b32 v10, 16, v10
  v_sub_f32 v11, v11, v20
  v_cvt_pk_bf16_f32 v11, v11, v11
  v_lshlrev_b32 v11, 16, v11
  v_mul_f32 v18, v11, v22
  v_fma_f32 v19, -v18, v21, v11
  v_fma_f32 v11, v19, v22, v18
  v_cvt_pk_bf16_f32 v11, v11, v11
  v_lshlrev_b32 v11, 16, v11
  v_sub_f32 v12, v12, v20
  v_cvt_pk_bf16_f32 v12, v12, v12
  v_lshlrev_b32 v12, 16, v12
  v_mul_f32 v18, v12, v22
  v_fma_f32 v19, -v18, v21, v12
  v_fma_f32 v12, v19, v22, v18
  v_cvt_pk_bf16_f32 v12, v12, v12
  v_lshlrev_b32 v12, 16, v12
  v_sub_f32 v13, v13, v20
  v_cvt_pk_bf16_f32 v13, v13, v13
  v_lshlrev_b32 v13, 16, v13
  v_mul_f32 v18, v13, v22
  v_fma_f32 v19, -v18, v21, v13
  v_fma_f32 v13, v19, v22, v18
  v_cvt_pk_bf16_f32 v13, v13, v13
  v_lshlrev_b32 v13, 16, v13
  v_sub_f32 v14, v14, v20
  v_cvt_pk_bf16_f32 v14, v14, v14
  v_lshlrev_b32 v14, 16, v14
  v_mul_f32 v18, v14, v22
  v_fma_f32 v19, -v18, v21, v14
  v_fma_f32 v14, v19, v22, v18
  v_cvt_pk_bf16_f32 v14, v14, v14
  v_lshlrev_b32 v14, 16, v14
  v_sub_f32 v15, v15, v20
  v_cvt_pk_bf16_f32 v15, v15, v15
  v_lshlrev_b32 v15, 16, v15
  v_mul_f32 v18, v15, v22
  v_fma_f32 v19, -v18, v21, v15
  v_fma_f32 v15, v19, v22, v18
  v_cvt_pk_bf16_f32 v15, v15, v15
  v_lshlrev_b32 v15, 16, v15
  v_sub_f32 v16, v16, v20
  v_cvt_pk_bf16_f32 v16, v16, v16
  v_lshlrev_b32 v16, 16, v16
  v_mul_f32 v18, v16, v22
  v_fma_f32 v19, -v18, v21, v16
  v_fma_f32 v16, v19, v22, v18
  v_cvt_pk_bf16_f32 v16, v16, v16
  v_lshlrev_b32 v16, 16, v16
  v_sub_f32 v17, v17, v20
  v_cvt_pk_bf16_f32 v17, v17, v17
  v_lshlrev_b32 v17, 16, v17
  v_mul_f32 v18, v17, v22
  v_fma_f32 v19, -v18, v21, v17
  v_fma_f32 v17, v19, v22, v18
  v_cvt_pk_bf16_f32 v17, v17, v17
  v_lshlrev_b32 v17, 16, v17
  v_mov_b32 v6, 0
  v_cvt_pk_bf16_f32 v8, v8, v6
  v_cvt_pk_bf16_f32 v9, v9, v6
  v_cvt_pk_bf16_f32 v10, v10, v6
  v_cvt_pk_bf16_f32 v11, v11, v6
  v_cvt_pk_bf16_f32 v12, v12, v6
  v_cvt_pk_bf16_f32 v13, v13, v6
  v_cvt_pk_bf16_f32 v14, v14, v6
  v_cvt_pk_bf16_f32 v15, v15, v6
  v_cvt_pk_bf16_f32 v16, v16, v6
  v_cvt_pk_bf16_f32 v17, v17, v6
  v_and_b32 v5, 1, v1
  v_mul_u32_u24 v5, 1280, v5
  v_lshrrev_b32 v6, 1, v1
  v_lshlrev_b32 v6, 2, v6
  v_add_u32 v5, v5, v6
  s_mul_i32 s64, s59, 2560
  v_add_u32 v5, s64, v5
  ds_write_b32 v5, v8 offset:16384
  ds_write_b32 v5, v9 offset:16544
  ds_write_b32 v5, v10 offset:16704
  ds_write_b32 v5, v11 offset:16864
  ds_write_b32 v5, v12 offset:17024
  ds_write_b32 v5, v13 offset:17184
  ds_write_b32 v5, v14 offset:17344
  ds_write_b32 v5, v15 offset:17504
  v_and_b32 v5, 7, v1
  v_mul_u32_u24 v5, 320, v5
  v_lshrrev_b32 v6, 3, v1
  v_lshlrev_b32 v6, 2, v6
  v_add_u32 v5, v5, v6
  v_add_u32 v5, s64, v5
  ds_write_b32 v5, v16 offset:16512
  ds_write_b32 v5, v17 offset:16672
L_ln_done:
  buffer_load_dwordx3 v[32:34], v26, s[36:39], s69 offen
  s_add_u32 s69, s69, 196608
  buffer_load_dwordx3 v[36:38], v26, s[36:39], s69 offen
  s_add_u32 s69, s69, 196608
  buffer_load_dwordx3 v[40:42], v26, s[36:39], s69 offen
  s_add_u32 s69, s69, 196608
  buffer_load_dwordx3 v[44:46], v26, s[36:39], s69 offen
  s_add_u32 s69, s69, 196608
  buffer_load_dwordx3 v[48:50], v26, s[36:39], s69 offen
  s_add_u32 s69, s69, 196608
  buffer_load_dwordx3 v[52:54], v26, s[36:39], s69 offen
  s_add_u32 s69, s69, 196608
  buffer_load_dwordx3 v[56:58], v26, s[36:39], s69 offen
  s_add_u32 s69, s69, 196608
  buffer_load_dwordx3 v[60:62], v26, s[36:39], s69 offen
  s_add_u32 s69, s69, 196608
  buffer_load_dwordx3 v[64:66], v26, s[36:39], s69 offen
  s_add_u32 s69, s69, 196608
  buffer_load_dwordx3 v[68:70], v26, s[36:39], s69 offen
  s_add_u32 s69, s69, 196608
  buffer_load_dwordx3 v[72:74], v26, s[36:39], s69 offen
  s_add_u32 s69, s69, 196608
  buffer_load_dwordx3 v[76:78], v26, s[36:39], s69 offen
  s_add_u32 s69, s69, 196608
  buffer_load_dwordx3 v[80:82], v26, s[36:39], s69 offen
  s_add_u32 s69, s69, 196608
  buffer_load_dwordx3 v[84:86], v26, s[36:39], s69 offen
  s_add_u32 s69, s69, 196608
  buffer_load_dwordx3 v[88:90], v26, s[36:39], s69 offen
  s_add_u32 s69, s69, 196608
  buffer_load_dwordx3 v[92:94], v26, s[36:39], s69 offen
  s_add_u32 s69, s69, 196608
  buffer_load_dwordx3 v[96:98], v26, s[36:39], s69 offen
  s_add_u32 s69, s69, 196608
  buffer_load_dwordx3 v[100:102], v26, s[36:39], s69 offen
  s_add_u32 s69, s69, 196608
  buffer_load_dwordx3 v[104:106], v26, s[36:39], s69 offen
  s_add_u32 s69, s69, 196608
  buffer_load_dwordx3 v[108:110], v26, s[36:39], s69 offen
  s_add_u32 s69, s69, 196608
  buffer_load_dwordx3 v[112:114], v26, s[36:39], s69 offen
  s_add_u32 s69, s69, 196608
  buffer_load_dwordx3 v[116:118], v26, s[36:39], s69 offen
  s_add_u32 s69, s69, 196608
  buffer_load_dwordx3 v[120:122], v26, s[36:39], s69 offen
  s_add_u32 s69, s69, 196608
  buffer_load_dwordx3 v[124:126], v26, s[36:39], s69 offen
  s_add_u32 s69, s69, 196608
  buffer_load_dwordx3 v[192:194], v26, s[36:39], s69 offen
  s_add_u32 s69, s69, 196608
  buffer_load_dwordx3 v[196:198], v26, s[36:39], s69 offen
  s_add_u32 s69, s69, 196608
  buffer_load_dwordx3 v[200:202], v26, s[36:39], s69 offen
  s_add_u32 s69, s69, 196608
  buffer_load_dwordx3 v[204:206], v26, s[36:39], s69 offen
  s_add_u32 s69, s69, 196608
  buffer_load_dwordx3 v[208:210], v26, s[36:39], s69 offen
  s_add_u32 s69, s69, 196608
  buffer_load_dwordx3 v[212:214], v26, s[36:39], s69 offen
  s_add_u32 s69, s69, 196608
  buffer_load_dwordx3 v[216:218], v26, s[36:39], s69 offen
  s_add_u32 s69, s69, 196608
  buffer_load_dwordx3 v[220:222], v26, s[36:39], s69 offen
  s_add_u32 s69, s69, 196608
  buffer_load_dwordx3 v[224:226], v26, s[36:39], s69 offen
  s_add_u32 s69, s69, 196608
  buffer_load_dwordx3 v[228:230], v26, s[36:39], s69 offen
  s_add_u32 s69, s69, 196608
  buffer_load_dwordx3 v[232:234], v26, s[36:39], s69 offen
  s_add_u32 s69, s69, 196608
  buffer_load_dwordx3 v[236:238], v26, s[36:39], s69 offen
  s_add_u32 s69, s69, 196608
  buffer_load_dwordx3 v[240:242], v26, s[36:39], s69 offen
  s_add_u32 s69, s69, 196608
  buffer_load_dwordx3 v[244:246], v26, s[36:39], s69 offen
  s_add_u32 s69, s69, 196608
  buffer_load_dwordx3 v[248:250], v26, s[36:39], s69 offen
  s_add_u32 s69, s69, 196608
  buffer_load_dwordx3 v[252:254], v26, s[36:39], s69 offen
  s_add_u32 s69, s69, 196608
  s_waitcnt lgkmcnt(0)
  s_barrier
  s_mov_b32 s52, s28
  s_mov_b32 s53, s29
  s_mov_b32 s54, s30
  s_mov_b32 s55, s31
  s_mov_b32 s62, s60
  v_mov_b32 v14, 0
  v_mov_b32 v15, 0
  v_mov_b32 v16, 0
  v_mov_b32 v17, 0
  v_mov_b32 v18, 0
  v_mov_b32 v19, 0
  v_mov_b32 v20, 0
  v_mov_b32 v21, 0
  v_mov_b32 v22, 0
  v_mov_b32 v23, 0
  v_mov_b32 v24, 0
  v_mov_b32 v25, 0
  v_lshrrev_b32 v5, 5, v1
  s_lshl_b32 s64, s59, 1
  v_add_u32 v5, s64, v5
  v_mul_u32_u24 v27, 160, v5
  ds_read_b128 v[8:11], v27 offset:16384
  ds_read_b128 v[28:31], v27 offset:18944
  s_waitcnt vmcnt(39) lgkmcnt(0)
  v_lshlrev_b32 v8, 16, v8
  v_lshlrev_b32 v28, 16, v28
  v_lshlrev_b32 v9, 16, v9
  v_lshlrev_b32 v29, 16, v29
  v_lshlrev_b32 v10, 16, v10
  v_lshlrev_b32 v30, 16, v30
  v_lshlrev_b32 v11, 16, v11
  v_lshlrev_b32 v31, 16, v31
  v_lshlrev_b32 v5, 16, v32
  v_and_b32 v6, 0xffff0000, v32
  v_fmac_f32 v14, v5, v8
  v_fmac_f32 v15, v6, v8
  v_fmac_f32 v20, v5, v28
  v_fmac_f32 v21, v6, v28
  v_lshlrev_b32 v5, 16, v33
  v_and_b32 v6, 0xffff0000, v33
  v_fmac_f32 v16, v5, v8
  v_fmac_f32 v17, v6, v8
  v_fmac_f32 v22, v5, v28
  v_fmac_f32 v23, v6, v28
  v_lshlrev_b32 v5, 16, v34
  v_and_b32 v6, 0xffff0000, v34
  v_fmac_f32 v18, v5, v8
  v_fmac_f32 v19, v6, v8
  v_fmac_f32 v24, v5, v28
  v_fmac_f32 v25, v6, v28
  buffer_load_dwordx3 v[128:130], v2, s[52:55], s62 offen nt
  s_add_u32 s62, s62, 6144
  s_waitcnt vmcnt(39)
  v_lshlrev_b32 v5, 16, v36
  v_and_b32 v6, 0xffff0000, v36
  v_fmac_f32 v14, v5, v9
  v_fmac_f32 v15, v6, v9
  v_fmac_f32 v20, v5, v29
  v_fmac_f32 v21, v6, v29
  v_lshlrev_b32 v5, 16, v37
  v_and_b32 v6, 0xffff0000, v37
  v_fmac_f32 v16, v5, v9
  v_fmac_f32 v17, v6, v9
  v_fmac_f32 v22, v5, v29
  v_fmac_f32 v23, v6, v29
  v_lshlrev_b32 v5, 16, v38
  v_and_b32 v6, 0xffff0000, v38
  v_fmac_f32 v18, v5, v9
  v_fmac_f32 v19, v6, v9
  v_fmac_f32 v24, v5, v29
  v_fmac_f32 v25, v6, v29
  buffer_load_dwordx3 v[132:134], v2, s[52:55], s62 offen nt
  s_add_u32 s62, s62, 6144
  s_waitcnt vmcnt(39)
  v_lshlrev_b32 v5, 16, v40
  v_and_b32 v6, 0xffff0000, v40
  v_fmac_f32 v14, v5, v10
  v_fmac_f32 v15, v6, v10
  v_fmac_f32 v20, v5, v30
  v_fmac_f32 v21, v6, v30
  v_lshlrev_b32 v5, 16, v41
  v_and_b32 v6, 0xffff0000, v41
  v_fmac_f32 v16, v5, v10
  v_fmac_f32 v17, v6, v10
  v_fmac_f32 v22, v5, v30
  v_fmac_f32 v23, v6, v30
  v_lshlrev_b32 v5, 16, v42
  v_and_b32 v6, 0xffff0000, v42
  v_fmac_f32 v18, v5, v10
  v_fmac_f32 v19, v6, v10
  v_fmac_f32 v24, v5, v30
  v_fmac_f32 v25, v6, v30
  buffer_load_dwordx3 v[136:138], v2, s[52:55], s62 offen nt
  s_add_u32 s62, s62, 6144
  s_waitcnt vmcnt(39)
  v_lshlrev_b32 v5, 16, v44
  v_and_b32 v6, 0xffff0000, v44
  v_fmac_f32 v14, v5, v11
  v_fmac_f32 v15, v6, v11
  v_fmac_f32 v20, v5, v31
  v_fmac_f32 v21, v6, v31
  v_lshlrev_b32 v5, 16, v45
  v_and_b32 v6, 0xffff0000, v45
  v_fmac_f32 v16, v5, v11
  v_fmac_f32 v17, v6, v11
  v_fmac_f32 v22, v5, v31
  v_fmac_f32 v23, v6, v31
  v_lshlrev_b32 v5, 16, v46
  v_and_b32 v6, 0xffff0000, v46
  v_fmac_f32 v18, v5, v11
  v_fmac_f32 v19, v6, v11
  v_fmac_f32 v24, v5, v31
  v_fmac_f32 v25, v6, v31
  buffer_load_dwordx3 v[140:142], v2, s[52:55], s62 offen nt
  s_add_u32 s62, s62, 6144
  s_cmp_eq_u32 s2, 0
  s_cbranch_scc0 L_nozf
  s_cmp_eq_u32 s59, 7
  s_cbranch_scc0 L_nozf
  v_mov_b32 v5, 1
  v_mov_b32 v6, 0
  s_mov_b64 exec, 1
  buffer_store_dword v5, v6, s[44:47], 0 offen offset:160 sc0 sc1
  s_mov_b64 exec, -1
L_nozf:
  ds_read_b128 v[8:11], v27 offset:16400
  ds_read_b128 v[28:31], v27 offset:18960
  s_waitcnt vmcnt(39) lgkmcnt(0)
  v_lshlrev_b32 v8, 16, v8
  v_lshlrev_b32 v28, 16, v28
  v_lshlrev_b32 v9, 16, v9
  v_lshlrev_b32 v29, 16, v29
  v_lshlrev_b32 v10, 16, v10
  v_lshlrev_b32 v30, 16, v30
  v_lshlrev_b32 v11, 16, v11
  v_lshlrev_b32 v31, 16, v31
  v_lshlrev_b32 v5, 16, v48
  v_and_b32 v6, 0xffff0000, v48
  v_fmac_f32 v14, v5, v8
  v_fmac_f32 v15, v6, v8
  v_fmac_f32 v20, v5, v28
  v_fmac_f32 v21, v6, v28
  v_lshlrev_b32 v5, 16, v49
  v_and_b32 v6, 0xffff0000, v49
  v_fmac_f32 v16, v5, v8
  v_fmac_f32 v17, v6, v8
  v_fmac_f32 v22, v5, v28
  v_fmac_f32 v23, v6, v28
  v_lshlrev_b32 v5, 16, v50
  v_and_b32 v6, 0xffff0000, v50
  v_fmac_f32 v18, v5, v8
  v_fmac_f32 v19, v6, v8
  v_fmac_f32 v24, v5, v28
  v_fmac_f32 v25, v6, v28
  buffer_load_dwordx3 v[144:146], v2, s[52:55], s62 offen nt
  s_add_u32 s62, s62, 6144
  s_waitcnt vmcnt(39)
  v_lshlrev_b32 v5, 16, v52
  v_and_b32 v6, 0xffff0000, v52
  v_fmac_f32 v14, v5, v9
  v_fmac_f32 v15, v6, v9
  v_fmac_f32 v20, v5, v29
  v_fmac_f32 v21, v6, v29
  v_lshlrev_b32 v5, 16, v53
  v_and_b32 v6, 0xffff0000, v53
  v_fmac_f32 v16, v5, v9
  v_fmac_f32 v17, v6, v9
  v_fmac_f32 v22, v5, v29
  v_fmac_f32 v23, v6, v29
  v_lshlrev_b32 v5, 16, v54
  v_and_b32 v6, 0xffff0000, v54
  v_fmac_f32 v18, v5, v9
  v_fmac_f32 v19, v6, v9
  v_fmac_f32 v24, v5, v29
  v_fmac_f32 v25, v6, v29
  buffer_load_dwordx3 v[148:150], v2, s[52:55], s62 offen nt
  s_add_u32 s62, s62, 6144
  s_waitcnt vmcnt(39)
  v_lshlrev_b32 v5, 16, v56
  v_and_b32 v6, 0xffff0000, v56
  v_fmac_f32 v14, v5, v10
  v_fmac_f32 v15, v6, v10
  v_fmac_f32 v20, v5, v30
  v_fmac_f32 v21, v6, v30
  v_lshlrev_b32 v5, 16, v57
  v_and_b32 v6, 0xffff0000, v57
  v_fmac_f32 v16, v5, v10
  v_fmac_f32 v17, v6, v10
  v_fmac_f32 v22, v5, v30
  v_fmac_f32 v23, v6, v30
  v_lshlrev_b32 v5, 16, v58
  v_and_b32 v6, 0xffff0000, v58
  v_fmac_f32 v18, v5, v10
  v_fmac_f32 v19, v6, v10
  v_fmac_f32 v24, v5, v30
  v_fmac_f32 v25, v6, v30
  buffer_load_dwordx3 v[152:154], v2, s[52:55], s62 offen nt
  s_add_u32 s62, s62, 6144
  s_waitcnt vmcnt(39)
  v_lshlrev_b32 v5, 16, v60
  v_and_b32 v6, 0xffff0000, v60
  v_fmac_f32 v14, v5, v11
  v_fmac_f32 v15, v6, v11
  v_fmac_f32 v20, v5, v31
  v_fmac_f32 v21, v6, v31
  v_lshlrev_b32 v5, 16, v61
  v_and_b32 v6, 0xffff0000, v61
  v_fmac_f32 v16, v5, v11
  v_fmac_f32 v17, v6, v11
  v_fmac_f32 v22, v5, v31
  v_fmac_f32 v23, v6, v31
  v_lshlrev_b32 v5, 16, v62
  v_and_b32 v6, 0xffff0000, v62
  v_fmac_f32 v18, v5, v11
  v_fmac_f32 v19, v6, v11
  v_fmac_f32 v24, v5, v31
  v_fmac_f32 v25, v6, v31
  buffer_load_dwordx3 v[156:158], v2, s[52:55], s62 offen nt
  s_add_u32 s62, s62, 6144
  ds_read_b128 v[8:11], v27 offset:16416
  ds_read_b128 v[28:31], v27 offset:18976
  s_waitcnt vmcnt(39) lgkmcnt(0)
  v_lshlrev_b32 v8, 16, v8
  v_lshlrev_b32 v28, 16, v28
  v_lshlrev_b32 v9, 16, v9
  v_lshlrev_b32 v29, 16, v29
  v_lshlrev_b32 v10, 16, v10
  v_lshlrev_b32 v30, 16, v30
  v_lshlrev_b32 v11, 16, v11
  v_lshlrev_b32 v31, 16, v31
  v_lshlrev_b32 v5, 16, v64
  v_and_b32 v6, 0xffff0000, v64
  v_fmac_f32 v14, v5, v8
  v_fmac_f32 v15, v6, v8
  v_fmac_f32 v20, v5, v28
  v_fmac_f32 v21, v6, v28
  v_lshlrev_b32 v5, 16, v65
  v_and_b32 v6, 0xffff0000, v65
  v_fmac_f32 v16, v5, v8
  v_fmac_f32 v17, v6, v8
  v_fmac_f32 v22, v5, v28
  v_fmac_f32 v23, v6, v28
  v_lshlrev_b32 v5, 16, v66
  v_and_b32 v6, 0xffff0000, v66
  v_fmac_f32 v18, v5, v8
  v_fmac_f32 v19, v6, v8
  v_fmac_f32 v24, v5, v28
  v_fmac_f32 v25, v6, v28
  buffer_load_dwordx3 v[160:162], v2, s[52:55], s62 offen nt
  s_add_u32 s62, s62, 6144
  s_waitcnt vmcnt(39)
  v_lshlrev_b32 v5, 16, v68
  v_and_b32 v6, 0xffff0000, v68
  v_fmac_f32 v14, v5, v9
  v_fmac_f32 v15, v6, v9
  v_fmac_f32 v20, v5, v29
  v_fmac_f32 v21, v6, v29
  v_lshlrev_b32 v5, 16, v69
  v_and_b32 v6, 0xffff0000, v69
  v_fmac_f32 v16, v5, v9
  v_fmac_f32 v17, v6, v9
  v_fmac_f32 v22, v5, v29
  v_fmac_f32 v23, v6, v29
  v_lshlrev_b32 v5, 16, v70
  v_and_b32 v6, 0xffff0000, v70
  v_fmac_f32 v18, v5, v9
  v_fmac_f32 v19, v6, v9
  v_fmac_f32 v24, v5, v29
  v_fmac_f32 v25, v6, v29
  buffer_load_dwordx3 v[164:166], v2, s[52:55], s62 offen nt
  s_add_u32 s62, s62, 6144
  s_waitcnt vmcnt(39)
  v_lshlrev_b32 v5, 16, v72
  v_and_b32 v6, 0xffff0000, v72
  v_fmac_f32 v14, v5, v10
  v_fmac_f32 v15, v6, v10
  v_fmac_f32 v20, v5, v30
  v_fmac_f32 v21, v6, v30
  v_lshlrev_b32 v5, 16, v73
  v_and_b32 v6, 0xffff0000, v73
  v_fmac_f32 v16, v5, v10
  v_fmac_f32 v17, v6, v10
  v_fmac_f32 v22, v5, v30
  v_fmac_f32 v23, v6, v30
  v_lshlrev_b32 v5, 16, v74
  v_and_b32 v6, 0xffff0000, v74
  v_fmac_f32 v18, v5, v10
  v_fmac_f32 v19, v6, v10
  v_fmac_f32 v24, v5, v30
  v_fmac_f32 v25, v6, v30
  buffer_load_dwordx3 v[168:170], v2, s[52:55], s62 offen nt
  s_add_u32 s62, s62, 6144
  s_waitcnt vmcnt(39)
  v_lshlrev_b32 v5, 16, v76
  v_and_b32 v6, 0xffff0000, v76
  v_fmac_f32 v14, v5, v11
  v_fmac_f32 v15, v6, v11
  v_fmac_f32 v20, v5, v31
  v_fmac_f32 v21, v6, v31
  v_lshlrev_b32 v5, 16, v77
  v_and_b32 v6, 0xffff0000, v77
  v_fmac_f32 v16, v5, v11
  v_fmac_f32 v17, v6, v11
  v_fmac_f32 v22, v5, v31
  v_fmac_f32 v23, v6, v31
  v_lshlrev_b32 v5, 16, v78
  v_and_b32 v6, 0xffff0000, v78
  v_fmac_f32 v18, v5, v11
  v_fmac_f32 v19, v6, v11
  v_fmac_f32 v24, v5, v31
  v_fmac_f32 v25, v6, v31
  buffer_load_dwordx3 v[172:174], v2, s[52:55], s62 offen nt
  s_add_u32 s62, s62, 6144
  ds_read_b128 v[8:11], v27 offset:16432
  ds_read_b128 v[28:31], v27 offset:18992
  s_waitcnt vmcnt(39) lgkmcnt(0)
  v_lshlrev_b32 v8, 16, v8
  v_lshlrev_b32 v28, 16, v28
  v_lshlrev_b32 v9, 16, v9
  v_lshlrev_b32 v29, 16, v29
  v_lshlrev_b32 v10, 16, v10
  v_lshlrev_b32 v30, 16, v30
  v_lshlrev_b32 v11, 16, v11
  v_lshlrev_b32 v31, 16, v31
  v_lshlrev_b32 v5, 16, v80
  v_and_b32 v6, 0xffff0000, v80
  v_fmac_f32 v14, v5, v8
  v_fmac_f32 v15, v6, v8
  v_fmac_f32 v20, v5, v28
  v_fmac_f32 v21, v6, v28
  v_lshlrev_b32 v5, 16, v81
  v_and_b32 v6, 0xffff0000, v81
  v_fmac_f32 v16, v5, v8
  v_fmac_f32 v17, v6, v8
  v_fmac_f32 v22, v5, v28
  v_fmac_f32 v23, v6, v28
  v_lshlrev_b32 v5, 16, v82
  v_and_b32 v6, 0xffff0000, v82
  v_fmac_f32 v18, v5, v8
  v_fmac_f32 v19, v6, v8
  v_fmac_f32 v24, v5, v28
  v_fmac_f32 v25, v6, v28
  buffer_load_dwordx3 v[176:178], v2, s[52:55], s62 offen nt
  s_add_u32 s62, s62, 6144
  s_waitcnt vmcnt(39)
  v_lshlrev_b32 v5, 16, v84
  v_and_b32 v6, 0xffff0000, v84
  v_fmac_f32 v14, v5, v9
  v_fmac_f32 v15, v6, v9
  v_fmac_f32 v20, v5, v29
  v_fmac_f32 v21, v6, v29
  v_lshlrev_b32 v5, 16, v85
  v_and_b32 v6, 0xffff0000, v85
  v_fmac_f32 v16, v5, v9
  v_fmac_f32 v17, v6, v9
  v_fmac_f32 v22, v5, v29
  v_fmac_f32 v23, v6, v29
  v_lshlrev_b32 v5, 16, v86
  v_and_b32 v6, 0xffff0000, v86
  v_fmac_f32 v18, v5, v9
  v_fmac_f32 v19, v6, v9
  v_fmac_f32 v24, v5, v29
  v_fmac_f32 v25, v6, v29
  buffer_load_dwordx3 v[180:182], v2, s[52:55], s62 offen nt
  s_add_u32 s62, s62, 6144
  s_waitcnt vmcnt(39)
  v_lshlrev_b32 v5, 16, v88
  v_and_b32 v6, 0xffff0000, v88
  v_fmac_f32 v14, v5, v10
  v_fmac_f32 v15, v6, v10
  v_fmac_f32 v20, v5, v30
  v_fmac_f32 v21, v6, v30
  v_lshlrev_b32 v5, 16, v89
  v_and_b32 v6, 0xffff0000, v89
  v_fmac_f32 v16, v5, v10
  v_fmac_f32 v17, v6, v10
  v_fmac_f32 v22, v5, v30
  v_fmac_f32 v23, v6, v30
  v_lshlrev_b32 v5, 16, v90
  v_and_b32 v6, 0xffff0000, v90
  v_fmac_f32 v18, v5, v10
  v_fmac_f32 v19, v6, v10
  v_fmac_f32 v24, v5, v30
  v_fmac_f32 v25, v6, v30
  buffer_load_dwordx3 v[184:186], v2, s[52:55], s62 offen nt
  s_add_u32 s62, s62, 6144
  s_waitcnt vmcnt(39)
  v_lshlrev_b32 v5, 16, v92
  v_and_b32 v6, 0xffff0000, v92
  v_fmac_f32 v14, v5, v11
  v_fmac_f32 v15, v6, v11
  v_fmac_f32 v20, v5, v31
  v_fmac_f32 v21, v6, v31
  v_lshlrev_b32 v5, 16, v93
  v_and_b32 v6, 0xffff0000, v93
  v_fmac_f32 v16, v5, v11
  v_fmac_f32 v17, v6, v11
  v_fmac_f32 v22, v5, v31
  v_fmac_f32 v23, v6, v31
  v_lshlrev_b32 v5, 16, v94
  v_and_b32 v6, 0xffff0000, v94
  v_fmac_f32 v18, v5, v11
  v_fmac_f32 v19, v6, v11
  v_fmac_f32 v24, v5, v31
  v_fmac_f32 v25, v6, v31
  buffer_load_dwordx3 v[188:190], v2, s[52:55], s62 offen nt
  s_add_u32 s62, s62, 6144
  ds_read_b128 v[8:11], v27 offset:16448
  ds_read_b128 v[28:31], v27 offset:19008
  s_waitcnt vmcnt(39) lgkmcnt(0)
  v_lshlrev_b32 v8, 16, v8
  v_lshlrev_b32 v28, 16, v28
  v_lshlrev_b32 v9, 16, v9
  v_lshlrev_b32 v29, 16, v29
  v_lshlrev_b32 v10, 16, v10
  v_lshlrev_b32 v30, 16, v30
  v_lshlrev_b32 v11, 16, v11
  v_lshlrev_b32 v31, 16, v31
  v_lshlrev_b32 v5, 16, v96
  v_and_b32 v6, 0xffff0000, v96
  v_fmac_f32 v14, v5, v8
  v_fmac_f32 v15, v6, v8
  v_fmac_f32 v20, v5, v28
  v_fmac_f32 v21, v6, v28
  v_lshlrev_b32 v5, 16, v97
  v_and_b32 v6, 0xffff0000, v97
  v_fmac_f32 v16, v5, v8
  v_fmac_f32 v17, v6, v8
  v_fmac_f32 v22, v5, v28
  v_fmac_f32 v23, v6, v28
  v_lshlrev_b32 v5, 16, v98
  v_and_b32 v6, 0xffff0000, v98
  v_fmac_f32 v18, v5, v8
  v_fmac_f32 v19, v6, v8
  v_fmac_f32 v24, v5, v28
  v_fmac_f32 v25, v6, v28
  s_waitcnt vmcnt(38)
  v_lshlrev_b32 v5, 16, v100
  v_and_b32 v6, 0xffff0000, v100
  v_fmac_f32 v14, v5, v9
  v_fmac_f32 v15, v6, v9
  v_fmac_f32 v20, v5, v29
  v_fmac_f32 v21, v6, v29
  v_lshlrev_b32 v5, 16, v101
  v_and_b32 v6, 0xffff0000, v101
  v_fmac_f32 v16, v5, v9
  v_fmac_f32 v17, v6, v9
  v_fmac_f32 v22, v5, v29
  v_fmac_f32 v23, v6, v29
  v_lshlrev_b32 v5, 16, v102
  v_and_b32 v6, 0xffff0000, v102
  v_fmac_f32 v18, v5, v9
  v_fmac_f32 v19, v6, v9
  v_fmac_f32 v24, v5, v29
  v_fmac_f32 v25, v6, v29
  s_waitcnt vmcnt(37)
  v_lshlrev_b32 v5, 16, v104
  v_and_b32 v6, 0xffff0000, v104
  v_fmac_f32 v14, v5, v10
  v_fmac_f32 v15, v6, v10
  v_fmac_f32 v20, v5, v30
  v_fmac_f32 v21, v6, v30
  v_lshlrev_b32 v5, 16, v105
  v_and_b32 v6, 0xffff0000, v105
  v_fmac_f32 v16, v5, v10
  v_fmac_f32 v17, v6, v10
  v_fmac_f32 v22, v5, v30
  v_fmac_f32 v23, v6, v30
  v_lshlrev_b32 v5, 16, v106
  v_and_b32 v6, 0xffff0000, v106
  v_fmac_f32 v18, v5, v10
  v_fmac_f32 v19, v6, v10
  v_fmac_f32 v24, v5, v30
  v_fmac_f32 v25, v6, v30
  s_waitcnt vmcnt(36)
  v_lshlrev_b32 v5, 16, v108
  v_and_b32 v6, 0xffff0000, v108
  v_fmac_f32 v14, v5, v11
  v_fmac_f32 v15, v6, v11
  v_fmac_f32 v20, v5, v31
  v_fmac_f32 v21, v6, v31
  v_lshlrev_b32 v5, 16, v109
  v_and_b32 v6, 0xffff0000, v109
  v_fmac_f32 v16, v5, v11
  v_fmac_f32 v17, v6, v11
  v_fmac_f32 v22, v5, v31
  v_fmac_f32 v23, v6, v31
  v_lshlrev_b32 v5, 16, v110
  v_and_b32 v6, 0xffff0000, v110
  v_fmac_f32 v18, v5, v11
  v_fmac_f32 v19, v6, v11
  v_fmac_f32 v24, v5, v31
  v_fmac_f32 v25, v6, v31
  ds_read_b128 v[8:11], v27 offset:16464
  ds_read_b128 v[28:31], v27 offset:19024
  s_waitcnt vmcnt(35) lgkmcnt(0)
  v_lshlrev_b32 v8, 16, v8
  v_lshlrev_b32 v28, 16, v28
  v_lshlrev_b32 v9, 16, v9
  v_lshlrev_b32 v29, 16, v29
  v_lshlrev_b32 v10, 16, v10
  v_lshlrev_b32 v30, 16, v30
  v_lshlrev_b32 v11, 16, v11
  v_lshlrev_b32 v31, 16, v31
  v_lshlrev_b32 v5, 16, v112
  v_and_b32 v6, 0xffff0000, v112
  v_fmac_f32 v14, v5, v8
  v_fmac_f32 v15, v6, v8
  v_fmac_f32 v20, v5, v28
  v_fmac_f32 v21, v6, v28
  v_lshlrev_b32 v5, 16, v113
  v_and_b32 v6, 0xffff0000, v113
  v_fmac_f32 v16, v5, v8
  v_fmac_f32 v17, v6, v8
  v_fmac_f32 v22, v5, v28
  v_fmac_f32 v23, v6, v28
  v_lshlrev_b32 v5, 16, v114
  v_and_b32 v6, 0xffff0000, v114
  v_fmac_f32 v18, v5, v8
  v_fmac_f32 v19, v6, v8
  v_fmac_f32 v24, v5, v28
  v_fmac_f32 v25, v6, v28
  s_waitcnt vmcnt(34)
  v_lshlrev_b32 v5, 16, v116
  v_and_b32 v6, 0xffff0000, v116
  v_fmac_f32 v14, v5, v9
  v_fmac_f32 v15, v6, v9
  v_fmac_f32 v20, v5, v29
  v_fmac_f32 v21, v6, v29
  v_lshlrev_b32 v5, 16, v117
  v_and_b32 v6, 0xffff0000, v117
  v_fmac_f32 v16, v5, v9
  v_fmac_f32 v17, v6, v9
  v_fmac_f32 v22, v5, v29
  v_fmac_f32 v23, v6, v29
  v_lshlrev_b32 v5, 16, v118
  v_and_b32 v6, 0xffff0000, v118
  v_fmac_f32 v18, v5, v9
  v_fmac_f32 v19, v6, v9
  v_fmac_f32 v24, v5, v29
  v_fmac_f32 v25, v6, v29
  s_waitcnt vmcnt(33)
  v_lshlrev_b32 v5, 16, v120
  v_and_b32 v6, 0xffff0000, v120
  v_fmac_f32 v14, v5, v10
  v_fmac_f32 v15, v6, v10
  v_fmac_f32 v20, v5, v30
  v_fmac_f32 v21, v6, v30
  v_lshlrev_b32 v5, 16, v121
  v_and_b32 v6, 0xffff0000, v121
  v_fmac_f32 v16, v5, v10
  v_fmac_f32 v17, v6, v10
  v_fmac_f32 v22, v5, v30
  v_fmac_f32 v23, v6, v30
  v_lshlrev_b32 v5, 16, v122
  v_and_b32 v6, 0xffff0000, v122
  v_fmac_f32 v18, v5, v10
  v_fmac_f32 v19, v6, v10
  v_fmac_f32 v24, v5, v30
  v_fmac_f32 v25, v6, v30
  s_waitcnt vmcnt(32)
  v_lshlrev_b32 v5, 16, v124
  v_and_b32 v6, 0xffff0000, v124
  v_fmac_f32 v14, v5, v11
  v_fmac_f32 v15, v6, v11
  v_fmac_f32 v20, v5, v31
  v_fmac_f32 v21, v6, v31
  v_lshlrev_b32 v5, 16, v125
  v_and_b32 v6, 0xffff0000, v125
  v_fmac_f32 v16, v5, v11
  v_fmac_f32 v17, v6, v11
  v_fmac_f32 v22, v5, v31
  v_fmac_f32 v23, v6, v31
  v_lshlrev_b32 v5, 16, v126
  v_and_b32 v6, 0xffff0000, v126
  v_fmac_f32 v18, v5, v11
  v_fmac_f32 v19, v6, v11
  v_fmac_f32 v24, v5, v31
  v_fmac_f32 v25, v6, v31
  ds_read_b128 v[8:11], v27 offset:16480
  ds_read_b128 v[28:31], v27 offset:19040
  s_waitcnt vmcnt(31) lgkmcnt(0)
  v_lshlrev_b32 v8, 16, v8
  v_lshlrev_b32 v28, 16, v28
  v_lshlrev_b32 v9, 16, v9
  v_lshlrev_b32 v29, 16, v29
  v_lshlrev_b32 v10, 16, v10
  v_lshlrev_b32 v30, 16, v30
  v_lshlrev_b32 v11, 16, v11
  v_lshlrev_b32 v31, 16, v31
  v_lshlrev_b32 v5, 16, v192
  v_and_b32 v6, 0xffff0000, v192
  v_fmac_f32 v14, v5, v8
  v_fmac_f32 v15, v6, v8
  v_fmac_f32 v20, v5, v28
  v_fmac_f32 v21, v6, v28
  v_lshlrev_b32 v5, 16, v193
  v_and_b32 v6, 0xffff0000, v193
  v_fmac_f32 v16, v5, v8
  v_fmac_f32 v17, v6, v8
  v_fmac_f32 v22, v5, v28
  v_fmac_f32 v23, v6, v28
  v_lshlrev_b32 v5, 16, v194
  v_and_b32 v6, 0xffff0000, v194
  v_fmac_f32 v18, v5, v8
  v_fmac_f32 v19, v6, v8
  v_fmac_f32 v24, v5, v28
  v_fmac_f32 v25, v6, v28
  buffer_load_dwordx3 v[192:194], v2, s[52:55], s62 offen nt
  s_add_u32 s62, s62, 6144
  s_waitcnt vmcnt(31)
  v_lshlrev_b32 v5, 16, v196
  v_and_b32 v6, 0xffff0000, v196
  v_fmac_f32 v14, v5, v9
  v_fmac_f32 v15, v6, v9
  v_fmac_f32 v20, v5, v29
  v_fmac_f32 v21, v6, v29
  v_lshlrev_b32 v5, 16, v197
  v_and_b32 v6, 0xffff0000, v197
  v_fmac_f32 v16, v5, v9
  v_fmac_f32 v17, v6, v9
  v_fmac_f32 v22, v5, v29
  v_fmac_f32 v23, v6, v29
  v_lshlrev_b32 v5, 16, v198
  v_and_b32 v6, 0xffff0000, v198
  v_fmac_f32 v18, v5, v9
  v_fmac_f32 v19, v6, v9
  v_fmac_f32 v24, v5, v29
  v_fmac_f32 v25, v6, v29
  buffer_load_dwordx3 v[196:198], v2, s[52:55], s62 offen nt
  s_add_u32 s62, s62, 6144
  s_waitcnt vmcnt(31)
  v_lshlrev_b32 v5, 16, v200
  v_and_b32 v6, 0xffff0000, v200
  v_fmac_f32 v14, v5, v10
  v_fmac_f32 v15, v6, v10
  v_fmac_f32 v20, v5, v30
  v_fmac_f32 v21, v6, v30
  v_lshlrev_b32 v5, 16, v201
  v_and_b32 v6, 0xffff0000, v201
  v_fmac_f32 v16, v5, v10
  v_fmac_f32 v17, v6, v10
  v_fmac_f32 v22, v5, v30
  v_fmac_f32 v23, v6, v30
  v_lshlrev_b32 v5, 16, v202
  v_and_b32 v6, 0xffff0000, v202
  v_fmac_f32 v18, v5, v10
  v_fmac_f32 v19, v6, v10
  v_fmac_f32 v24, v5, v30
  v_fmac_f32 v25, v6, v30
  buffer_load_dwordx3 v[200:202], v2, s[52:55], s62 offen nt
  s_add_u32 s62, s62, 6144
  s_waitcnt vmcnt(31)
  v_lshlrev_b32 v5, 16, v204
  v_and_b32 v6, 0xffff0000, v204
  v_fmac_f32 v14, v5, v11
  v_fmac_f32 v15, v6, v11
  v_fmac_f32 v20, v5, v31
  v_fmac_f32 v21, v6, v31
  v_lshlrev_b32 v5, 16, v205
  v_and_b32 v6, 0xffff0000, v205
  v_fmac_f32 v16, v5, v11
  v_fmac_f32 v17, v6, v11
  v_fmac_f32 v22, v5, v31
  v_fmac_f32 v23, v6, v31
  v_lshlrev_b32 v5, 16, v206
  v_and_b32 v6, 0xffff0000, v206
  v_fmac_f32 v18, v5, v11
  v_fmac_f32 v19, v6, v11
  v_fmac_f32 v24, v5, v31
  v_fmac_f32 v25, v6, v31
  buffer_load_dwordx3 v[204:206], v2, s[52:55], s62 offen nt
  s_add_u32 s62, s62, 6144
  ds_read_b128 v[8:11], v27 offset:16496
  ds_read_b128 v[28:31], v27 offset:19056
  s_waitcnt vmcnt(31) lgkmcnt(0)
  v_lshlrev_b32 v8, 16, v8
  v_lshlrev_b32 v28, 16, v28
  v_lshlrev_b32 v9, 16, v9
  v_lshlrev_b32 v29, 16, v29
  v_lshlrev_b32 v10, 16, v10
  v_lshlrev_b32 v30, 16, v30
  v_lshlrev_b32 v11, 16, v11
  v_lshlrev_b32 v31, 16, v31
  v_lshlrev_b32 v5, 16, v208
  v_and_b32 v6, 0xffff0000, v208
  v_fmac_f32 v14, v5, v8
  v_fmac_f32 v15, v6, v8
  v_fmac_f32 v20, v5, v28
  v_fmac_f32 v21, v6, v28
  v_lshlrev_b32 v5, 16, v209
  v_and_b32 v6, 0xffff0000, v209
  v_fmac_f32 v16, v5, v8
  v_fmac_f32 v17, v6, v8
  v_fmac_f32 v22, v5, v28
  v_fmac_f32 v23, v6, v28
  v_lshlrev_b32 v5, 16, v210
  v_and_b32 v6, 0xffff0000, v210
  v_fmac_f32 v18, v5, v8
  v_fmac_f32 v19, v6, v8
  v_fmac_f32 v24, v5, v28
  v_fmac_f32 v25, v6, v28
  buffer_load_dwordx3 v[208:210], v2, s[52:55], s62 offen nt
  s_add_u32 s62, s62, 6144
  s_waitcnt vmcnt(31)
  v_lshlrev_b32 v5, 16, v212
  v_and_b32 v6, 0xffff0000, v212
  v_fmac_f32 v14, v5, v9
  v_fmac_f32 v15, v6, v9
  v_fmac_f32 v20, v5, v29
  v_fmac_f32 v21, v6, v29
  v_lshlrev_b32 v5, 16, v213
  v_and_b32 v6, 0xffff0000, v213
  v_fmac_f32 v16, v5, v9
  v_fmac_f32 v17, v6, v9
  v_fmac_f32 v22, v5, v29
  v_fmac_f32 v23, v6, v29
  v_lshlrev_b32 v5, 16, v214
  v_and_b32 v6, 0xffff0000, v214
  v_fmac_f32 v18, v5, v9
  v_fmac_f32 v19, v6, v9
  v_fmac_f32 v24, v5, v29
  v_fmac_f32 v25, v6, v29
  buffer_load_dwordx3 v[212:214], v2, s[52:55], s62 offen nt
  s_add_u32 s62, s62, 6144
  s_waitcnt vmcnt(31)
  v_lshlrev_b32 v5, 16, v216
  v_and_b32 v6, 0xffff0000, v216
  v_fmac_f32 v14, v5, v10
  v_fmac_f32 v15, v6, v10
  v_fmac_f32 v20, v5, v30
  v_fmac_f32 v21, v6, v30
  v_lshlrev_b32 v5, 16, v217
  v_and_b32 v6, 0xffff0000, v217
  v_fmac_f32 v16, v5, v10
  v_fmac_f32 v17, v6, v10
  v_fmac_f32 v22, v5, v30
  v_fmac_f32 v23, v6, v30
  v_lshlrev_b32 v5, 16, v218
  v_and_b32 v6, 0xffff0000, v218
  v_fmac_f32 v18, v5, v10
  v_fmac_f32 v19, v6, v10
  v_fmac_f32 v24, v5, v30
  v_fmac_f32 v25, v6, v30
  buffer_load_dwordx3 v[216:218], v2, s[52:55], s62 offen nt
  s_add_u32 s62, s62, 6144
  s_waitcnt vmcnt(31)
  v_lshlrev_b32 v5, 16, v220
  v_and_b32 v6, 0xffff0000, v220
  v_fmac_f32 v14, v5, v11
  v_fmac_f32 v15, v6, v11
  v_fmac_f32 v20, v5, v31
  v_fmac_f32 v21, v6, v31
  v_lshlrev_b32 v5, 16, v221
  v_and_b32 v6, 0xffff0000, v221
  v_fmac_f32 v16, v5, v11
  v_fmac_f32 v17, v6, v11
  v_fmac_f32 v22, v5, v31
  v_fmac_f32 v23, v6, v31
  v_lshlrev_b32 v5, 16, v222
  v_and_b32 v6, 0xffff0000, v222
  v_fmac_f32 v18, v5, v11
  v_fmac_f32 v19, v6, v11
  v_fmac_f32 v24, v5, v31
  v_fmac_f32 v25, v6, v31
  buffer_load_dwordx3 v[220:222], v2, s[52:55], s62 offen nt
  s_add_u32 s62, s62, 6144
  ds_read_b128 v[8:11], v27 offset:16512
  ds_read_b128 v[28:31], v27 offset:19072
  s_waitcnt vmcnt(31) lgkmcnt(0)
  v_lshlrev_b32 v8, 16, v8
  v_lshlrev_b32 v28, 16, v28
  v_lshlrev_b32 v9, 16, v9
  v_lshlrev_b32 v29, 16, v29
  v_lshlrev_b32 v10, 16, v10
  v_lshlrev_b32 v30, 16, v30
  v_lshlrev_b32 v11, 16, v11
  v_lshlrev_b32 v31, 16, v31
  v_lshlrev_b32 v5, 16, v224
  v_and_b32 v6, 0xffff0000, v224
  v_fmac_f32 v14, v5, v8
  v_fmac_f32 v15, v6, v8
  v_fmac_f32 v20, v5, v28
  v_fmac_f32 v21, v6, v28
  v_lshlrev_b32 v5, 16, v225
  v_and_b32 v6, 0xffff0000, v225
  v_fmac_f32 v16, v5, v8
  v_fmac_f32 v17, v6, v8
  v_fmac_f32 v22, v5, v28
  v_fmac_f32 v23, v6, v28
  v_lshlrev_b32 v5, 16, v226
  v_and_b32 v6, 0xffff0000, v226
  v_fmac_f32 v18, v5, v8
  v_fmac_f32 v19, v6, v8
  v_fmac_f32 v24, v5, v28
  v_fmac_f32 v25, v6, v28
  buffer_load_dwordx3 v[224:226], v2, s[52:55], s62 offen nt
  s_add_u32 s62, s62, 6144
  s_waitcnt vmcnt(31)
  v_lshlrev_b32 v5, 16, v228
  v_and_b32 v6, 0xffff0000, v228
  v_fmac_f32 v14, v5, v9
  v_fmac_f32 v15, v6, v9
  v_fmac_f32 v20, v5, v29
  v_fmac_f32 v21, v6, v29
  v_lshlrev_b32 v5, 16, v229
  v_and_b32 v6, 0xffff0000, v229
  v_fmac_f32 v16, v5, v9
  v_fmac_f32 v17, v6, v9
  v_fmac_f32 v22, v5, v29
  v_fmac_f32 v23, v6, v29
  v_lshlrev_b32 v5, 16, v230
  v_and_b32 v6, 0xffff0000, v230
  v_fmac_f32 v18, v5, v9
  v_fmac_f32 v19, v6, v9
  v_fmac_f32 v24, v5, v29
  v_fmac_f32 v25, v6, v29
  buffer_load_dwordx3 v[228:230], v2, s[52:55], s62 offen nt
  s_add_u32 s62, s62, 6144
  s_waitcnt vmcnt(31)
  v_lshlrev_b32 v5, 16, v232
  v_and_b32 v6, 0xffff0000, v232
  v_fmac_f32 v14, v5, v10
  v_fmac_f32 v15, v6, v10
  v_fmac_f32 v20, v5, v30
  v_fmac_f32 v21, v6, v30
  v_lshlrev_b32 v5, 16, v233
  v_and_b32 v6, 0xffff0000, v233
  v_fmac_f32 v16, v5, v10
  v_fmac_f32 v17, v6, v10
  v_fmac_f32 v22, v5, v30
  v_fmac_f32 v23, v6, v30
  v_lshlrev_b32 v5, 16, v234
  v_and_b32 v6, 0xffff0000, v234
  v_fmac_f32 v18, v5, v10
  v_fmac_f32 v19, v6, v10
  v_fmac_f32 v24, v5, v30
  v_fmac_f32 v25, v6, v30
  buffer_load_dwordx3 v[232:234], v2, s[52:55], s62 offen nt
  s_add_u32 s62, s62, 6144
  s_waitcnt vmcnt(31)
  v_lshlrev_b32 v5, 16, v236
  v_and_b32 v6, 0xffff0000, v236
  v_fmac_f32 v14, v5, v11
  v_fmac_f32 v15, v6, v11
  v_fmac_f32 v20, v5, v31
  v_fmac_f32 v21, v6, v31
  v_lshlrev_b32 v5, 16, v237
  v_and_b32 v6, 0xffff0000, v237
  v_fmac_f32 v16, v5, v11
  v_fmac_f32 v17, v6, v11
  v_fmac_f32 v22, v5, v31
  v_fmac_f32 v23, v6, v31
  v_lshlrev_b32 v5, 16, v238
  v_and_b32 v6, 0xffff0000, v238
  v_fmac_f32 v18, v5, v11
  v_fmac_f32 v19, v6, v11
  v_fmac_f32 v24, v5, v31
  v_fmac_f32 v25, v6, v31
  buffer_load_dwordx3 v[236:238], v2, s[52:55], s62 offen nt
  s_add_u32 s62, s62, 6144
  ds_read_b128 v[8:11], v27 offset:16528
  ds_read_b128 v[28:31], v27 offset:19088
  s_waitcnt vmcnt(31) lgkmcnt(0)
  v_lshlrev_b32 v8, 16, v8
  v_lshlrev_b32 v28, 16, v28
  v_lshlrev_b32 v9, 16, v9
  v_lshlrev_b32 v29, 16, v29
  v_lshlrev_b32 v10, 16, v10
  v_lshlrev_b32 v30, 16, v30
  v_lshlrev_b32 v11, 16, v11
  v_lshlrev_b32 v31, 16, v31
  v_lshlrev_b32 v5, 16, v240
  v_and_b32 v6, 0xffff0000, v240
  v_fmac_f32 v14, v5, v8
  v_fmac_f32 v15, v6, v8
  v_fmac_f32 v20, v5, v28
  v_fmac_f32 v21, v6, v28
  v_lshlrev_b32 v5, 16, v241
  v_and_b32 v6, 0xffff0000, v241
  v_fmac_f32 v16, v5, v8
  v_fmac_f32 v17, v6, v8
  v_fmac_f32 v22, v5, v28
  v_fmac_f32 v23, v6, v28
  v_lshlrev_b32 v5, 16, v242
  v_and_b32 v6, 0xffff0000, v242
  v_fmac_f32 v18, v5, v8
  v_fmac_f32 v19, v6, v8
  v_fmac_f32 v24, v5, v28
  v_fmac_f32 v25, v6, v28
  buffer_load_dwordx3 v[240:242], v2, s[52:55], s62 offen nt
  s_add_u32 s62, s62, 6144
  s_waitcnt vmcnt(31)
  v_lshlrev_b32 v5, 16, v244
  v_and_b32 v6, 0xffff0000, v244
  v_fmac_f32 v14, v5, v9
  v_fmac_f32 v15, v6, v9
  v_fmac_f32 v20, v5, v29
  v_fmac_f32 v21, v6, v29
  v_lshlrev_b32 v5, 16, v245
  v_and_b32 v6, 0xffff0000, v245
  v_fmac_f32 v16, v5, v9
  v_fmac_f32 v17, v6, v9
  v_fmac_f32 v22, v5, v29
  v_fmac_f32 v23, v6, v29
  v_lshlrev_b32 v5, 16, v246
  v_and_b32 v6, 0xffff0000, v246
  v_fmac_f32 v18, v5, v9
  v_fmac_f32 v19, v6, v9
  v_fmac_f32 v24, v5, v29
  v_fmac_f32 v25, v6, v29
  buffer_load_dwordx3 v[244:246], v2, s[52:55], s62 offen nt
  s_add_u32 s62, s62, 6144
  s_waitcnt vmcnt(31)
  v_lshlrev_b32 v5, 16, v248
  v_and_b32 v6, 0xffff0000, v248
  v_fmac_f32 v14, v5, v10
  v_fmac_f32 v15, v6, v10
  v_fmac_f32 v20, v5, v30
  v_fmac_f32 v21, v6, v30
  v_lshlrev_b32 v5, 16, v249
  v_and_b32 v6, 0xffff0000, v249
  v_fmac_f32 v16, v5, v10
  v_fmac_f32 v17, v6, v10
  v_fmac_f32 v22, v5, v30
  v_fmac_f32 v23, v6, v30
  v_lshlrev_b32 v5, 16, v250
  v_and_b32 v6, 0xffff0000, v250
  v_fmac_f32 v18, v5, v10
  v_fmac_f32 v19, v6, v10
  v_fmac_f32 v24, v5, v30
  v_fmac_f32 v25, v6, v30
  buffer_load_dwordx3 v[248:250], v2, s[52:55], s62 offen nt
  s_add_u32 s62, s62, 6144
  s_waitcnt vmcnt(31)
  v_lshlrev_b32 v5, 16, v252
  v_and_b32 v6, 0xffff0000, v252
  v_fmac_f32 v14, v5, v11
  v_fmac_f32 v15, v6, v11
  v_fmac_f32 v20, v5, v31
  v_fmac_f32 v21, v6, v31
  v_lshlrev_b32 v5, 16, v253
  v_and_b32 v6, 0xffff0000, v253
  v_fmac_f32 v16, v5, v11
  v_fmac_f32 v17, v6, v11
  v_fmac_f32 v22, v5, v31
  v_fmac_f32 v23, v6, v31
  v_lshlrev_b32 v5, 16, v254
  v_and_b32 v6, 0xffff0000, v254
  v_fmac_f32 v18, v5, v11
  v_fmac_f32 v19, v6, v11
  v_fmac_f32 v24, v5, v31
  v_fmac_f32 v25, v6, v31
  buffer_load_dwordx3 v[252:254], v2, s[52:55], s62 offen nt
  s_add_u32 s62, s62, 6144
  v_lshrrev_b32 v5, 5, v1
  s_lshl_b32 s64, s59, 1
  v_add_u32 v5, s64, v5
  v_mul_u32_u24 v5, 768, v5
  v_and_b32 v6, 31, v1
  v_mul_u32_u24 v6, 24, v6
  v_add_u32 v5, v5, v6
  ds_write_b64 v5, v[14:15] offset:27136
  ds_write_b64 v5, v[16:17] offset:27144
  ds_write_b64 v5, v[18:19] offset:27152
  ds_write_b64 v5, v[20:21] offset:39424
  ds_write_b64 v5, v[22:23] offset:39432
  ds_write_b64 v5, v[24:25] offset:39440
  s_waitcnt lgkmcnt(0)
  s_barrier
  v_cmp_gt_u32 vcc, 384, v0
  s_and_saveexec_b64 s[64:65], vcc
  s_cbranch_execz L_cw_q
  v_cmp_le_u32 vcc, 192, v0
  v_mov_b32 v6, 0
  v_mov_b32 v5, 11520
  s_nop 0
  v_cndmask_b32 v6, v6, v5, vcc
  v_lshlrev_b32 v5, 2, v0
  v_add_u32 v5, v5, v6
  ds_read_b32 v112, v5 offset:27136
  ds_read_b32 v113, v5 offset:27904
  ds_read_b32 v114, v5 offset:28672
  ds_read_b32 v115, v5 offset:29440
  ds_read_b32 v116, v5 offset:30208
  ds_read_b32 v117, v5 offset:30976
  ds_read_b32 v118, v5 offset:31744
  ds_read_b32 v119, v5 offset:32512
  ds_read_b32 v120, v5 offset:33280
  ds_read_b32 v121, v5 offset:34048
  ds_read_b32 v122, v5 offset:34816
  ds_read_b32 v123, v5 offset:35584
  ds_read_b32 v124, v5 offset:36352
  ds_read_b32 v125, v5 offset:37120
  ds_read_b32 v126, v5 offset:37888
  ds_read_b32 v127, v5 offset:38656
  s_waitcnt lgkmcnt(0)
  v_add_f32 v112, v112, v120
  v_add_f32 v113, v113, v121
  v_add_f32 v114, v114, v122
  v_add_f32 v115, v115, v123
  v_add_f32 v116, v116, v124
  v_add_f32 v117, v117, v125
  v_add_f32 v118, v118, v126
  v_add_f32 v119, v119, v127
  v_add_f32 v112, v112, v116
  v_add_f32 v113, v113, v117
  v_add_f32 v114, v114, v118
  v_add_f32 v115, v115, v119
  v_add_f32 v112, v112, v114
  v_add_f32 v113, v113, v115
  v_add_f32 v112, v112, v113
  v_cvt_pk_bf16_f32 v112, v112, v112
  v_lshlrev_b32 v5, 1, v0
  ds_write_b16 v5, v112 offset:24576
L_cw_q:
  s_mov_b64 exec, -1
  s_waitcnt lgkmcnt(0)
  s_barrier
  v_and_b32 v5, 31, v1
  v_mul_u32_u24 v5, 12, v5
  ds_read_b32 v8, v5 offset:24576
  ds_read_b32 v9, v5 offset:24580
  ds_read_b32 v10, v5 offset:24584
  ds_read_b32 v11, v5 offset:24960
  ds_read_b32 v12, v5 offset:24964
  ds_read_b32 v13, v5 offset:24968
  s_waitcnt lgkmcnt(0)
  s_mov_b32 s19, 0
  s_mov_b32 s63, 0
L_K0:
  s_waitcnt lgkmcnt(0)
  s_barrier
  s_cmp_eq_u32 s63, 3
  s_cbranch_scc0 L_K0_h3
  s_mov_b32 s52, s28
  s_mov_b32 s53, s29
  s_mov_b32 s54, s30
  s_mov_b32 s55, s31
  s_mov_b32 s62, s61
L_K0_h3:
  s_waitcnt vmcnt(31)
  v_dot2_f32_bf16 v131, v128, v8, 0
  v_dot2_f32_bf16 v131, v129, v9, v131
  v_dot2_f32_bf16 v131, v130, v10, v131
  buffer_load_dwordx3 v[128:130], v2, s[52:55], s62 offen nt
  s_add_u32 s62, s62, 6144
  s_waitcnt vmcnt(31)
  v_dot2_f32_bf16 v135, v132, v8, 0
  v_dot2_f32_bf16 v135, v133, v9, v135
  v_dot2_f32_bf16 v135, v134, v10, v135
  buffer_load_dwordx3 v[132:134], v2, s[52:55], s62 offen nt
  s_add_u32 s62, s62, 6144
  s_waitcnt vmcnt(31)
  v_dot2_f32_bf16 v139, v136, v8, 0
  v_dot2_f32_bf16 v139, v137, v9, v139
  v_dot2_f32_bf16 v139, v138, v10, v139
  buffer_load_dwordx3 v[136:138], v2, s[52:55], s62 offen nt
  s_add_u32 s62, s62, 6144
  s_waitcnt vmcnt(31)
  v_dot2_f32_bf16 v143, v140, v8, 0
  v_dot2_f32_bf16 v143, v141, v9, v143
  v_dot2_f32_bf16 v143, v142, v10, v143
  buffer_load_dwordx3 v[140:142], v2, s[52:55], s62 offen nt
  s_add_u32 s62, s62, 6144
  s_waitcnt vmcnt(31)
  v_dot2_f32_bf16 v147, v144, v8, 0
  v_dot2_f32_bf16 v147, v145, v9, v147
  v_dot2_f32_bf16 v147, v146, v10, v147
  buffer_load_dwordx3 v[144:146], v2, s[52:55], s62 offen nt
  s_add_u32 s62, s62, 6144
  s_waitcnt vmcnt(31)
  v_dot2_f32_bf16 v151, v148, v8, 0
  v_dot2_f32_bf16 v151, v149, v9, v151
  v_dot2_f32_bf16 v151, v150, v10, v151
  buffer_load_dwordx3 v[148:150], v2, s[52:55], s62 offen nt
  s_add_u32 s62, s62, 6144
  s_waitcnt vmcnt(31)
  v_dot2_f32_bf16 v155, v152, v8, 0
  v_dot2_f32_bf16 v155, v153, v9, v155
  v_dot2_f32_bf16 v155, v154, v10, v155
  buffer_load_dwordx3 v[152:154], v2, s[52:55], s62 offen nt
  s_add_u32 s62, s62, 6144
  s_waitcnt vmcnt(31)
  v_dot2_f32_bf16 v159, v156, v8, 0
  v_dot2_f32_bf16 v159, v157, v9, v159
  v_dot2_f32_bf16 v159, v158, v10, v159
  buffer_load_dwordx3 v[156:158], v2, s[52:55], s62 offen nt
  s_add_u32 s62, s62, 6144
  s_nop 1
  v_permlane16_swap_b32 v131, v135
  v_permlane16_swap_b32 v139, v143
  v_permlane16_swap_b32 v147, v151
  v_permlane16_swap_b32 v155, v159
  s_nop 0
  v_add_f32 v131, v131, v135
  v_add_f32 v139, v139, v143
  v_add_f32 v147, v147, v151
  v_add_f32 v155, v155, v159
  s_nop 0
  v_add_f32_dpp v131, v131, v131 row_ror:8 row_mask:0xf bank_mask:0x3
  v_add_f32_dpp v147, v147, v147 row_ror:8 row_mask:0xf bank_mask:0x3
  v_add_f32_dpp v131, v139, v139 row_ror:8 row_mask:0xf bank_mask:0xc
  v_add_f32_dpp v147, v155, v155 row_ror:8 row_mask:0xf bank_mask:0xc
  s_nop 1
  v_add_f32_dpp v131, v131, v131 row_half_mirror row_mask:0xf bank_mask:0x5
  v_add_f32_dpp v131, v147, v147 row_half_mirror row_mask:0xf bank_mask:0xa
  s_nop 1
  v_add_f32_dpp v131, v131, v131 quad_perm:[1,0,3,2] row_mask:0xf bank_mask:0xf
  s_nop 1
  v_add_f32_dpp v131, v131, v131 quad_perm:[2,3,0,1] row_mask:0xf bank_mask:0xf
  v_cvt_pk_bf16_f32 v131, v131, v131
  v_lshlrev_b32 v131, 16, v131
  v_mul_f32 v131, s82, v131
  v_cvt_pk_bf16_f32 v131, v131, v131
  v_lshlrev_b32 v131, 16, v131
  v_max_f32 v4, v4, v131
  s_mov_b64 exec, s[80:81]
  ds_write_b32 v3, v131 offset:0
  s_mov_b64 exec, -1
  s_waitcnt vmcnt(31)
  v_dot2_f32_bf16 v163, v160, v8, 0
  v_dot2_f32_bf16 v163, v161, v9, v163
  v_dot2_f32_bf16 v163, v162, v10, v163
  buffer_load_dwordx3 v[160:162], v2, s[52:55], s62 offen nt
  s_add_u32 s62, s62, 6144
  s_waitcnt vmcnt(31)
  v_dot2_f32_bf16 v167, v164, v8, 0
  v_dot2_f32_bf16 v167, v165, v9, v167
  v_dot2_f32_bf16 v167, v166, v10, v167
  buffer_load_dwordx3 v[164:166], v2, s[52:55], s62 offen nt
  s_add_u32 s62, s62, 6144
  s_waitcnt vmcnt(31)
  v_dot2_f32_bf16 v171, v168, v8, 0
  v_dot2_f32_bf16 v171, v169, v9, v171
  v_dot2_f32_bf16 v171, v170, v10, v171
  buffer_load_dwordx3 v[168:170], v2, s[52:55], s62 offen nt
  s_add_u32 s62, s62, 6144
  s_waitcnt vmcnt(31)
  v_dot2_f32_bf16 v175, v172, v8, 0
  v_dot2_f32_bf16 v175, v173, v9, v175
  v_dot2_f32_bf16 v175, v174, v10, v175
  buffer_load_dwordx3 v[172:174], v2, s[52:55], s62 offen nt
  s_add_u32 s62, s62, 6144
  s_waitcnt vmcnt(31)
  v_dot2_f32_bf16 v179, v176, v8, 0
  v_dot2_f32_bf16 v179, v177, v9, v179
  v_dot2_f32_bf16 v179, v178, v10, v179
  buffer_load_dwordx3 v[176:178], v2, s[52:55], s62 offen nt
  s_add_u32 s62, s62, 6144
  s_waitcnt vmcnt(31)
  v_dot2_f32_bf16 v183, v180, v8, 0
  v_dot2_f32_bf16 v183, v181, v9, v183
  v_dot2_f32_bf16 v183, v182, v10, v183
  buffer_load_dwordx3 v[180:182], v2, s[52:55], s62 offen nt
  s_add_u32 s62, s62, 6144
  s_waitcnt vmcnt(31)
  v_dot2_f32_bf16 v187, v184, v8, 0
  v_dot2_f32_bf16 v187, v185, v9, v187
  v_dot2_f32_bf16 v187, v186, v10, v187
  buffer_load_dwordx3 v[184:186], v2, s[52:55], s62 offen nt
  s_add_u32 s62, s62, 6144
  s_waitcnt vmcnt(31)
  v_dot2_f32_bf16 v191, v188, v8, 0
  v_dot2_f32_bf16 v191, v189, v9, v191
  v_dot2_f32_bf16 v191, v190, v10, v191
  buffer_load_dwordx3 v[188:190], v2, s[52:55], s62 offen nt
  s_add_u32 s62, s62, 6144
  s_nop 1
  v_permlane16_swap_b32 v163, v167
  v_permlane16_swap_b32 v171, v175
  v_permlane16_swap_b32 v179, v183
  v_permlane16_swap_b32 v187, v191
  s_nop 0
  v_add_f32 v163, v163, v167
  v_add_f32 v171, v171, v175
  v_add_f32 v179, v179, v183
  v_add_f32 v187, v187, v191
  s_nop 0
  v_add_f32_dpp v163, v163, v163 row_ror:8 row_mask:0xf bank_mask:0x3
  v_add_f32_dpp v179, v179, v179 row_ror:8 row_mask:0xf bank_mask:0x3
  v_add_f32_dpp v163, v171, v171 row_ror:8 row_mask:0xf bank_mask:0xc
  v_add_f32_dpp v179, v187, v187 row_ror:8 row_mask:0xf bank_mask:0xc
  s_nop 1
  v_add_f32_dpp v163, v163, v163 row_half_mirror row_mask:0xf bank_mask:0x5
  v_add_f32_dpp v163, v179, v179 row_half_mirror row_mask:0xf bank_mask:0xa
  s_nop 1
  v_add_f32_dpp v163, v163, v163 quad_perm:[1,0,3,2] row_mask:0xf bank_mask:0xf
  s_nop 1
  v_add_f32_dpp v163, v163, v163 quad_perm:[2,3,0,1] row_mask:0xf bank_mask:0xf
  v_cvt_pk_bf16_f32 v163, v163, v163
  v_lshlrev_b32 v163, 16, v163
  v_mul_f32 v163, s82, v163
  v_cvt_pk_bf16_f32 v163, v163, v163
  v_lshlrev_b32 v163, 16, v163
  v_max_f32 v4, v4, v163
  s_mov_b64 exec, s[80:81]
  ds_write_b32 v3, v163 offset:32
  s_mov_b64 exec, -1
  s_waitcnt vmcnt(31)
  v_dot2_f32_bf16 v195, v192, v8, 0
  v_dot2_f32_bf16 v195, v193, v9, v195
  v_dot2_f32_bf16 v195, v194, v10, v195
  buffer_load_dwordx3 v[192:194], v2, s[52:55], s62 offen nt
  s_add_u32 s62, s62, 6144
  s_waitcnt vmcnt(31)
  v_dot2_f32_bf16 v199, v196, v8, 0
  v_dot2_f32_bf16 v199, v197, v9, v199
  v_dot2_f32_bf16 v199, v198, v10, v199
  buffer_load_dwordx3 v[196:198], v2, s[52:55], s62 offen nt
  s_add_u32 s62, s62, 6144
  s_waitcnt vmcnt(31)
  v_dot2_f32_bf16 v203, v200, v8, 0
  v_dot2_f32_bf16 v203, v201, v9, v203
  v_dot2_f32_bf16 v203, v202, v10, v203
  buffer_load_dwordx3 v[200:202], v2, s[52:55], s62 offen nt
  s_add_u32 s62, s62, 6144
  s_waitcnt vmcnt(31)
  v_dot2_f32_bf16 v207, v204, v8, 0
  v_dot2_f32_bf16 v207, v205, v9, v207
  v_dot2_f32_bf16 v207, v206, v10, v207
  buffer_load_dwordx3 v[204:206], v2, s[52:55], s62 offen nt
  s_add_u32 s62, s62, 6144
  s_waitcnt vmcnt(31)
  v_dot2_f32_bf16 v211, v208, v8, 0
  v_dot2_f32_bf16 v211, v209, v9, v211
  v_dot2_f32_bf16 v211, v210, v10, v211
  buffer_load_dwordx3 v[208:210], v2, s[52:55], s62 offen nt
  s_add_u32 s62, s62, 6144
  s_waitcnt vmcnt(31)
  v_dot2_f32_bf16 v215, v212, v8, 0
  v_dot2_f32_bf16 v215, v213, v9, v215
  v_dot2_f32_bf16 v215, v214, v10, v215
  buffer_load_dwordx3 v[212:214], v2, s[52:55], s62 offen nt
  s_add_u32 s62, s62, 6144
  s_waitcnt vmcnt(31)
  v_dot2_f32_bf16 v219, v216, v8, 0
  v_dot2_f32_bf16 v219, v217, v9, v219
  v_dot2_f32_bf16 v219, v218, v10, v219
  buffer_load_dwordx3 v[216:218], v2, s[52:55], s62 offen nt
  s_add_u32 s62, s62, 6144
  s_waitcnt vmcnt(31)
  v_dot2_f32_bf16 v223, v220, v8, 0
  v_dot2_f32_bf16 v223, v221, v9, v223
  v_dot2_f32_bf16 v223, v222, v10, v223
  buffer_load_dwordx3 v[220:222], v2, s[52:55], s62 offen nt
  s_add_u32 s62, s62, 6144
  s_nop 1
  v_permlane16_swap_b32 v195, v199
  v_permlane16_swap_b32 v203, v207
  v_permlane16_swap_b32 v211, v215
  v_permlane16_swap_b32 v219, v223
  s_nop 0
  v_add_f32 v195, v195, v199
  v_add_f32 v203, v203, v207
  v_add_f32 v211, v211, v215
  v_add_f32 v219, v219, v223
  s_nop 0
  v_add_f32_dpp v195, v195, v195 row_ror:8 row_mask:0xf bank_mask:0x3
  v_add_f32_dpp v211, v211, v211 row_ror:8 row_mask:0xf bank_mask:0x3
  v_add_f32_dpp v195, v203, v203 row_ror:8 row_mask:0xf bank_mask:0xc
  v_add_f32_dpp v211, v219, v219 row_ror:8 row_mask:0xf bank_mask:0xc
  s_nop 1
  v_add_f32_dpp v195, v195, v195 row_half_mirror row_mask:0xf bank_mask:0x5
  v_add_f32_dpp v195, v211, v211 row_half_mirror row_mask:0xf bank_mask:0xa
  s_nop 1
  v_add_f32_dpp v195, v195, v195 quad_perm:[1,0,3,2] row_mask:0xf bank_mask:0xf
  s_nop 1
  v_add_f32_dpp v195, v195, v195 quad_perm:[2,3,0,1] row_mask:0xf bank_mask:0xf
  v_cvt_pk_bf16_f32 v195, v195, v195
  v_lshlrev_b32 v195, 16, v195
  v_mul_f32 v195, s82, v195
  v_cvt_pk_bf16_f32 v195, v195, v195
  v_lshlrev_b32 v195, 16, v195
  v_max_f32 v4, v4, v195
  s_mov_b64 exec, s[80:81]
  ds_write_b32 v3, v195 offset:64
  s_mov_b64 exec, -1
  s_waitcnt vmcnt(31)
  v_dot2_f32_bf16 v227, v224, v8, 0
  v_dot2_f32_bf16 v227, v225, v9, v227
  v_dot2_f32_bf16 v227, v226, v10, v227
  buffer_load_dwordx3 v[224:226], v2, s[52:55], s62 offen nt
  s_add_u32 s62, s62, 6144
  s_waitcnt vmcnt(31)
  v_dot2_f32_bf16 v231, v228, v8, 0
  v_dot2_f32_bf16 v231, v229, v9, v231
  v_dot2_f32_bf16 v231, v230, v10, v231
  buffer_load_dwordx3 v[228:230], v2, s[52:55], s62 offen nt
  s_add_u32 s62, s62, 6144
  s_waitcnt vmcnt(31)
  v_dot2_f32_bf16 v235, v232, v8, 0
  v_dot2_f32_bf16 v235, v233, v9, v235
  v_dot2_f32_bf16 v235, v234, v10, v235
  buffer_load_dwordx3 v[232:234], v2, s[52:55], s62 offen nt
  s_add_u32 s62, s62, 6144
  s_waitcnt vmcnt(31)
  v_dot2_f32_bf16 v239, v236, v8, 0
  v_dot2_f32_bf16 v239, v237, v9, v239
  v_dot2_f32_bf16 v239, v238, v10, v239
  buffer_load_dwordx3 v[236:238], v2, s[52:55], s62 offen nt
  s_add_u32 s62, s62, 6144
  s_waitcnt vmcnt(31)
  v_dot2_f32_bf16 v243, v240, v8, 0
  v_dot2_f32_bf16 v243, v241, v9, v243
  v_dot2_f32_bf16 v243, v242, v10, v243
  buffer_load_dwordx3 v[240:242], v2, s[52:55], s62 offen nt
  s_add_u32 s62, s62, 6144
  s_waitcnt vmcnt(31)
  v_dot2_f32_bf16 v247, v244, v8, 0
  v_dot2_f32_bf16 v247, v245, v9, v247
  v_dot2_f32_bf16 v247, v246, v10, v247
  buffer_load_dwordx3 v[244:246], v2, s[52:55], s62 offen nt
  s_add_u32 s62, s62, 6144
  s_waitcnt vmcnt(31)
  v_dot2_f32_bf16 v251, v248, v8, 0
  v_dot2_f32_bf16 v251, v249, v9, v251
  v_dot2_f32_bf16 v251, v250, v10, v251
  buffer_load_dwordx3 v[248:250], v2, s[52:55], s62 offen nt
  s_add_u32 s62, s62, 6144
  s_waitcnt vmcnt(31)
  v_dot2_f32_bf16 v255, v252, v8, 0
  v_dot2_f32_bf16 v255, v253, v9, v255
  v_dot2_f32_bf16 v255, v254, v10, v255
  buffer_load_dwordx3 v[252:254], v2, s[52:55], s62 offen nt
  s_add_u32 s62, s62, 6144
  s_nop 1
  v_permlane16_swap_b32 v227, v231
  v_permlane16_swap_b32 v235, v239
  v_permlane16_swap_b32 v243, v247
  v_permlane16_swap_b32 v251, v255
  s_nop 0
  v_add_f32 v227, v227, v231
  v_add_f32 v235, v235, v239
  v_add_f32 v243, v243, v247
  v_add_f32 v251, v251, v255
  s_nop 0
  v_add_f32_dpp v227, v227, v227 row_ror:8 row_mask:0xf bank_mask:0x3
  v_add_f32_dpp v243, v243, v243 row_ror:8 row_mask:0xf bank_mask:0x3
  v_add_f32_dpp v227, v235, v235 row_ror:8 row_mask:0xf bank_mask:0xc
  v_add_f32_dpp v243, v251, v251 row_ror:8 row_mask:0xf bank_mask:0xc
  s_nop 1
  v_add_f32_dpp v227, v227, v227 row_half_mirror row_mask:0xf bank_mask:0x5
  v_add_f32_dpp v227, v243, v243 row_half_mirror row_mask:0xf bank_mask:0xa
  s_nop 1
  v_add_f32_dpp v227, v227, v227 quad_perm:[1,0,3,2] row_mask:0xf bank_mask:0xf
  s_nop 1
  v_add_f32_dpp v227, v227, v227 quad_perm:[2,3,0,1] row_mask:0xf bank_mask:0xf
  v_cvt_pk_bf16_f32 v227, v227, v227
  v_lshlrev_b32 v227, 16, v227
  v_mul_f32 v227, s82, v227
  v_cvt_pk_bf16_f32 v227, v227, v227
  v_lshlrev_b32 v227, 16, v227
  v_max_f32 v4, v4, v227
  s_mov_b64 exec, s[80:81]
  ds_write_b32 v3, v227 offset:96
  s_mov_b64 exec, -1
  v_add_u32 v3, 128, v3
  s_add_u32 s63, s63, 1
  s_cmp_lt_u32 s63, 4
  s_cbranch_scc1 L_K0
  v_subrev_u32 v3, 512, v3
  s_waitcnt lgkmcnt(0)
  ds_read_b128 v[28:31], v7 offset:0
  s_nop 1
  v_max_f32_dpp v4, v4, v4 quad_perm:[1,0,3,2] row_mask:0xf bank_mask:0xf
  s_nop 1
  v_max_f32_dpp v4, v4, v4 quad_perm:[2,3,0,1] row_mask:0xf bank_mask:0xf
  s_nop 1
  v_max_f32_dpp v4, v4, v4 row_half_mirror row_mask:0xf bank_mask:0xf
  s_nop 1
  v_max_f32_dpp v4, v4, v4 row_mirror row_mask:0xf bank_mask:0xf
  v_mov_b32 v5, v4
  s_nop 1
  v_permlane16_swap_b32 v4, v5
  s_nop 1
  v_max_f32 v4, v4, v5
  v_mov_b32 v5, v4
  s_nop 1
  v_permlane32_swap_b32 v4, v5
  s_nop 1
  v_max_f32 v4, v4, v5
  s_waitcnt lgkmcnt(0)
  v_sub_f32 v28, v28, v4
  v_sub_f32 v29, v29, v4
  v_sub_f32 v30, v30, v4
  v_sub_f32 v31, v31, v4
  v_mul_f32 v28, s83, v28
  v_mul_f32 v29, s83, v29
  v_mul_f32 v30, s83, v30
  v_mul_f32 v31, s83, v31
  v_exp_f32 v28, v28
  v_exp_f32 v29, v29
  v_exp_f32 v30, v30
  v_exp_f32 v31, v31
  s_nop 0
  v_add_f32 v28, v28, v29
  v_add_f32 v30, v30, v31
  v_add_f32 v5, v28, v30
  s_nop 1
  v_add_f32_dpp v5, v5, v5 quad_perm:[1,0,3,2] row_mask:0xf bank_mask:0xf
  s_nop 1
  v_add_f32_dpp v5, v5, v5 quad_perm:[2,3,0,1] row_mask:0xf bank_mask:0xf
  s_nop 1
  v_add_f32_dpp v5, v5, v5 row_half_mirror row_mask:0xf bank_mask:0xf
  s_nop 1
  v_add_f32_dpp v5, v5, v5 row_mirror row_mask:0xf bank_mask:0xf
  v_mov_b32 v6, v5
  s_nop 1
  v_permlane16_swap_b32 v5, v6
  s_nop 1
  v_add_f32 v5, v5, v6
  v_mov_b32 v6, v5
  s_nop 1
  v_permlane32_swap_b32 v5, v6
  s_nop 1
  v_add_f32 v5, v5, v6
  s_lshl_b32 s64, s59, 3
  v_mov_b32 v6, s64
  s_mov_b64 exec, 1
  ds_write_b64 v6, v[4:5] offset:26880
  s_mov_b64 exec, -1
  v_mov_b32 v4, 0xff800000
  s_mov_b32 s63, 0
L_K1:
  s_waitcnt lgkmcnt(0)
  s_barrier
  s_cmp_eq_u32 s63, 3
  s_cbranch_scc0 L_K1_h3
  s_mov_b32 s52, s32
  s_mov_b32 s53, s33
  s_mov_b32 s54, s34
  s_mov_b32 s55, s35
  s_mov_b32 s62, s60
L_K1_h3:
  s_cmp_eq_u32 s59, 0
  s_cbranch_scc0 L_K1_hx
  s_cmp_eq_u32 s63, 0
  s_cbranch_scc0 L_K1_a
  v_and_b32 v6, 7, v1
  v_lshlrev_b32 v6, 3, v6
  ds_read_b64 v[30:31], v6 offset:26880
  s_waitcnt lgkmcnt(0)
  v_mov_b32 v5, v30
  s_nop 1
  v_max_f32_dpp v5, v5, v5 quad_perm:[1,0,3,2] row_mask:0xf bank_mask:0xf
  s_nop 1
  v_max_f32_dpp v5, v5, v5 quad_perm:[2,3,0,1] row_mask:0xf bank_mask:0xf
  s_nop 1
  v_max_f32_dpp v5, v5, v5 row_half_mirror row_mask:0xf bank_mask:0xf
  v_sub_f32 v30, v30, v5
  v_mul_f32 v30, s83, v30
  v_exp_f32 v30, v30
  s_nop 0
  v_mul_f32 v31, v31, v30
  s_nop 1
  v_add_f32_dpp v31, v31, v31 quad_perm:[1,0,3,2] row_mask:0xf bank_mask:0xf
  s_nop 1
  v_add_f32_dpp v31, v31, v31 quad_perm:[2,3,0,1] row_mask:0xf bank_mask:0xf
  s_nop 1
  v_add_f32_dpp v31, v31, v31 row_half_mirror row_mask:0xf bank_mask:0xf
  v_mov_b32 v30, v5
  v_mov_b32 v6, 0
  s_mov_b64 exec, 1
  buffer_store_dwordx2 v[30:31], v6, s[48:51], s72 offen sc0 sc1
  s_mov_b64 exec, -1
  s_branch L_K1_hx
L_K1_a:
  s_cmp_eq_u32 s63, 1
  s_cbranch_scc0 L_K1_b
  v_mov_b32 v6, 0
  v_mov_b32 v5, s79
  s_mov_b64 exec, 1
  buffer_atomic_add v5, v6, s[44:47], s76 offen sc1
  s_mov_b64 exec, -1
  s_branch L_K1_hx
L_K1_b:
  s_cmp_eq_u32 s63, 2
  s_cbranch_scc0 L_K1_c
  v_mov_b32 v6, 0
  buffer_load_dword v126, v6, s[44:47], s76 offen sc0 sc1
  s_branch L_K1_hx
L_K1_c:
  v_readfirstlane_b32 s64, v126
  s_nop 3
L_chk_K1:
  s_lshr_b32 s64, s64, s78
  s_and_b32 s64, s64, 0xff
  s_cmp_eq_u32 s64, 4
  s_cbranch_scc1 L_ok_K1
  s_sleep 8
  v_mov_b32 v6, 0
  buffer_load_dword v126, v6, s[44:47], s76 offen sc0 sc1
  s_waitcnt vmcnt(0)
  v_readfirstlane_b32 s64, v126
  s_nop 3
  s_branch L_chk_K1
L_ok_K1:
  v_and_b32 v6, 3, v1
  v_lshlrev_b32 v6, 3, v6
  buffer_load_dwordx2 v[124:125], v6, s[48:51], s74 offen sc0 sc1
L_K1_hx:
  s_waitcnt vmcnt(31)
  v_dot2_f32_bf16 v131, v128, v11, 0
  v_dot2_f32_bf16 v131, v129, v12, v131
  v_dot2_f32_bf16 v131, v130, v13, v131
  buffer_load_dwordx3 v[128:130], v2, s[52:55], s62 offen nt
  s_add_u32 s62, s62, 6144
  s_waitcnt vmcnt(31)
  v_dot2_f32_bf16 v135, v132, v11, 0
  v_dot2_f32_bf16 v135, v133, v12, v135
  v_dot2_f32_bf16 v135, v134, v13, v135
  buffer_load_dwordx3 v[132:134], v2, s[52:55], s62 offen nt
  s_add_u32 s62, s62, 6144
  s_waitcnt vmcnt(31)
  v_dot2_f32_bf16 v139, v136, v11, 0
  v_dot2_f32_bf16 v139, v137, v12, v139
  v_dot2_f32_bf16 v139, v138, v13, v139
  buffer_load_dwordx3 v[136:138], v2, s[52:55], s62 offen nt
  s_add_u32 s62, s62, 6144
  s_waitcnt vmcnt(31)
  v_dot2_f32_bf16 v143, v140, v11, 0
  v_dot2_f32_bf16 v143, v141, v12, v143
  v_dot2_f32_bf16 v143, v142, v13, v143
  buffer_load_dwordx3 v[140:142], v2, s[52:55], s62 offen nt
  s_add_u32 s62, s62, 6144
  s_waitcnt vmcnt(31)
  v_dot2_f32_bf16 v147, v144, v11, 0
  v_dot2_f32_bf16 v147, v145, v12, v147
  v_dot2_f32_bf16 v147, v146, v13, v147
  buffer_load_dwordx3 v[144:146], v2, s[52:55], s62 offen nt
  s_add_u32 s62, s62, 6144
  s_waitcnt vmcnt(31)
  v_dot2_f32_bf16 v151, v148, v11, 0
  v_dot2_f32_bf16 v151, v149, v12, v151
  v_dot2_f32_bf16 v151, v150, v13, v151
  buffer_load_dwordx3 v[148:150], v2, s[52:55], s62 offen nt
  s_add_u32 s62, s62, 6144
  s_waitcnt vmcnt(31)
  v_dot2_f32_bf16 v155, v152, v11, 0
  v_dot2_f32_bf16 v155, v153, v12, v155
  v_dot2_f32_bf16 v155, v154, v13, v155
  buffer_load_dwordx3 v[152:154], v2, s[52:55], s62 offen nt
  s_add_u32 s62, s62, 6144
  s_waitcnt vmcnt(31)
  v_dot2_f32_bf16 v159, v156, v11, 0
  v_dot2_f32_bf16 v159, v157, v12, v159
  v_dot2_f32_bf16 v159, v158, v13, v159
  buffer_load_dwordx3 v[156:158], v2, s[52:55], s62 offen nt
  s_add_u32 s62, s62, 6144
  s_nop 1
  v_permlane16_swap_b32 v131, v135
  v_permlane16_swap_b32 v139, v143
  v_permlane16_swap_b32 v147, v151
  v_permlane16_swap_b32 v155, v159
  s_nop 0
  v_add_f32 v131, v131, v135
  v_add_f32 v139, v139, v143
  v_add_f32 v147, v147, v151
  v_add_f32 v155, v155, v159
  s_nop 0
  v_add_f32_dpp v131, v131, v131 row_ror:8 row_mask:0xf bank_mask:0x3
  v_add_f32_dpp v147, v147, v147 row_ror:8 row_mask:0xf bank_mask:0x3
  v_add_f32_dpp v131, v139, v139 row_ror:8 row_mask:0xf bank_mask:0xc
  v_add_f32_dpp v147, v155, v155 row_ror:8 row_mask:0xf bank_mask:0xc
  s_nop 1
  v_add_f32_dpp v131, v131, v131 row_half_mirror row_mask:0xf bank_mask:0x5
  v_add_f32_dpp v131, v147, v147 row_half_mirror row_mask:0xf bank_mask:0xa
  s_nop 1
  v_add_f32_dpp v131, v131, v131 quad_perm:[1,0,3,2] row_mask:0xf bank_mask:0xf
  s_nop 1
  v_add_f32_dpp v131, v131, v131 quad_perm:[2,3,0,1] row_mask:0xf bank_mask:0xf
  v_cvt_pk_bf16_f32 v131, v131, v131
  v_lshlrev_b32 v131, 16, v131
  v_mul_f32 v131, s82, v131
  v_cvt_pk_bf16_f32 v131, v131, v131
  v_lshlrev_b32 v131, 16, v131
  v_max_f32 v4, v4, v131
  s_mov_b64 exec, s[80:81]
  ds_write_b32 v3, v131 offset:8192
  s_mov_b64 exec, -1
  s_waitcnt vmcnt(31)
  v_dot2_f32_bf16 v163, v160, v11, 0
  v_dot2_f32_bf16 v163, v161, v12, v163
  v_dot2_f32_bf16 v163, v162, v13, v163
  buffer_load_dwordx3 v[160:162], v2, s[52:55], s62 offen nt
  s_add_u32 s62, s62, 6144
  s_waitcnt vmcnt(31)
  v_dot2_f32_bf16 v167, v164, v11, 0
  v_dot2_f32_bf16 v167, v165, v12, v167
  v_dot2_f32_bf16 v167, v166, v13, v167
  buffer_load_dwordx3 v[164:166], v2, s[52:55], s62 offen nt
  s_add_u32 s62, s62, 6144
  s_waitcnt vmcnt(31)
  v_dot2_f32_bf16 v171, v168, v11, 0
  v_dot2_f32_bf16 v171, v169, v12, v171
  v_dot2_f32_bf16 v171, v170, v13, v171
  buffer_load_dwordx3 v[168:170], v2, s[52:55], s62 offen nt
  s_add_u32 s62, s62, 6144
  s_waitcnt vmcnt(31)
  v_dot2_f32_bf16 v175, v172, v11, 0
  v_dot2_f32_bf16 v175, v173, v12, v175
  v_dot2_f32_bf16 v175, v174, v13, v175
  buffer_load_dwordx3 v[172:174], v2, s[52:55], s62 offen nt
  s_add_u32 s62, s62, 6144
  s_waitcnt vmcnt(31)
  v_dot2_f32_bf16 v179, v176, v11, 0
  v_dot2_f32_bf16 v179, v177, v12, v179
  v_dot2_f32_bf16 v179, v178, v13, v179
  buffer_load_dwordx3 v[176:178], v2, s[52:55], s62 offen nt
  s_add_u32 s62, s62, 6144
  s_waitcnt vmcnt(31)
  v_dot2_f32_bf16 v183, v180, v11, 0
  v_dot2_f32_bf16 v183, v181, v12, v183
  v_dot2_f32_bf16 v183, v182, v13, v183
  buffer_load_dwordx3 v[180:182], v2, s[52:55], s62 offen nt
  s_add_u32 s62, s62, 6144
  s_waitcnt vmcnt(31)
  v_dot2_f32_bf16 v187, v184, v11, 0
  v_dot2_f32_bf16 v187, v185, v12, v187
  v_dot2_f32_bf16 v187, v186, v13, v187
  buffer_load_dwordx3 v[184:186], v2, s[52:55], s62 offen nt
  s_add_u32 s62, s62, 6144
  s_waitcnt vmcnt(31)
  v_dot2_f32_bf16 v191, v188, v11, 0
  v_dot2_f32_bf16 v191, v189, v12, v191
  v_dot2_f32_bf16 v191, v190, v13, v191
  buffer_load_dwordx3 v[188:190], v2, s[52:55], s62 offen nt
  s_add_u32 s62, s62, 6144
  s_nop 1
  v_permlane16_swap_b32 v163, v167
  v_permlane16_swap_b32 v171, v175
  v_permlane16_swap_b32 v179, v183
  v_permlane16_swap_b32 v187, v191
  s_nop 0
  v_add_f32 v163, v163, v167
  v_add_f32 v171, v171, v175
  v_add_f32 v179, v179, v183
  v_add_f32 v187, v187, v191
  s_nop 0
  v_add_f32_dpp v163, v163, v163 row_ror:8 row_mask:0xf bank_mask:0x3
  v_add_f32_dpp v179, v179, v179 row_ror:8 row_mask:0xf bank_mask:0x3
  v_add_f32_dpp v163, v171, v171 row_ror:8 row_mask:0xf bank_mask:0xc
  v_add_f32_dpp v179, v187, v187 row_ror:8 row_mask:0xf bank_mask:0xc
  s_nop 1
  v_add_f32_dpp v163, v163, v163 row_half_mirror row_mask:0xf bank_mask:0x5
  v_add_f32_dpp v163, v179, v179 row_half_mirror row_mask:0xf bank_mask:0xa
  s_nop 1
  v_add_f32_dpp v163, v163, v163 quad_perm:[1,0,3,2] row_mask:0xf bank_mask:0xf
  s_nop 1
  v_add_f32_dpp v163, v163, v163 quad_perm:[2,3,0,1] row_mask:0xf bank_mask:0xf
  v_cvt_pk_bf16_f32 v163, v163, v163
  v_lshlrev_b32 v163, 16, v163
  v_mul_f32 v163, s82, v163
  v_cvt_pk_bf16_f32 v163, v163, v163
  v_lshlrev_b32 v163, 16, v163
  v_max_f32 v4, v4, v163
  s_mov_b64 exec, s[80:81]
  ds_write_b32 v3, v163 offset:8224
  s_mov_b64 exec, -1
  s_waitcnt vmcnt(31)
  v_dot2_f32_bf16 v195, v192, v11, 0
  v_dot2_f32_bf16 v195, v193, v12, v195
  v_dot2_f32_bf16 v195, v194, v13, v195
  buffer_load_dwordx3 v[192:194], v2, s[52:55], s62 offen nt
  s_add_u32 s62, s62, 6144
  s_waitcnt vmcnt(31)
  v_dot2_f32_bf16 v199, v196, v11, 0
  v_dot2_f32_bf16 v199, v197, v12, v199
  v_dot2_f32_bf16 v199, v198, v13, v199
  buffer_load_dwordx3 v[196:198], v2, s[52:55], s62 offen nt
  s_add_u32 s62, s62, 6144
  s_waitcnt vmcnt(31)
  v_dot2_f32_bf16 v203, v200, v11, 0
  v_dot2_f32_bf16 v203, v201, v12, v203
  v_dot2_f32_bf16 v203, v202, v13, v203
  buffer_load_dwordx3 v[200:202], v2, s[52:55], s62 offen nt
  s_add_u32 s62, s62, 6144
  s_waitcnt vmcnt(31)
  v_dot2_f32_bf16 v207, v204, v11, 0
  v_dot2_f32_bf16 v207, v205, v12, v207
  v_dot2_f32_bf16 v207, v206, v13, v207
  buffer_load_dwordx3 v[204:206], v2, s[52:55], s62 offen nt
  s_add_u32 s62, s62, 6144
  s_waitcnt vmcnt(31)
  v_dot2_f32_bf16 v211, v208, v11, 0
  v_dot2_f32_bf16 v211, v209, v12, v211
  v_dot2_f32_bf16 v211, v210, v13, v211
  buffer_load_dwordx3 v[208:210], v2, s[52:55], s62 offen nt
  s_add_u32 s62, s62, 6144
  s_waitcnt vmcnt(31)
  v_dot2_f32_bf16 v215, v212, v11, 0
  v_dot2_f32_bf16 v215, v213, v12, v215
  v_dot2_f32_bf16 v215, v214, v13, v215
  buffer_load_dwordx3 v[212:214], v2, s[52:55], s62 offen nt
  s_add_u32 s62, s62, 6144
  s_waitcnt vmcnt(31)
  v_dot2_f32_bf16 v219, v216, v11, 0
  v_dot2_f32_bf16 v219, v217, v12, v219
  v_dot2_f32_bf16 v219, v218, v13, v219
  buffer_load_dwordx3 v[216:218], v2, s[52:55], s62 offen nt
  s_add_u32 s62, s62, 6144
  s_waitcnt vmcnt(31)
  v_dot2_f32_bf16 v223, v220, v11, 0
  v_dot2_f32_bf16 v223, v221, v12, v223
  v_dot2_f32_bf16 v223, v222, v13, v223
  buffer_load_dwordx3 v[220:222], v2, s[52:55], s62 offen nt
  s_add_u32 s62, s62, 6144
  s_nop 1
  v_permlane16_swap_b32 v195, v199
  v_permlane16_swap_b32 v203, v207
  v_permlane16_swap_b32 v211, v215
  v_permlane16_swap_b32 v219, v223
  s_nop 0
  v_add_f32 v195, v195, v199
  v_add_f32 v203, v203, v207
  v_add_f32 v211, v211, v215
  v_add_f32 v219, v219, v223
  s_nop 0
  v_add_f32_dpp v195, v195, v195 row_ror:8 row_mask:0xf bank_mask:0x3
  v_add_f32_dpp v211, v211, v211 row_ror:8 row_mask:0xf bank_mask:0x3
  v_add_f32_dpp v195, v203, v203 row_ror:8 row_mask:0xf bank_mask:0xc
  v_add_f32_dpp v211, v219, v219 row_ror:8 row_mask:0xf bank_mask:0xc
  s_nop 1
  v_add_f32_dpp v195, v195, v195 row_half_mirror row_mask:0xf bank_mask:0x5
  v_add_f32_dpp v195, v211, v211 row_half_mirror row_mask:0xf bank_mask:0xa
  s_nop 1
  v_add_f32_dpp v195, v195, v195 quad_perm:[1,0,3,2] row_mask:0xf bank_mask:0xf
  s_nop 1
  v_add_f32_dpp v195, v195, v195 quad_perm:[2,3,0,1] row_mask:0xf bank_mask:0xf
  v_cvt_pk_bf16_f32 v195, v195, v195
  v_lshlrev_b32 v195, 16, v195
  v_mul_f32 v195, s82, v195
  v_cvt_pk_bf16_f32 v195, v195, v195
  v_lshlrev_b32 v195, 16, v195
  v_max_f32 v4, v4, v195
  s_mov_b64 exec, s[80:81]
  ds_write_b32 v3, v195 offset:8256
  s_mov_b64 exec, -1
  s_waitcnt vmcnt(31)
  v_dot2_f32_bf16 v227, v224, v11, 0
  v_dot2_f32_bf16 v227, v225, v12, v227
  v_dot2_f32_bf16 v227, v226, v13, v227
  buffer_load_dwordx3 v[224:226], v2, s[52:55], s62 offen nt
  s_add_u32 s62, s62, 6144
  s_waitcnt vmcnt(31)
  v_dot2_f32_bf16 v231, v228, v11, 0
  v_dot2_f32_bf16 v231, v229, v12, v231
  v_dot2_f32_bf16 v231, v230, v13, v231
  buffer_load_dwordx3 v[228:230], v2, s[52:55], s62 offen nt
  s_add_u32 s62, s62, 6144
  s_waitcnt vmcnt(31)
  v_dot2_f32_bf16 v235, v232, v11, 0
  v_dot2_f32_bf16 v235, v233, v12, v235
  v_dot2_f32_bf16 v235, v234, v13, v235
  buffer_load_dwordx3 v[232:234], v2, s[52:55], s62 offen nt
  s_add_u32 s62, s62, 6144
  s_waitcnt vmcnt(31)
  v_dot2_f32_bf16 v239, v236, v11, 0
  v_dot2_f32_bf16 v239, v237, v12, v239
  v_dot2_f32_bf16 v239, v238, v13, v239
  buffer_load_dwordx3 v[236:238], v2, s[52:55], s62 offen nt
  s_add_u32 s62, s62, 6144
  s_waitcnt vmcnt(31)
  v_dot2_f32_bf16 v243, v240, v11, 0
  v_dot2_f32_bf16 v243, v241, v12, v243
  v_dot2_f32_bf16 v243, v242, v13, v243
  buffer_load_dwordx3 v[240:242], v2, s[52:55], s62 offen nt
  s_add_u32 s62, s62, 6144
  s_waitcnt vmcnt(31)
  v_dot2_f32_bf16 v247, v244, v11, 0
  v_dot2_f32_bf16 v247, v245, v12, v247
  v_dot2_f32_bf16 v247, v246, v13, v247
  buffer_load_dwordx3 v[244:246], v2, s[52:55], s62 offen nt
  s_add_u32 s62, s62, 6144
  s_waitcnt vmcnt(31)
  v_dot2_f32_bf16 v251, v248, v11, 0
  v_dot2_f32_bf16 v251, v249, v12, v251
  v_dot2_f32_bf16 v251, v250, v13, v251
  buffer_load_dwordx3 v[248:250], v2, s[52:55], s62 offen nt
  s_add_u32 s62, s62, 6144
  s_waitcnt vmcnt(31)
  v_dot2_f32_bf16 v255, v252, v11, 0
  v_dot2_f32_bf16 v255, v253, v12, v255
  v_dot2_f32_bf16 v255, v254, v13, v255
  buffer_load_dwordx3 v[252:254], v2, s[52:55], s62 offen nt
  s_add_u32 s62, s62, 6144
  s_nop 1
  v_permlane16_swap_b32 v227, v231
  v_permlane16_swap_b32 v235, v239
  v_permlane16_swap_b32 v243, v247
  v_permlane16_swap_b32 v251, v255
  s_nop 0
  v_add_f32 v227, v227, v231
  v_add_f32 v235, v235, v239
  v_add_f32 v243, v243, v247
  v_add_f32 v251, v251, v255
  s_nop 0
  v_add_f32_dpp v227, v227, v227 row_ror:8 row_mask:0xf bank_mask:0x3
  v_add_f32_dpp v243, v243, v243 row_ror:8 row_mask:0xf bank_mask:0x3
  v_add_f32_dpp v227, v235, v235 row_ror:8 row_mask:0xf bank_mask:0xc
  v_add_f32_dpp v243, v251, v251 row_ror:8 row_mask:0xf bank_mask:0xc
  s_nop 1
  v_add_f32_dpp v227, v227, v227 row_half_mirror row_mask:0xf bank_mask:0x5
  v_add_f32_dpp v227, v243, v243 row_half_mirror row_mask:0xf bank_mask:0xa
  s_nop 1
  v_add_f32_dpp v227, v227, v227 quad_perm:[1,0,3,2] row_mask:0xf bank_mask:0xf
  s_nop 1
  v_add_f32_dpp v227, v227, v227 quad_perm:[2,3,0,1] row_mask:0xf bank_mask:0xf
  v_cvt_pk_bf16_f32 v227, v227, v227
  v_lshlrev_b32 v227, 16, v227
  v_mul_f32 v227, s82, v227
  v_cvt_pk_bf16_f32 v227, v227, v227
  v_lshlrev_b32 v227, 16, v227
  v_max_f32 v4, v4, v227
  s_mov_b64 exec, s[80:81]
  ds_write_b32 v3, v227 offset:8288
  s_mov_b64 exec, -1
  v_add_u32 v3, 128, v3
  s_add_u32 s63, s63, 1
  s_cmp_lt_u32 s63, 4
  s_cbranch_scc1 L_K1
  v_subrev_u32 v3, 512, v3
  s_waitcnt lgkmcnt(0)
  ds_read_b128 v[28:31], v7 offset:8192
  s_nop 1
  v_max_f32_dpp v4, v4, v4 quad_perm:[1,0,3,2] row_mask:0xf bank_mask:0xf
  s_nop 1
  v_max_f32_dpp v4, v4, v4 quad_perm:[2,3,0,1] row_mask:0xf bank_mask:0xf
  s_nop 1
  v_max_f32_dpp v4, v4, v4 row_half_mirror row_mask:0xf bank_mask:0xf
  s_nop 1
  v_max_f32_dpp v4, v4, v4 row_mirror row_mask:0xf bank_mask:0xf
  v_mov_b32 v5, v4
  s_nop 1
  v_permlane16_swap_b32 v4, v5
  s_nop 1
  v_max_f32 v4, v4, v5
  v_mov_b32 v5, v4
  s_nop 1
  v_permlane32_swap_b32 v4, v5
  s_nop 1
  v_max_f32 v4, v4, v5
  s_waitcnt lgkmcnt(0)
  v_sub_f32 v28, v28, v4
  v_sub_f32 v29, v29, v4
  v_sub_f32 v30, v30, v4
  v_sub_f32 v31, v31, v4
  v_mul_f32 v28, s83, v28
  v_mul_f32 v29, s83, v29
  v_mul_f32 v30, s83, v30
  v_mul_f32 v31, s83, v31
  v_exp_f32 v28, v28
  v_exp_f32 v29, v29
  v_exp_f32 v30, v30
  v_exp_f32 v31, v31
  s_nop 0
  v_add_f32 v28, v28, v29
  v_add_f32 v30, v30, v31
  v_add_f32 v5, v28, v30
  s_nop 1
  v_add_f32_dpp v5, v5, v5 quad_perm:[1,0,3,2] row_mask:0xf bank_mask:0xf
  s_nop 1
  v_add_f32_dpp v5, v5, v5 quad_perm:[2,3,0,1] row_mask:0xf bank_mask:0xf
  s_nop 1
  v_add_f32_dpp v5, v5, v5 row_half_mirror row_mask:0xf bank_mask:0xf
  s_nop 1
  v_add_f32_dpp v5, v5, v5 row_mirror row_mask:0xf bank_mask:0xf
  v_mov_b32 v6, v5
  s_nop 1
  v_permlane16_swap_b32 v5, v6
  s_nop 1
  v_add_f32 v5, v5, v6
  v_mov_b32 v6, v5
  s_nop 1
  v_permlane32_swap_b32 v5, v6
  s_nop 1
  v_add_f32 v5, v5, v6
  s_lshl_b32 s64, s59, 3
  v_mov_b32 v6, s64
  s_mov_b64 exec, 1
  ds_write_b64 v6, v[4:5] offset:26944
  s_mov_b64 exec, -1
  v_mov_b32 v4, 0xff800000
  s_cmp_eq_u32 s59, 0
  s_cbranch_scc0 L_gs0
  v_mov_b32 v5, v124
  s_nop 1
  v_max_f32_dpp v5, v5, v5 quad_perm:[1,0,3,2] row_mask:0xf bank_mask:0xf
  s_nop 1
  v_max_f32_dpp v5, v5, v5 quad_perm:[2,3,0,1] row_mask:0xf bank_mask:0xf
  v_sub_f32 v124, v124, v5
  v_mul_f32 v124, s83, v124
  v_exp_f32 v124, v124
  s_nop 0
  v_mul_f32 v125, v125, v124
  s_nop 1
  v_add_f32_dpp v125, v125, v125 quad_perm:[1,0,3,2] row_mask:0xf bank_mask:0xf
  s_nop 1
  v_add_f32_dpp v125, v125, v125 quad_perm:[2,3,0,1] row_mask:0xf bank_mask:0xf
  v_mov_b32 v124, v5
  v_rcp_f32 v6, v125
  s_nop 0
  v_fma_f32 v5, -v125, v6, 1.0
  v_fma_f32 v125, v5, v6, v6
  v_mov_b32 v6, 0
  s_mov_b64 exec, 1
  ds_write_b64 v6, v[124:125] offset:27008
  s_mov_b64 exec, -1
L_gs0:
  v_mov_b32 v14, 0
  v_mov_b32 v15, 0
  v_mov_b32 v16, 0
  v_mov_b32 v17, 0
  v_mov_b32 v18, 0
  v_mov_b32 v19, 0
  v_mov_b32 v20, 0
  v_mov_b32 v21, 0
  v_mov_b32 v22, 0
  v_mov_b32 v23, 0
  v_mov_b32 v24, 0
  v_mov_b32 v25, 0
  ds_read_b128 v[26:29], v7 offset:8192
  v_lshlrev_b32 v5, 4, v1
  s_waitcnt lgkmcnt(0)
  buffer_store_dwordx4 v[26:29], v5, s[48:51], s10 offen sc0 sc1
  v_lshrrev_b32 v5, 5, v1
  v_lshlrev_b32 v5, 9, v5
  s_lshl_b32 s64, s59, 10
  v_add_u32 v3, s64, v5
  s_mov_b32 s63, 0
L_V0:
  s_waitcnt lgkmcnt(0)
  s_barrier
  s_cmp_eq_u32 s63, 0
  s_cbranch_scc0 L_V0_h0
  v_mov_b32 v6, 0
  ds_read_b128 v[26:29], v7 offset:0
  ds_read_b64 v[30:31], v6 offset:27008
  s_waitcnt lgkmcnt(0)
  v_sub_f32 v26, v26, v30
  v_sub_f32 v27, v27, v30
  v_sub_f32 v28, v28, v30
  v_sub_f32 v29, v29, v30
  v_mul_f32 v26, s83, v26
  v_mul_f32 v27, s83, v27
  v_mul_f32 v28, s83, v28
  v_mul_f32 v29, s83, v29
  v_exp_f32 v26, v26
  v_exp_f32 v27, v27
  v_exp_f32 v28, v28
  v_exp_f32 v29, v29
  s_nop 0
  v_mul_f32 v26, v26, v31
  v_mul_f32 v27, v27, v31
  v_mul_f32 v28, v28, v31
  v_mul_f32 v29, v29, v31
  v_cvt_pk_bf16_f32 v26, v26, v6
  v_cvt_pk_bf16_f32 v27, v27, v6
  v_cvt_pk_bf16_f32 v28, v28, v6
  v_cvt_pk_bf16_f32 v29, v29, v6
  ds_write_b128 v7, v[26:29] offset:0
  s_waitcnt lgkmcnt(0)
L_V0_h0:
  s_cmp_eq_u32 s63, 3
  s_cbranch_scc0 L_V0_h3
  s_mov_b32 s52, s32
  s_mov_b32 s53, s33
  s_mov_b32 s54, s34
  s_mov_b32 s55, s35
  s_mov_b32 s62, s61
  v_lshrrev_b32 v29, 5, v1
  v_lshlrev_b32 v29, 9, v29
  s_lshl_b32 s12, s58, 3
  s_add_u32 s13, s12, 1
  s_lshr_b32 s64, s12, 3
  s_lshl_b32 s64, s64, 13
  s_and_b32 s65, s12, 7
  s_lshl_b32 s65, s65, 6
  s_add_u32 s64, s64, s65
  s_add_u32 s64, s64, s9
  buffer_load_dwordx4 v[64:67], v29, s[48:51], s64 offen offset:0 sc0 sc1
  buffer_load_dwordx4 v[68:71], v29, s[48:51], s64 offen offset:16 sc0 sc1
  buffer_load_dwordx4 v[72:75], v29, s[48:51], s64 offen offset:32 sc0 sc1
  buffer_load_dwordx4 v[76:79], v29, s[48:51], s64 offen offset:48 sc0 sc1
  s_lshr_b32 s64, s13, 3
  s_lshl_b32 s64, s64, 13
  s_and_b32 s65, s13, 7
  s_lshl_b32 s65, s65, 6
  s_add_u32 s64, s64, s65
  s_add_u32 s64, s64, s9
  buffer_load_dwordx4 v[80:83], v29, s[48:51], s64 offen offset:0 sc0 sc1
  buffer_load_dwordx4 v[84:87], v29, s[48:51], s64 offen offset:16 sc0 sc1
  buffer_load_dwordx4 v[88:91], v29, s[48:51], s64 offen offset:32 sc0 sc1
  buffer_load_dwordx4 v[92:95], v29, s[48:51], s64 offen offset:48 sc0 sc1
L_V0_h3:
  s_cmp_eq_u32 s59, 0
  s_cbranch_scc0 L_V0_hx
  s_cmp_eq_u32 s63, 0
  s_cbranch_scc0 L_V0_a
  v_and_b32 v6, 7, v1
  v_lshlrev_b32 v6, 3, v6
  ds_read_b64 v[30:31], v6 offset:26944
  s_waitcnt lgkmcnt(0)
  v_mov_b32 v5, v30
  s_nop 1
  v_max_f32_dpp v5, v5, v5 quad_perm:[1,0,3,2] row_mask:0xf bank_mask:0xf
  s_nop 1
  v_max_f32_dpp v5, v5, v5 quad_perm:[2,3,0,1] row_mask:0xf bank_mask:0xf
  s_nop 1
  v_max_f32_dpp v5, v5, v5 row_half_mirror row_mask:0xf bank_mask:0xf
  v_sub_f32 v30, v30, v5
  v_mul_f32 v30, s83, v30
  v_exp_f32 v30, v30
  s_nop 0
  v_mul_f32 v31, v31, v30
  s_nop 1
  v_add_f32_dpp v31, v31, v31 quad_perm:[1,0,3,2] row_mask:0xf bank_mask:0xf
  s_nop 1
  v_add_f32_dpp v31, v31, v31 quad_perm:[2,3,0,1] row_mask:0xf bank_mask:0xf
  s_nop 1
  v_add_f32_dpp v31, v31, v31 row_half_mirror row_mask:0xf bank_mask:0xf
  v_mov_b32 v30, v5
  v_mov_b32 v6, 0
  s_mov_b64 exec, 1
  buffer_store_dwordx2 v[30:31], v6, s[48:51], s73 offen sc0 sc1
  s_mov_b64 exec, -1
  v_mov_b32 v6, 0
  buffer_load_dword v127, v6, s[44:47], 0 offen offset:160 sc0 sc1
  s_branch L_V0_hx
L_V0_a:
  s_cmp_eq_u32 s63, 1
  s_cbranch_scc0 L_V0_b
  v_mov_b32 v6, 0
  v_mov_b32 v5, s79
  s_mov_b64 exec, 1
  buffer_atomic_add v5, v6, s[44:47], s77 offen sc1
  s_mov_b64 exec, -1
L_zf:
  v_readfirstlane_b32 s64, v127
  s_nop 3
  s_cmp_eq_u32 s64, 1
  s_cbranch_scc1 L_zf_ok
  s_sleep 8
  v_mov_b32 v6, 0
  buffer_load_dword v127, v6, s[44:47], 0 offen offset:160 sc0 sc1
  s_waitcnt vmcnt(0)
  s_branch L_zf
L_zf_ok:
  v_mov_b32 v122, 1
  v_mov_b32 v6, 0
  s_mov_b64 exec, 1
  buffer_atomic_add v122, v6, s[48:51], s11 offen sc0 sc1
  s_mov_b64 exec, -1
  s_branch L_V0_hx
L_V0_b:
  s_cmp_eq_u32 s63, 2
  s_cbranch_scc0 L_V0_c
  v_mov_b32 v6, 0
  buffer_load_dword v126, v6, s[44:47], s77 offen sc0 sc1
  v_mov_b32 v123, 1
  v_mov_b32 v6, 0
  s_mov_b64 exec, 1
  buffer_atomic_add v123, v6, s[48:51], s11 offen sc0 sc1
  s_mov_b64 exec, -1
  s_branch L_V0_hx
L_V0_c:
  v_readfirstlane_b32 s64, v126
  s_nop 3
L_chk_V0:
  s_lshr_b32 s64, s64, s78
  s_and_b32 s64, s64, 0xff
  s_cmp_eq_u32 s64, 4
  s_cbranch_scc1 L_ok_V0
  s_sleep 8
  v_mov_b32 v6, 0
  buffer_load_dword v126, v6, s[44:47], s77 offen sc0 sc1
  s_waitcnt vmcnt(0)
  v_readfirstlane_b32 s64, v126
  s_nop 3
  s_branch L_chk_V0
L_ok_V0:
  v_and_b32 v6, 3, v1
  v_lshlrev_b32 v6, 3, v6
  buffer_load_dwordx2 v[124:125], v6, s[48:51], s75 offen sc0 sc1
L_V0_hx:
  s_mul_i32 s64, s56, 192
  s_mul_i32 s68, s59, 24
  s_add_u32 s64, s64, s68
  s_mul_i32 s64, s64, 1280
  s_lshl_b32 s68, s63, 12
  s_add_u32 s64, s64, s68
  s_mul_i32 s65, s59, 15360
  s_add_u32 s65, s65, s68
  s_add_u32 s65, s65, 27136
  v_lshlrev_b32 v5, 4, v1
  s_mov_b32 m0, s65
  s_add_u32 s65, s65, 1024
  buffer_load_dwordx4 v5, s[40:43], s64 offen lds
  s_add_u32 s64, s64, 1024
  s_mov_b32 m0, s65
  s_add_u32 s65, s65, 1024
  buffer_load_dwordx4 v5, s[40:43], s64 offen lds
  s_add_u32 s64, s64, 1024
  s_mov_b32 m0, s65
  s_add_u32 s65, s65, 1024
  buffer_load_dwordx4 v5, s[40:43], s64 offen lds
  s_add_u32 s64, s64, 1024
  s_cmp_eq_u32 s63, 3
  s_cbranch_scc1 L_V0_nd
  s_mov_b32 m0, s65
  s_add_u32 s65, s65, 1024
  buffer_load_dwordx4 v5, s[40:43], s64 offen lds
  s_add_u32 s64, s64, 1024
L_V0_nd:
  ds_read_b128 v[32:35], v3 offset:0
  ds_read_b128 v[36:39], v3 offset:16
  ds_read_b128 v[40:43], v3 offset:32
  ds_read_b128 v[44:47], v3 offset:48
  ds_read_b128 v[48:51], v3 offset:64
  ds_read_b128 v[52:55], v3 offset:80
  ds_read_b128 v[56:59], v3 offset:96
  ds_read_b128 v[60:63], v3 offset:112
  s_waitcnt lgkmcnt(0)
  s_waitcnt vmcnt(31)
  v_lshlrev_b32 v26, 16, v32
  v_dot2c_f32_bf16 v14, v128, v32
  v_dot2c_f32_bf16 v16, v129, v32
  v_dot2c_f32_bf16 v18, v130, v32
  v_dot2c_f32_bf16 v15, v128, v26
  v_dot2c_f32_bf16 v17, v129, v26
  v_dot2c_f32_bf16 v19, v130, v26
  buffer_load_dwordx3 v[128:130], v2, s[52:55], s62 offen nt
  s_add_u32 s62, s62, 6144
  s_waitcnt vmcnt(31)
  v_lshlrev_b32 v27, 16, v33
  v_dot2c_f32_bf16 v14, v132, v33
  v_dot2c_f32_bf16 v16, v133, v33
  v_dot2c_f32_bf16 v18, v134, v33
  v_dot2c_f32_bf16 v15, v132, v27
  v_dot2c_f32_bf16 v17, v133, v27
  v_dot2c_f32_bf16 v19, v134, v27
  buffer_load_dwordx3 v[132:134], v2, s[52:55], s62 offen nt
  s_add_u32 s62, s62, 6144
  s_waitcnt vmcnt(31)
  v_lshlrev_b32 v26, 16, v34
  v_dot2c_f32_bf16 v14, v136, v34
  v_dot2c_f32_bf16 v16, v137, v34
  v_dot2c_f32_bf16 v18, v138, v34
  v_dot2c_f32_bf16 v15, v136, v26
  v_dot2c_f32_bf16 v17, v137, v26
  v_dot2c_f32_bf16 v19, v138, v26
  buffer_load_dwordx3 v[136:138], v2, s[52:55], s62 offen nt
  s_add_u32 s62, s62, 6144
  s_waitcnt vmcnt(31)
  v_lshlrev_b32 v27, 16, v35
  v_dot2c_f32_bf16 v14, v140, v35
  v_dot2c_f32_bf16 v16, v141, v35
  v_dot2c_f32_bf16 v18, v142, v35
  v_dot2c_f32_bf16 v15, v140, v27
  v_dot2c_f32_bf16 v17, v141, v27
  v_dot2c_f32_bf16 v19, v142, v27
  buffer_load_dwordx3 v[140:142], v2, s[52:55], s62 offen nt
  s_add_u32 s62, s62, 6144
  s_waitcnt vmcnt(31)
  v_lshlrev_b32 v26, 16, v36
  v_dot2c_f32_bf16 v14, v144, v36
  v_dot2c_f32_bf16 v16, v145, v36
  v_dot2c_f32_bf16 v18, v146, v36
  v_dot2c_f32_bf16 v15, v144, v26
  v_dot2c_f32_bf16 v17, v145, v26
  v_dot2c_f32_bf16 v19, v146, v26
  buffer_load_dwordx3 v[144:146], v2, s[52:55], s62 offen nt
  s_add_u32 s62, s62, 6144
  s_waitcnt vmcnt(31)
  v_lshlrev_b32 v27, 16, v37
  v_dot2c_f32_bf16 v14, v148, v37
  v_dot2c_f32_bf16 v16, v149, v37
  v_dot2c_f32_bf16 v18, v150, v37
  v_dot2c_f32_bf16 v15, v148, v27
  v_dot2c_f32_bf16 v17, v149, v27
  v_dot2c_f32_bf16 v19, v150, v27
  buffer_load_dwordx3 v[148:150], v2, s[52:55], s62 offen nt
  s_add_u32 s62, s62, 6144
  s_waitcnt vmcnt(31)
  v_lshlrev_b32 v26, 16, v38
  v_dot2c_f32_bf16 v14, v152, v38
  v_dot2c_f32_bf16 v16, v153, v38
  v_dot2c_f32_bf16 v18, v154, v38
  v_dot2c_f32_bf16 v15, v152, v26
  v_dot2c_f32_bf16 v17, v153, v26
  v_dot2c_f32_bf16 v19, v154, v26
  buffer_load_dwordx3 v[152:154], v2, s[52:55], s62 offen nt
  s_add_u32 s62, s62, 6144
  s_waitcnt vmcnt(31)
  v_lshlrev_b32 v27, 16, v39
  v_dot2c_f32_bf16 v14, v156, v39
  v_dot2c_f32_bf16 v16, v157, v39
  v_dot2c_f32_bf16 v18, v158, v39
  v_dot2c_f32_bf16 v15, v156, v27
  v_dot2c_f32_bf16 v17, v157, v27
  v_dot2c_f32_bf16 v19, v158, v27
  buffer_load_dwordx3 v[156:158], v2, s[52:55], s62 offen nt
  s_add_u32 s62, s62, 6144
  s_waitcnt vmcnt(31)
  v_lshlrev_b32 v26, 16, v40
  v_dot2c_f32_bf16 v14, v160, v40
  v_dot2c_f32_bf16 v16, v161, v40
  v_dot2c_f32_bf16 v18, v162, v40
  v_dot2c_f32_bf16 v15, v160, v26
  v_dot2c_f32_bf16 v17, v161, v26
  v_dot2c_f32_bf16 v19, v162, v26
  buffer_load_dwordx3 v[160:162], v2, s[52:55], s62 offen nt
  s_add_u32 s62, s62, 6144
  s_waitcnt vmcnt(31)
  v_lshlrev_b32 v27, 16, v41
  v_dot2c_f32_bf16 v14, v164, v41
  v_dot2c_f32_bf16 v16, v165, v41
  v_dot2c_f32_bf16 v18, v166, v41
  v_dot2c_f32_bf16 v15, v164, v27
  v_dot2c_f32_bf16 v17, v165, v27
  v_dot2c_f32_bf16 v19, v166, v27
  buffer_load_dwordx3 v[164:166], v2, s[52:55], s62 offen nt
  s_add_u32 s62, s62, 6144
  s_waitcnt vmcnt(31)
  v_lshlrev_b32 v26, 16, v42
  v_dot2c_f32_bf16 v14, v168, v42
  v_dot2c_f32_bf16 v16, v169, v42
  v_dot2c_f32_bf16 v18, v170, v42
  v_dot2c_f32_bf16 v15, v168, v26
  v_dot2c_f32_bf16 v17, v169, v26
  v_dot2c_f32_bf16 v19, v170, v26
  buffer_load_dwordx3 v[168:170], v2, s[52:55], s62 offen nt
  s_add_u32 s62, s62, 6144
  s_waitcnt vmcnt(31)
  v_lshlrev_b32 v27, 16, v43
  v_dot2c_f32_bf16 v14, v172, v43
  v_dot2c_f32_bf16 v16, v173, v43
  v_dot2c_f32_bf16 v18, v174, v43
  v_dot2c_f32_bf16 v15, v172, v27
  v_dot2c_f32_bf16 v17, v173, v27
  v_dot2c_f32_bf16 v19, v174, v27
  buffer_load_dwordx3 v[172:174], v2, s[52:55], s62 offen nt
  s_add_u32 s62, s62, 6144
  s_waitcnt vmcnt(31)
  v_lshlrev_b32 v26, 16, v44
  v_dot2c_f32_bf16 v14, v176, v44
  v_dot2c_f32_bf16 v16, v177, v44
  v_dot2c_f32_bf16 v18, v178, v44
  v_dot2c_f32_bf16 v15, v176, v26
  v_dot2c_f32_bf16 v17, v177, v26
  v_dot2c_f32_bf16 v19, v178, v26
  buffer_load_dwordx3 v[176:178], v2, s[52:55], s62 offen nt
  s_add_u32 s62, s62, 6144
  s_waitcnt vmcnt(31)
  v_lshlrev_b32 v27, 16, v45
  v_dot2c_f32_bf16 v14, v180, v45
  v_dot2c_f32_bf16 v16, v181, v45
  v_dot2c_f32_bf16 v18, v182, v45
  v_dot2c_f32_bf16 v15, v180, v27
  v_dot2c_f32_bf16 v17, v181, v27
  v_dot2c_f32_bf16 v19, v182, v27
  buffer_load_dwordx3 v[180:182], v2, s[52:55], s62 offen nt
  s_add_u32 s62, s62, 6144
  s_waitcnt vmcnt(31)
  v_lshlrev_b32 v26, 16, v46
  v_dot2c_f32_bf16 v14, v184, v46
  v_dot2c_f32_bf16 v16, v185, v46
  v_dot2c_f32_bf16 v18, v186, v46
  v_dot2c_f32_bf16 v15, v184, v26
  v_dot2c_f32_bf16 v17, v185, v26
  v_dot2c_f32_bf16 v19, v186, v26
  buffer_load_dwordx3 v[184:186], v2, s[52:55], s62 offen nt
  s_add_u32 s62, s62, 6144
  s_waitcnt vmcnt(31)
  v_lshlrev_b32 v27, 16, v47
  v_dot2c_f32_bf16 v14, v188, v47
  v_dot2c_f32_bf16 v16, v189, v47
  v_dot2c_f32_bf16 v18, v190, v47
  v_dot2c_f32_bf16 v15, v188, v27
  v_dot2c_f32_bf16 v17, v189, v27
  v_dot2c_f32_bf16 v19, v190, v27
  buffer_load_dwordx3 v[188:190], v2, s[52:55], s62 offen nt
  s_add_u32 s62, s62, 6144
  s_waitcnt vmcnt(31)
  v_lshlrev_b32 v26, 16, v48
  v_dot2c_f32_bf16 v14, v192, v48
  v_dot2c_f32_bf16 v16, v193, v48
  v_dot2c_f32_bf16 v18, v194, v48
  v_dot2c_f32_bf16 v15, v192, v26
  v_dot2c_f32_bf16 v17, v193, v26
  v_dot2c_f32_bf16 v19, v194, v26
  buffer_load_dwordx3 v[192:194], v2, s[52:55], s62 offen nt
  s_add_u32 s62, s62, 6144
  s_waitcnt vmcnt(31)
  v_lshlrev_b32 v27, 16, v49
  v_dot2c_f32_bf16 v14, v196, v49
  v_dot2c_f32_bf16 v16, v197, v49
  v_dot2c_f32_bf16 v18, v198, v49
  v_dot2c_f32_bf16 v15, v196, v27
  v_dot2c_f32_bf16 v17, v197, v27
  v_dot2c_f32_bf16 v19, v198, v27
  buffer_load_dwordx3 v[196:198], v2, s[52:55], s62 offen nt
  s_add_u32 s62, s62, 6144
  s_waitcnt vmcnt(31)
  v_lshlrev_b32 v26, 16, v50
  v_dot2c_f32_bf16 v14, v200, v50
  v_dot2c_f32_bf16 v16, v201, v50
  v_dot2c_f32_bf16 v18, v202, v50
  v_dot2c_f32_bf16 v15, v200, v26
  v_dot2c_f32_bf16 v17, v201, v26
  v_dot2c_f32_bf16 v19, v202, v26
  buffer_load_dwordx3 v[200:202], v2, s[52:55], s62 offen nt
  s_add_u32 s62, s62, 6144
  s_waitcnt vmcnt(31)
  v_lshlrev_b32 v27, 16, v51
  v_dot2c_f32_bf16 v14, v204, v51
  v_dot2c_f32_bf16 v16, v205, v51
  v_dot2c_f32_bf16 v18, v206, v51
  v_dot2c_f32_bf16 v15, v204, v27
  v_dot2c_f32_bf16 v17, v205, v27
  v_dot2c_f32_bf16 v19, v206, v27
  buffer_load_dwordx3 v[204:206], v2, s[52:55], s62 offen nt
  s_add_u32 s62, s62, 6144
  s_waitcnt vmcnt(31)
  v_lshlrev_b32 v26, 16, v52
  v_dot2c_f32_bf16 v14, v208, v52
  v_dot2c_f32_bf16 v16, v209, v52
  v_dot2c_f32_bf16 v18, v210, v52
  v_dot2c_f32_bf16 v15, v208, v26
  v_dot2c_f32_bf16 v17, v209, v26
  v_dot2c_f32_bf16 v19, v210, v26
  buffer_load_dwordx3 v[208:210], v2, s[52:55], s62 offen nt
  s_add_u32 s62, s62, 6144
  s_waitcnt vmcnt(31)
  v_lshlrev_b32 v27, 16, v53
  v_dot2c_f32_bf16 v14, v212, v53
  v_dot2c_f32_bf16 v16, v213, v53
  v_dot2c_f32_bf16 v18, v214, v53
  v_dot2c_f32_bf16 v15, v212, v27
  v_dot2c_f32_bf16 v17, v213, v27
  v_dot2c_f32_bf16 v19, v214, v27
  buffer_load_dwordx3 v[212:214], v2, s[52:55], s62 offen nt
  s_add_u32 s62, s62, 6144
  s_waitcnt vmcnt(31)
  v_lshlrev_b32 v26, 16, v54
  v_dot2c_f32_bf16 v14, v216, v54
  v_dot2c_f32_bf16 v16, v217, v54
  v_dot2c_f32_bf16 v18, v218, v54
  v_dot2c_f32_bf16 v15, v216, v26
  v_dot2c_f32_bf16 v17, v217, v26
  v_dot2c_f32_bf16 v19, v218, v26
  buffer_load_dwordx3 v[216:218], v2, s[52:55], s62 offen nt
  s_add_u32 s62, s62, 6144
  s_waitcnt vmcnt(31)
  v_lshlrev_b32 v27, 16, v55
  v_dot2c_f32_bf16 v14, v220, v55
  v_dot2c_f32_bf16 v16, v221, v55
  v_dot2c_f32_bf16 v18, v222, v55
  v_dot2c_f32_bf16 v15, v220, v27
  v_dot2c_f32_bf16 v17, v221, v27
  v_dot2c_f32_bf16 v19, v222, v27
  buffer_load_dwordx3 v[220:222], v2, s[52:55], s62 offen nt
  s_add_u32 s62, s62, 6144
  s_waitcnt vmcnt(31)
  v_lshlrev_b32 v26, 16, v56
  v_dot2c_f32_bf16 v14, v224, v56
  v_dot2c_f32_bf16 v16, v225, v56
  v_dot2c_f32_bf16 v18, v226, v56
  v_dot2c_f32_bf16 v15, v224, v26
  v_dot2c_f32_bf16 v17, v225, v26
  v_dot2c_f32_bf16 v19, v226, v26
  buffer_load_dwordx3 v[224:226], v2, s[52:55], s62 offen nt
  s_add_u32 s62, s62, 6144
  s_waitcnt vmcnt(31)
  v_lshlrev_b32 v27, 16, v57
  v_dot2c_f32_bf16 v14, v228, v57
  v_dot2c_f32_bf16 v16, v229, v57
  v_dot2c_f32_bf16 v18, v230, v57
  v_dot2c_f32_bf16 v15, v228, v27
  v_dot2c_f32_bf16 v17, v229, v27
  v_dot2c_f32_bf16 v19, v230, v27
  buffer_load_dwordx3 v[228:230], v2, s[52:55], s62 offen nt
  s_add_u32 s62, s62, 6144
  s_waitcnt vmcnt(31)
  v_lshlrev_b32 v26, 16, v58
  v_dot2c_f32_bf16 v14, v232, v58
  v_dot2c_f32_bf16 v16, v233, v58
  v_dot2c_f32_bf16 v18, v234, v58
  v_dot2c_f32_bf16 v15, v232, v26
  v_dot2c_f32_bf16 v17, v233, v26
  v_dot2c_f32_bf16 v19, v234, v26
  buffer_load_dwordx3 v[232:234], v2, s[52:55], s62 offen nt
  s_add_u32 s62, s62, 6144
  s_waitcnt vmcnt(31)
  v_lshlrev_b32 v27, 16, v59
  v_dot2c_f32_bf16 v14, v236, v59
  v_dot2c_f32_bf16 v16, v237, v59
  v_dot2c_f32_bf16 v18, v238, v59
  v_dot2c_f32_bf16 v15, v236, v27
  v_dot2c_f32_bf16 v17, v237, v27
  v_dot2c_f32_bf16 v19, v238, v27
  buffer_load_dwordx3 v[236:238], v2, s[52:55], s62 offen nt
  s_add_u32 s62, s62, 6144
  s_waitcnt vmcnt(31)
  v_lshlrev_b32 v26, 16, v60
  v_dot2c_f32_bf16 v14, v240, v60
  v_dot2c_f32_bf16 v16, v241, v60
  v_dot2c_f32_bf16 v18, v242, v60
  v_dot2c_f32_bf16 v15, v240, v26
  v_dot2c_f32_bf16 v17, v241, v26
  v_dot2c_f32_bf16 v19, v242, v26
  buffer_load_dwordx3 v[240:242], v2, s[52:55], s62 offen nt
  s_add_u32 s62, s62, 6144
  s_waitcnt vmcnt(31)
  v_lshlrev_b32 v27, 16, v61
  v_dot2c_f32_bf16 v14, v244, v61
  v_dot2c_f32_bf16 v16, v245, v61
  v_dot2c_f32_bf16 v18, v246, v61
  v_dot2c_f32_bf16 v15, v244, v27
  v_dot2c_f32_bf16 v17, v245, v27
  v_dot2c_f32_bf16 v19, v246, v27
  buffer_load_dwordx3 v[244:246], v2, s[52:55], s62 offen nt
  s_add_u32 s62, s62, 6144
  s_waitcnt vmcnt(31)
  v_lshlrev_b32 v26, 16, v62
  v_dot2c_f32_bf16 v14, v248, v62
  v_dot2c_f32_bf16 v16, v249, v62
  v_dot2c_f32_bf16 v18, v250, v62
  v_dot2c_f32_bf16 v15, v248, v26
  v_dot2c_f32_bf16 v17, v249, v26
  v_dot2c_f32_bf16 v19, v250, v26
  buffer_load_dwordx3 v[248:250], v2, s[52:55], s62 offen nt
  s_add_u32 s62, s62, 6144
  s_waitcnt vmcnt(31)
  v_lshlrev_b32 v27, 16, v63
  v_dot2c_f32_bf16 v14, v252, v63
  v_dot2c_f32_bf16 v16, v253, v63
  v_dot2c_f32_bf16 v18, v254, v63
  v_dot2c_f32_bf16 v15, v252, v27
  v_dot2c_f32_bf16 v17, v253, v27
  v_dot2c_f32_bf16 v19, v254, v27
  buffer_load_dwordx3 v[252:254], v2, s[52:55], s62 offen nt
  s_add_u32 s62, s62, 6144
  v_add_u32 v3, 128, v3
  s_add_u32 s63, s63, 1
  s_cmp_lt_u32 s63, 4
  s_cbranch_scc1 L_V0
  s_cmp_eq_u32 s59, 0
  s_cbranch_scc0 L_gs1
  v_mov_b32 v5, v124
  s_nop 1
  v_max_f32_dpp v5, v5, v5 quad_perm:[1,0,3,2] row_mask:0xf bank_mask:0xf
  s_nop 1
  v_max_f32_dpp v5, v5, v5 quad_perm:[2,3,0,1] row_mask:0xf bank_mask:0xf
  v_sub_f32 v124, v124, v5
  v_mul_f32 v124, s83, v124
  v_exp_f32 v124, v124
  s_nop 0
  v_mul_f32 v125, v125, v124
  s_nop 1
  v_add_f32_dpp v125, v125, v125 quad_perm:[1,0,3,2] row_mask:0xf bank_mask:0xf
  s_nop 1
  v_add_f32_dpp v125, v125, v125 quad_perm:[2,3,0,1] row_mask:0xf bank_mask:0xf
  v_mov_b32 v124, v5
  v_rcp_f32 v6, v125
  s_nop 0
  v_fma_f32 v5, -v125, v6, 1.0
  v_fma_f32 v125, v5, v6, v6
  v_mov_b32 v6, 0
  s_mov_b64 exec, 1
  ds_write_b64 v6, v[124:125] offset:27016
  s_mov_b64 exec, -1
L_gs1:
  s_mov_b32 s15, 0
L_V1:
  s_cmp_eq_u32 s59, 0
  s_cbranch_scc0 L_V1_w0
  s_waitcnt vmcnt(41)
  v_readfirstlane_b32 s64, v122
  s_nop 3
  s_mul_i32 s65, s64, 43
  s_lshr_b32 s65, s65, 8
  s_mul_i32 s68, s65, 6
  s_sub_u32 s68, s64, s68
  s_lshl_b32 s65, s65, 3
  s_add_u32 s65, s65, s68
  s_add_u32 s65, s65, 2
  s_cmp_lt_u32 s64, 24
  s_cselect_b32 s65, s65, 32
  v_mov_b32 v5, s65
  v_mov_b32 v6, 0
  s_mov_b64 exec, 1
  ds_write_b32 v6, v5 offset:27040
  s_mov_b64 exec, -1
  v_mov_b32 v122, 1
  v_mov_b32 v6, 0
  s_mov_b64 exec, 1
  buffer_atomic_add v122, v6, s[48:51], s11 offen sc0 sc1
  s_mov_b64 exec, -1
L_V1_w0:
  s_waitcnt lgkmcnt(0)
  s_barrier
  s_cmp_ge_u32 s12, 32
  s_cbranch_scc1 L_V1_done
  v_mov_b32 v6, 0
  ds_read_b32 v5, v6 offset:27040
  s_cmp_eq_u32 s15, 0
  s_cbranch_scc0 L_V1_ng0
  ds_read_b64 v[30:31], v6 offset:27016
L_V1_ng0:
  s_waitcnt vmcnt(36) lgkmcnt(0)
  v_readfirstlane_b32 s14, v5
  v_sub_f32 v32, v64, v30
  v_sub_f32 v33, v65, v30
  v_sub_f32 v34, v66, v30
  v_sub_f32 v35, v67, v30
  v_sub_f32 v36, v68, v30
  v_sub_f32 v37, v69, v30
  v_sub_f32 v38, v70, v30
  v_sub_f32 v39, v71, v30
  v_sub_f32 v40, v72, v30
  v_sub_f32 v41, v73, v30
  v_sub_f32 v42, v74, v30
  v_sub_f32 v43, v75, v30
  v_sub_f32 v44, v76, v30
  v_sub_f32 v45, v77, v30
  v_sub_f32 v46, v78, v30
  v_sub_f32 v47, v79, v30
  v_mul_f32 v32, s83, v32
  v_mul_f32 v33, s83, v33
  v_mul_f32 v34, s83, v34
  v_mul_f32 v35, s83, v35
  v_mul_f32 v36, s83, v36
  v_mul_f32 v37, s83, v37
  v_mul_f32 v38, s83, v38
  v_mul_f32 v39, s83, v39
  v_mul_f32 v40, s83, v40
  v_mul_f32 v41, s83, v41
  v_mul_f32 v42, s83, v42
  v_mul_f32 v43, s83, v43
  v_mul_f32 v44, s83, v44
  v_mul_f32 v45, s83, v45
  v_mul_f32 v46, s83, v46
  v_mul_f32 v47, s83, v47
  v_exp_f32 v32, v32
  v_exp_f32 v33, v33
  v_exp_f32 v34, v34
  v_exp_f32 v35, v35
  v_exp_f32 v36, v36
  v_exp_f32 v37, v37
  v_exp_f32 v38, v38
  v_exp_f32 v39, v39
  v_exp_f32 v40, v40
  v_exp_f32 v41, v41
  v_exp_f32 v42, v42
  v_exp_f32 v43, v43
  v_exp_f32 v44, v44
  v_exp_f32 v45, v45
  v_exp_f32 v46, v46
  v_exp_f32 v47, v47
  v_mov_b32 v6, 0
  v_mul_f32 v32, v32, v31
  v_mul_f32 v33, v33, v31
  v_mul_f32 v34, v34, v31
  v_mul_f32 v35, v35, v31
  v_mul_f32 v36, v36, v31
  v_mul_f32 v37, v37, v31
  v_mul_f32 v38, v38, v31
  v_mul_f32 v39, v39, v31
  v_mul_f32 v40, v40, v31
  v_mul_f32 v41, v41, v31
  v_mul_f32 v42, v42, v31
  v_mul_f32 v43, v43, v31
  v_mul_f32 v44, v44, v31
  v_mul_f32 v45, v45, v31
  v_mul_f32 v46, v46, v31
  v_mul_f32 v47, v47, v31
  v_cvt_pk_bf16_f32 v32, v32, v6
  v_cvt_pk_bf16_f32 v33, v33, v6
  v_cvt_pk_bf16_f32 v34, v34, v6
  v_cvt_pk_bf16_f32 v35, v35, v6
  v_cvt_pk_bf16_f32 v36, v36, v6
  v_cvt_pk_bf16_f32 v37, v37, v6
  v_cvt_pk_bf16_f32 v38, v38, v6
  v_cvt_pk_bf16_f32 v39, v39, v6
  v_cvt_pk_bf16_f32 v40, v40, v6
  v_cvt_pk_bf16_f32 v41, v41, v6
  v_cvt_pk_bf16_f32 v42, v42, v6
  v_cvt_pk_bf16_f32 v43, v43, v6
  v_cvt_pk_bf16_f32 v44, v44, v6
  v_cvt_pk_bf16_f32 v45, v45, v6
  v_cvt_pk_bf16_f32 v46, v46, v6
  v_cvt_pk_bf16_f32 v47, v47, v6
  s_lshr_b32 s64, s14, 3
  s_lshl_b32 s64, s64, 13
  s_and_b32 s65, s14, 7
  s_lshl_b32 s65, s65, 6
  s_add_u32 s64, s64, s65
  s_add_u32 s64, s64, s9
  buffer_load_dwordx4 v[64:67], v29, s[48:51], s64 offen offset:0 sc0 sc1
  buffer_load_dwordx4 v[68:71], v29, s[48:51], s64 offen offset:16 sc0 sc1
  buffer_load_dwordx4 v[72:75], v29, s[48:51], s64 offen offset:32 sc0 sc1
  buffer_load_dwordx4 v[76:79], v29, s[48:51], s64 offen offset:48 sc0 sc1
  s_mul_i32 s62, s14, 98304
  s_add_u32 s62, s62, s8
  s_cmp_lt_u32 s14, 32
  s_cselect_b32 s54, 402653184, 0
  s_waitcnt vmcnt(31)
  v_lshlrev_b32 v26, 16, v32
  v_dot2c_f32_bf16 v20, v128, v32
  v_dot2c_f32_bf16 v22, v129, v32
  v_dot2c_f32_bf16 v24, v130, v32
  v_dot2c_f32_bf16 v21, v128, v26
  v_dot2c_f32_bf16 v23, v129, v26
  v_dot2c_f32_bf16 v25, v130, v26
  buffer_load_dwordx3 v[128:130], v2, s[52:55], s62 offen nt
  s_add_u32 s62, s62, 6144
  s_waitcnt vmcnt(31)
  v_lshlrev_b32 v27, 16, v33
  v_dot2c_f32_bf16 v20, v132, v33
  v_dot2c_f32_bf16 v22, v133, v33
  v_dot2c_f32_bf16 v24, v134, v33
  v_dot2c_f32_bf16 v21, v132, v27
  v_dot2c_f32_bf16 v23, v133, v27
  v_dot2c_f32_bf16 v25, v134, v27
  buffer_load_dwordx3 v[132:134], v2, s[52:55], s62 offen nt
  s_add_u32 s62, s62, 6144
  s_waitcnt vmcnt(31)
  v_lshlrev_b32 v26, 16, v34
  v_dot2c_f32_bf16 v20, v136, v34
  v_dot2c_f32_bf16 v22, v137, v34
  v_dot2c_f32_bf16 v24, v138, v34
  v_dot2c_f32_bf16 v21, v136, v26
  v_dot2c_f32_bf16 v23, v137, v26
  v_dot2c_f32_bf16 v25, v138, v26
  buffer_load_dwordx3 v[136:138], v2, s[52:55], s62 offen nt
  s_add_u32 s62, s62, 6144
  s_waitcnt vmcnt(31)
  v_lshlrev_b32 v27, 16, v35
  v_dot2c_f32_bf16 v20, v140, v35
  v_dot2c_f32_bf16 v22, v141, v35
  v_dot2c_f32_bf16 v24, v142, v35
  v_dot2c_f32_bf16 v21, v140, v27
  v_dot2c_f32_bf16 v23, v141, v27
  v_dot2c_f32_bf16 v25, v142, v27
  buffer_load_dwordx3 v[140:142], v2, s[52:55], s62 offen nt
  s_add_u32 s62, s62, 6144
  s_waitcnt vmcnt(31)
  v_lshlrev_b32 v26, 16, v36
  v_dot2c_f32_bf16 v20, v144, v36
  v_dot2c_f32_bf16 v22, v145, v36
  v_dot2c_f32_bf16 v24, v146, v36
  v_dot2c_f32_bf16 v21, v144, v26
  v_dot2c_f32_bf16 v23, v145, v26
  v_dot2c_f32_bf16 v25, v146, v26
  buffer_load_dwordx3 v[144:146], v2, s[52:55], s62 offen nt
  s_add_u32 s62, s62, 6144
  s_waitcnt vmcnt(31)
  v_lshlrev_b32 v27, 16, v37
  v_dot2c_f32_bf16 v20, v148, v37
  v_dot2c_f32_bf16 v22, v149, v37
  v_dot2c_f32_bf16 v24, v150, v37
  v_dot2c_f32_bf16 v21, v148, v27
  v_dot2c_f32_bf16 v23, v149, v27
  v_dot2c_f32_bf16 v25, v150, v27
  buffer_load_dwordx3 v[148:150], v2, s[52:55], s62 offen nt
  s_add_u32 s62, s62, 6144
  s_waitcnt vmcnt(31)
  v_lshlrev_b32 v26, 16, v38
  v_dot2c_f32_bf16 v20, v152, v38
  v_dot2c_f32_bf16 v22, v153, v38
  v_dot2c_f32_bf16 v24, v154, v38
  v_dot2c_f32_bf16 v21, v152, v26
  v_dot2c_f32_bf16 v23, v153, v26
  v_dot2c_f32_bf16 v25, v154, v26
  buffer_load_dwordx3 v[152:154], v2, s[52:55], s62 offen nt
  s_add_u32 s62, s62, 6144
  s_waitcnt vmcnt(31)
  v_lshlrev_b32 v27, 16, v39
  v_dot2c_f32_bf16 v20, v156, v39
  v_dot2c_f32_bf16 v22, v157, v39
  v_dot2c_f32_bf16 v24, v158, v39
  v_dot2c_f32_bf16 v21, v156, v27
  v_dot2c_f32_bf16 v23, v157, v27
  v_dot2c_f32_bf16 v25, v158, v27
  buffer_load_dwordx3 v[156:158], v2, s[52:55], s62 offen nt
  s_add_u32 s62, s62, 6144
  s_waitcnt vmcnt(31)
  v_lshlrev_b32 v26, 16, v40
  v_dot2c_f32_bf16 v20, v160, v40
  v_dot2c_f32_bf16 v22, v161, v40
  v_dot2c_f32_bf16 v24, v162, v40
  v_dot2c_f32_bf16 v21, v160, v26
  v_dot2c_f32_bf16 v23, v161, v26
  v_dot2c_f32_bf16 v25, v162, v26
  buffer_load_dwordx3 v[160:162], v2, s[52:55], s62 offen nt
  s_add_u32 s62, s62, 6144
  s_waitcnt vmcnt(31)
  v_lshlrev_b32 v27, 16, v41
  v_dot2c_f32_bf16 v20, v164, v41
  v_dot2c_f32_bf16 v22, v165, v41
  v_dot2c_f32_bf16 v24, v166, v41
  v_dot2c_f32_bf16 v21, v164, v27
  v_dot2c_f32_bf16 v23, v165, v27
  v_dot2c_f32_bf16 v25, v166, v27
  buffer_load_dwordx3 v[164:166], v2, s[52:55], s62 offen nt
  s_add_u32 s62, s62, 6144
  s_waitcnt vmcnt(31)
  v_lshlrev_b32 v26, 16, v42
  v_dot2c_f32_bf16 v20, v168, v42
  v_dot2c_f32_bf16 v22, v169, v42
  v_dot2c_f32_bf16 v24, v170, v42
  v_dot2c_f32_bf16 v21, v168, v26
  v_dot2c_f32_bf16 v23, v169, v26
  v_dot2c_f32_bf16 v25, v170, v26
  buffer_load_dwordx3 v[168:170], v2, s[52:55], s62 offen nt
  s_add_u32 s62, s62, 6144
  s_waitcnt vmcnt(31)
  v_lshlrev_b32 v27, 16, v43
  v_dot2c_f32_bf16 v20, v172, v43
  v_dot2c_f32_bf16 v22, v173, v43
  v_dot2c_f32_bf16 v24, v174, v43
  v_dot2c_f32_bf16 v21, v172, v27
  v_dot2c_f32_bf16 v23, v173, v27
  v_dot2c_f32_bf16 v25, v174, v27
  buffer_load_dwordx3 v[172:174], v2, s[52:55], s62 offen nt
  s_add_u32 s62, s62, 6144
  s_waitcnt vmcnt(31)
  v_lshlrev_b32 v26, 16, v44
  v_dot2c_f32_bf16 v20, v176, v44
  v_dot2c_f32_bf16 v22, v177, v44
  v_dot2c_f32_bf16 v24, v178, v44
  v_dot2c_f32_bf16 v21, v176, v26
  v_dot2c_f32_bf16 v23, v177, v26
  v_dot2c_f32_bf16 v25, v178, v26
  buffer_load_dwordx3 v[176:178], v2, s[52:55], s62 offen nt
  s_add_u32 s62, s62, 6144
  s_waitcnt vmcnt(31)
  v_lshlrev_b32 v27, 16, v45
  v_dot2c_f32_bf16 v20, v180, v45
  v_dot2c_f32_bf16 v22, v181, v45
  v_dot2c_f32_bf16 v24, v182, v45
  v_dot2c_f32_bf16 v21, v180, v27
  v_dot2c_f32_bf16 v23, v181, v27
  v_dot2c_f32_bf16 v25, v182, v27
  buffer_load_dwordx3 v[180:182], v2, s[52:55], s62 offen nt
  s_add_u32 s62, s62, 6144
  s_waitcnt vmcnt(31)
  v_lshlrev_b32 v26, 16, v46
  v_dot2c_f32_bf16 v20, v184, v46
  v_dot2c_f32_bf16 v22, v185, v46
  v_dot2c_f32_bf16 v24, v186, v46
  v_dot2c_f32_bf16 v21, v184, v26
  v_dot2c_f32_bf16 v23, v185, v26
  v_dot2c_f32_bf16 v25, v186, v26
  buffer_load_dwordx3 v[184:186], v2, s[52:55], s62 offen nt
  s_add_u32 s62, s62, 6144
  s_waitcnt vmcnt(31)
  v_lshlrev_b32 v27, 16, v47
  v_dot2c_f32_bf16 v20, v188, v47
  v_dot2c_f32_bf16 v22, v189, v47
  v_dot2c_f32_bf16 v24, v190, v47
  v_dot2c_f32_bf16 v21, v188, v27
  v_dot2c_f32_bf16 v23, v189, v27
  v_dot2c_f32_bf16 v25, v190, v27
  buffer_load_dwordx3 v[188:190], v2, s[52:55], s62 offen nt
  s_add_u32 s62, s62, 6144
  s_mov_b32 s12, s13
  s_mov_b32 s13, s14
  s_add_u32 s15, s15, 1
  s_cmp_eq_u32 s59, 0
  s_cbranch_scc0 L_V1_w1
  s_waitcnt vmcnt(41)
  v_readfirstlane_b32 s64, v123
  s_nop 3
  s_mul_i32 s65, s64, 43
  s_lshr_b32 s65, s65, 8
  s_mul_i32 s68, s65, 6
  s_sub_u32 s68, s64, s68
  s_lshl_b32 s65, s65, 3
  s_add_u32 s65, s65, s68
  s_add_u32 s65, s65, 2
  s_cmp_lt_u32 s64, 24
  s_cselect_b32 s65, s65, 32
  v_mov_b32 v5, s65
  v_mov_b32 v6, 0
  s_mov_b64 exec, 1
  ds_write_b32 v6, v5 offset:27044
  s_mov_b64 exec, -1
  v_mov_b32 v123, 1
  v_mov_b32 v6, 0
  s_mov_b64 exec, 1
  buffer_atomic_add v123, v6, s[48:51], s11 offen sc0 sc1
  s_mov_b64 exec, -1
L_V1_w1:
  s_waitcnt lgkmcnt(0)
  s_barrier
  s_cmp_ge_u32 s12, 32
  s_cbranch_scc1 L_V1_done
  v_mov_b32 v6, 0
  ds_read_b32 v5, v6 offset:27044
  s_cmp_eq_u32 s15, 0
  s_cbranch_scc0 L_V1_ng1
  ds_read_b64 v[30:31], v6 offset:27016
L_V1_ng1:
  s_waitcnt vmcnt(36) lgkmcnt(0)
  v_readfirstlane_b32 s14, v5
  v_sub_f32 v32, v80, v30
  v_sub_f32 v33, v81, v30
  v_sub_f32 v34, v82, v30
  v_sub_f32 v35, v83, v30
  v_sub_f32 v36, v84, v30
  v_sub_f32 v37, v85, v30
  v_sub_f32 v38, v86, v30
  v_sub_f32 v39, v87, v30
  v_sub_f32 v40, v88, v30
  v_sub_f32 v41, v89, v30
  v_sub_f32 v42, v90, v30
  v_sub_f32 v43, v91, v30
  v_sub_f32 v44, v92, v30
  v_sub_f32 v45, v93, v30
  v_sub_f32 v46, v94, v30
  v_sub_f32 v47, v95, v30
  v_mul_f32 v32, s83, v32
  v_mul_f32 v33, s83, v33
  v_mul_f32 v34, s83, v34
  v_mul_f32 v35, s83, v35
  v_mul_f32 v36, s83, v36
  v_mul_f32 v37, s83, v37
  v_mul_f32 v38, s83, v38
  v_mul_f32 v39, s83, v39
  v_mul_f32 v40, s83, v40
  v_mul_f32 v41, s83, v41
  v_mul_f32 v42, s83, v42
  v_mul_f32 v43, s83, v43
  v_mul_f32 v44, s83, v44
  v_mul_f32 v45, s83, v45
  v_mul_f32 v46, s83, v46
  v_mul_f32 v47, s83, v47
  v_exp_f32 v32, v32
  v_exp_f32 v33, v33
  v_exp_f32 v34, v34
  v_exp_f32 v35, v35
  v_exp_f32 v36, v36
  v_exp_f32 v37, v37
  v_exp_f32 v38, v38
  v_exp_f32 v39, v39
  v_exp_f32 v40, v40
  v_exp_f32 v41, v41
  v_exp_f32 v42, v42
  v_exp_f32 v43, v43
  v_exp_f32 v44, v44
  v_exp_f32 v45, v45
  v_exp_f32 v46, v46
  v_exp_f32 v47, v47
  v_mov_b32 v6, 0
  v_mul_f32 v32, v32, v31
  v_mul_f32 v33, v33, v31
  v_mul_f32 v34, v34, v31
  v_mul_f32 v35, v35, v31
  v_mul_f32 v36, v36, v31
  v_mul_f32 v37, v37, v31
  v_mul_f32 v38, v38, v31
  v_mul_f32 v39, v39, v31
  v_mul_f32 v40, v40, v31
  v_mul_f32 v41, v41, v31
  v_mul_f32 v42, v42, v31
  v_mul_f32 v43, v43, v31
  v_mul_f32 v44, v44, v31
  v_mul_f32 v45, v45, v31
  v_mul_f32 v46, v46, v31
  v_mul_f32 v47, v47, v31
  v_cvt_pk_bf16_f32 v32, v32, v6
  v_cvt_pk_bf16_f32 v33, v33, v6
  v_cvt_pk_bf16_f32 v34, v34, v6
  v_cvt_pk_bf16_f32 v35, v35, v6
  v_cvt_pk_bf16_f32 v36, v36, v6
  v_cvt_pk_bf16_f32 v37, v37, v6
  v_cvt_pk_bf16_f32 v38, v38, v6
  v_cvt_pk_bf16_f32 v39, v39, v6
  v_cvt_pk_bf16_f32 v40, v40, v6
  v_cvt_pk_bf16_f32 v41, v41, v6
  v_cvt_pk_bf16_f32 v42, v42, v6
  v_cvt_pk_bf16_f32 v43, v43, v6
  v_cvt_pk_bf16_f32 v44, v44, v6
  v_cvt_pk_bf16_f32 v45, v45, v6
  v_cvt_pk_bf16_f32 v46, v46, v6
  v_cvt_pk_bf16_f32 v47, v47, v6
  s_lshr_b32 s64, s14, 3
  s_lshl_b32 s64, s64, 13
  s_and_b32 s65, s14, 7
  s_lshl_b32 s65, s65, 6
  s_add_u32 s64, s64, s65
  s_add_u32 s64, s64, s9
  buffer_load_dwordx4 v[80:83], v29, s[48:51], s64 offen offset:0 sc0 sc1
  buffer_load_dwordx4 v[84:87], v29, s[48:51], s64 offen offset:16 sc0 sc1
  buffer_load_dwordx4 v[88:91], v29, s[48:51], s64 offen offset:32 sc0 sc1
  buffer_load_dwordx4 v[92:95], v29, s[48:51], s64 offen offset:48 sc0 sc1
  s_mul_i32 s62, s14, 98304
  s_add_u32 s62, s62, s8
  s_cmp_lt_u32 s14, 32
  s_cselect_b32 s54, 402653184, 0
  s_waitcnt vmcnt(31)
  v_lshlrev_b32 v26, 16, v32
  v_dot2c_f32_bf16 v20, v192, v32
  v_dot2c_f32_bf16 v22, v193, v32
  v_dot2c_f32_bf16 v24, v194, v32
  v_dot2c_f32_bf16 v21, v192, v26
  v_dot2c_f32_bf16 v23, v193, v26
  v_dot2c_f32_bf16 v25, v194, v26
  buffer_load_dwordx3 v[192:194], v2, s[52:55], s62 offen nt
  s_add_u32 s62, s62, 6144
  s_waitcnt vmcnt(31)
  v_lshlrev_b32 v27, 16, v33
  v_dot2c_f32_bf16 v20, v196, v33
  v_dot2c_f32_bf16 v22, v197, v33
  v_dot2c_f32_bf16 v24, v198, v33
  v_dot2c_f32_bf16 v21, v196, v27
  v_dot2c_f32_bf16 v23, v197, v27
  v_dot2c_f32_bf16 v25, v198, v27
  buffer_load_dwordx3 v[196:198], v2, s[52:55], s62 offen nt
  s_add_u32 s62, s62, 6144
  s_waitcnt vmcnt(31)
  v_lshlrev_b32 v26, 16, v34
  v_dot2c_f32_bf16 v20, v200, v34
  v_dot2c_f32_bf16 v22, v201, v34
  v_dot2c_f32_bf16 v24, v202, v34
  v_dot2c_f32_bf16 v21, v200, v26
  v_dot2c_f32_bf16 v23, v201, v26
  v_dot2c_f32_bf16 v25, v202, v26
  buffer_load_dwordx3 v[200:202], v2, s[52:55], s62 offen nt
  s_add_u32 s62, s62, 6144
  s_waitcnt vmcnt(31)
  v_lshlrev_b32 v27, 16, v35
  v_dot2c_f32_bf16 v20, v204, v35
  v_dot2c_f32_bf16 v22, v205, v35
  v_dot2c_f32_bf16 v24, v206, v35
  v_dot2c_f32_bf16 v21, v204, v27
  v_dot2c_f32_bf16 v23, v205, v27
  v_dot2c_f32_bf16 v25, v206, v27
  buffer_load_dwordx3 v[204:206], v2, s[52:55], s62 offen nt
  s_add_u32 s62, s62, 6144
  s_waitcnt vmcnt(31)
  v_lshlrev_b32 v26, 16, v36
  v_dot2c_f32_bf16 v20, v208, v36
  v_dot2c_f32_bf16 v22, v209, v36
  v_dot2c_f32_bf16 v24, v210, v36
  v_dot2c_f32_bf16 v21, v208, v26
  v_dot2c_f32_bf16 v23, v209, v26
  v_dot2c_f32_bf16 v25, v210, v26
  buffer_load_dwordx3 v[208:210], v2, s[52:55], s62 offen nt
  s_add_u32 s62, s62, 6144
  s_waitcnt vmcnt(31)
  v_lshlrev_b32 v27, 16, v37
  v_dot2c_f32_bf16 v20, v212, v37
  v_dot2c_f32_bf16 v22, v213, v37
  v_dot2c_f32_bf16 v24, v214, v37
  v_dot2c_f32_bf16 v21, v212, v27
  v_dot2c_f32_bf16 v23, v213, v27
  v_dot2c_f32_bf16 v25, v214, v27
  buffer_load_dwordx3 v[212:214], v2, s[52:55], s62 offen nt
  s_add_u32 s62, s62, 6144
  s_waitcnt vmcnt(31)
  v_lshlrev_b32 v26, 16, v38
  v_dot2c_f32_bf16 v20, v216, v38
  v_dot2c_f32_bf16 v22, v217, v38
  v_dot2c_f32_bf16 v24, v218, v38
  v_dot2c_f32_bf16 v21, v216, v26
  v_dot2c_f32_bf16 v23, v217, v26
  v_dot2c_f32_bf16 v25, v218, v26
  buffer_load_dwordx3 v[216:218], v2, s[52:55], s62 offen nt
  s_add_u32 s62, s62, 6144
  s_waitcnt vmcnt(31)
  v_lshlrev_b32 v27, 16, v39
  v_dot2c_f32_bf16 v20, v220, v39
  v_dot2c_f32_bf16 v22, v221, v39
  v_dot2c_f32_bf16 v24, v222, v39
  v_dot2c_f32_bf16 v21, v220, v27
  v_dot2c_f32_bf16 v23, v221, v27
  v_dot2c_f32_bf16 v25, v222, v27
  buffer_load_dwordx3 v[220:222], v2, s[52:55], s62 offen nt
  s_add_u32 s62, s62, 6144
  s_waitcnt vmcnt(31)
  v_lshlrev_b32 v26, 16, v40
  v_dot2c_f32_bf16 v20, v224, v40
  v_dot2c_f32_bf16 v22, v225, v40
  v_dot2c_f32_bf16 v24, v226, v40
  v_dot2c_f32_bf16 v21, v224, v26
  v_dot2c_f32_bf16 v23, v225, v26
  v_dot2c_f32_bf16 v25, v226, v26
  buffer_load_dwordx3 v[224:226], v2, s[52:55], s62 offen nt
  s_add_u32 s62, s62, 6144
  s_waitcnt vmcnt(31)
  v_lshlrev_b32 v27, 16, v41
  v_dot2c_f32_bf16 v20, v228, v41
  v_dot2c_f32_bf16 v22, v229, v41
  v_dot2c_f32_bf16 v24, v230, v41
  v_dot2c_f32_bf16 v21, v228, v27
  v_dot2c_f32_bf16 v23, v229, v27
  v_dot2c_f32_bf16 v25, v230, v27
  buffer_load_dwordx3 v[228:230], v2, s[52:55], s62 offen nt
  s_add_u32 s62, s62, 6144
  s_waitcnt vmcnt(31)
  v_lshlrev_b32 v26, 16, v42
  v_dot2c_f32_bf16 v20, v232, v42
  v_dot2c_f32_bf16 v22, v233, v42
  v_dot2c_f32_bf16 v24, v234, v42
  v_dot2c_f32_bf16 v21, v232, v26
  v_dot2c_f32_bf16 v23, v233, v26
  v_dot2c_f32_bf16 v25, v234, v26
  buffer_load_dwordx3 v[232:234], v2, s[52:55], s62 offen nt
  s_add_u32 s62, s62, 6144
  s_waitcnt vmcnt(31)
  v_lshlrev_b32 v27, 16, v43
  v_dot2c_f32_bf16 v20, v236, v43
  v_dot2c_f32_bf16 v22, v237, v43
  v_dot2c_f32_bf16 v24, v238, v43
  v_dot2c_f32_bf16 v21, v236, v27
  v_dot2c_f32_bf16 v23, v237, v27
  v_dot2c_f32_bf16 v25, v238, v27
  buffer_load_dwordx3 v[236:238], v2, s[52:55], s62 offen nt
  s_add_u32 s62, s62, 6144
  s_waitcnt vmcnt(31)
  v_lshlrev_b32 v26, 16, v44
  v_dot2c_f32_bf16 v20, v240, v44
  v_dot2c_f32_bf16 v22, v241, v44
  v_dot2c_f32_bf16 v24, v242, v44
  v_dot2c_f32_bf16 v21, v240, v26
  v_dot2c_f32_bf16 v23, v241, v26
  v_dot2c_f32_bf16 v25, v242, v26
  buffer_load_dwordx3 v[240:242], v2, s[52:55], s62 offen nt
  s_add_u32 s62, s62, 6144
  s_waitcnt vmcnt(31)
  v_lshlrev_b32 v27, 16, v45
  v_dot2c_f32_bf16 v20, v244, v45
  v_dot2c_f32_bf16 v22, v245, v45
  v_dot2c_f32_bf16 v24, v246, v45
  v_dot2c_f32_bf16 v21, v244, v27
  v_dot2c_f32_bf16 v23, v245, v27
  v_dot2c_f32_bf16 v25, v246, v27
  buffer_load_dwordx3 v[244:246], v2, s[52:55], s62 offen nt
  s_add_u32 s62, s62, 6144
  s_waitcnt vmcnt(31)
  v_lshlrev_b32 v26, 16, v46
  v_dot2c_f32_bf16 v20, v248, v46
  v_dot2c_f32_bf16 v22, v249, v46
  v_dot2c_f32_bf16 v24, v250, v46
  v_dot2c_f32_bf16 v21, v248, v26
  v_dot2c_f32_bf16 v23, v249, v26
  v_dot2c_f32_bf16 v25, v250, v26
  buffer_load_dwordx3 v[248:250], v2, s[52:55], s62 offen nt
  s_add_u32 s62, s62, 6144
  s_waitcnt vmcnt(31)
  v_lshlrev_b32 v27, 16, v47
  v_dot2c_f32_bf16 v20, v252, v47
  v_dot2c_f32_bf16 v22, v253, v47
  v_dot2c_f32_bf16 v24, v254, v47
  v_dot2c_f32_bf16 v21, v252, v27
  v_dot2c_f32_bf16 v23, v253, v27
  v_dot2c_f32_bf16 v25, v254, v27
  buffer_load_dwordx3 v[252:254], v2, s[52:55], s62 offen nt
  s_add_u32 s62, s62, 6144
  s_mov_b32 s12, s13
  s_mov_b32 s13, s14
  s_add_u32 s15, s15, 1
  s_branch L_V1
L_V1_done:
  s_waitcnt vmcnt(0)
  s_mul_i32 s64, s56, 192
  s_mul_i32 s68, s59, 24
  s_add_u32 s64, s64, s68
  s_add_u32 s64, s64, 12
  s_mul_i32 s64, s64, 1280
  v_lshlrev_b32 v28, 4, v1
  v_lshlrev_b32 v29, 2, v1
  buffer_load_dwordx4 v[32:35], v28, s[40:43], s64 offen
  buffer_load_dword v80, v29, s[40:43], s64 offen offset:1024
  s_add_u32 s64, s64, 1280
  buffer_load_dwordx4 v[36:39], v28, s[40:43], s64 offen
  buffer_load_dword v81, v29, s[40:43], s64 offen offset:1024
  s_add_u32 s64, s64, 1280
  buffer_load_dwordx4 v[40:43], v28, s[40:43], s64 offen
  buffer_load_dword v82, v29, s[40:43], s64 offen offset:1024
  s_add_u32 s64, s64, 1280
  buffer_load_dwordx4 v[44:47], v28, s[40:43], s64 offen
  buffer_load_dword v83, v29, s[40:43], s64 offen offset:1024
  s_add_u32 s64, s64, 1280
  buffer_load_dwordx4 v[48:51], v28, s[40:43], s64 offen
  buffer_load_dword v84, v29, s[40:43], s64 offen offset:1024
  s_add_u32 s64, s64, 1280
  buffer_load_dwordx4 v[52:55], v28, s[40:43], s64 offen
  buffer_load_dword v85, v29, s[40:43], s64 offen offset:1024
  s_add_u32 s64, s64, 1280
  buffer_load_dwordx4 v[56:59], v28, s[40:43], s64 offen
  buffer_load_dword v86, v29, s[40:43], s64 offen offset:1024
  s_add_u32 s64, s64, 1280
  buffer_load_dwordx4 v[60:63], v28, s[40:43], s64 offen
  buffer_load_dword v87, v29, s[40:43], s64 offen offset:1024
  s_add_u32 s64, s64, 1280
  buffer_load_dwordx4 v[64:67], v28, s[40:43], s64 offen
  buffer_load_dword v88, v29, s[40:43], s64 offen offset:1024
  s_add_u32 s64, s64, 1280
  buffer_load_dwordx4 v[68:71], v28, s[40:43], s64 offen
  buffer_load_dword v89, v29, s[40:43], s64 offen offset:1024
  s_add_u32 s64, s64, 1280
  buffer_load_dwordx4 v[72:75], v28, s[40:43], s64 offen
  buffer_load_dword v90, v29, s[40:43], s64 offen offset:1024
  s_add_u32 s64, s64, 1280
  buffer_load_dwordx4 v[76:79], v28, s[40:43], s64 offen
  buffer_load_dword v91, v29, s[40:43], s64 offen offset:1024
  s_add_u32 s64, s64, 1280
  v_lshrrev_b32 v5, 5, v1
  s_lshl_b32 s64, s59, 1
  v_add_u32 v5, s64, v5
  v_mul_u32_u24 v5, 768, v5
  v_and_b32 v6, 31, v1
  v_mul_u32_u24 v6, 24, v6
  v_add_u32 v5, v5, v6
  ds_write_b64 v5, v[14:15] offset:0
  ds_write_b64 v5, v[16:17] offset:8
  ds_write_b64 v5, v[18:19] offset:16
  ds_write_b64 v5, v[20:21] offset:12288
  ds_write_b64 v5, v[22:23] offset:12296
  ds_write_b64 v5, v[24:25] offset:12304
  s_waitcnt lgkmcnt(0)
  s_barrier
  v_cmp_gt_u32 vcc, 384, v0
  s_and_saveexec_b64 s[64:65], vcc
  s_cbranch_execz L_cw_o
  v_cmp_le_u32 vcc, 192, v0
  v_mov_b32 v6, 0
  v_mov_b32 v5, 11520
  s_nop 0
  v_cndmask_b32 v6, v6, v5, vcc
  v_lshlrev_b32 v5, 2, v0
  v_add_u32 v5, v5, v6
  ds_read_b32 v92, v5 offset:0
  ds_read_b32 v93, v5 offset:768
  ds_read_b32 v94, v5 offset:1536
  ds_read_b32 v95, v5 offset:2304
  ds_read_b32 v96, v5 offset:3072
  ds_read_b32 v97, v5 offset:3840
  ds_read_b32 v98, v5 offset:4608
  ds_read_b32 v99, v5 offset:5376
  ds_read_b32 v100, v5 offset:6144
  ds_read_b32 v101, v5 offset:6912
  ds_read_b32 v102, v5 offset:7680
  ds_read_b32 v103, v5 offset:8448
  ds_read_b32 v104, v5 offset:9216
  ds_read_b32 v105, v5 offset:9984
  ds_read_b32 v106, v5 offset:10752
  ds_read_b32 v107, v5 offset:11520
  s_waitcnt lgkmcnt(0)
  v_add_f32 v92, v92, v100
  v_add_f32 v93, v93, v101
  v_add_f32 v94, v94, v102
  v_add_f32 v95, v95, v103
  v_add_f32 v96, v96, v104
  v_add_f32 v97, v97, v105
  v_add_f32 v98, v98, v106
  v_add_f32 v99, v99, v107
  v_add_f32 v92, v92, v96
  v_add_f32 v93, v93, v97
  v_add_f32 v94, v94, v98
  v_add_f32 v95, v95, v99
  v_add_f32 v92, v92, v94
  v_add_f32 v93, v93, v95
  v_add_f32 v92, v92, v93
  v_lshlrev_b32 v5, 3, v0
  v_mov_b32 v6, 0
  v_mov_b32 v93, 1532
  v_cndmask_b32 v6, v6, v93, vcc
  v_sub_u32 v5, v5, v6
  ds_write_b32 v5, v92 offset:25344
L_cw_o:
  s_mov_b64 exec, -1
  s_waitcnt lgkmcnt(0)
  s_barrier
  s_mul_i32 s64, s59, 192
  v_mov_b32 v7, s64
  ds_read_b128 v[122:125], v7 offset:25344
  ds_read_b128 v[126:129], v7 offset:25360
  ds_read_b128 v[130:133], v7 offset:25376
  ds_read_b128 v[134:137], v7 offset:25392
  ds_read_b128 v[138:141], v7 offset:25408
  ds_read_b128 v[142:145], v7 offset:25424
  ds_read_b128 v[146:149], v7 offset:25440
  ds_read_b128 v[150:153], v7 offset:25456
  ds_read_b128 v[154:157], v7 offset:25472
  ds_read_b128 v[158:161], v7 offset:25488
  ds_read_b128 v[162:165], v7 offset:25504
  ds_read_b128 v[166:169], v7 offset:25520
  v_mov_b32 v170, 0
  v_mov_b32 v171, 0
  v_mov_b32 v172, 0
  v_mov_b32 v173, 0
  v_mov_b32 v174, 0
  v_mov_b32 v175, 0
  v_mov_b32 v176, 0
  v_mov_b32 v177, 0
  v_mov_b32 v178, 0
  v_mov_b32 v179, 0
  v_mov_b32 v180, 0
  v_mov_b32 v181, 0
  v_mov_b32 v182, 0
  v_mov_b32 v183, 0
  v_mov_b32 v184, 0
  v_mov_b32 v185, 0
  v_mov_b32 v186, 0
  v_mov_b32 v187, 0
  v_mov_b32 v188, 0
  v_mov_b32 v189, 0
  s_mul_i32 s64, s59, 15360
  v_add_u32 v26, s64, v28
  v_add_u32 v27, s64, v29
  ds_read_b128 v[92:95], v26 offset:27136
  ds_read_b32 v116, v27 offset:28160
  ds_read_b128 v[96:99], v26 offset:28416
  ds_read_b32 v117, v27 offset:29440
  ds_read_b128 v[100:103], v26 offset:29696
  ds_read_b32 v118, v27 offset:30720
  ds_read_b128 v[104:107], v26 offset:30976
  ds_read_b32 v119, v27 offset:32000
  ds_read_b128 v[108:111], v26 offset:32256
  ds_read_b32 v120, v27 offset:33280
  ds_read_b128 v[112:115], v26 offset:33536
  ds_read_b32 v121, v27 offset:34560
  s_waitcnt lgkmcnt(0)
  v_lshlrev_b32 v5, 16, v92
  v_and_b32 v6, 0xffff0000, v92
  v_fmac_f32 v170, v5, v122
  v_fmac_f32 v171, v6, v122
  v_fmac_f32 v180, v5, v123
  v_fmac_f32 v181, v6, v123
  v_lshlrev_b32 v5, 16, v93
  v_and_b32 v6, 0xffff0000, v93
  v_fmac_f32 v172, v5, v122
  v_fmac_f32 v173, v6, v122
  v_fmac_f32 v182, v5, v123
  v_fmac_f32 v183, v6, v123
  v_lshlrev_b32 v5, 16, v94
  v_and_b32 v6, 0xffff0000, v94
  v_fmac_f32 v174, v5, v122
  v_fmac_f32 v175, v6, v122
  v_fmac_f32 v184, v5, v123
  v_fmac_f32 v185, v6, v123
  v_lshlrev_b32 v5, 16, v95
  v_and_b32 v6, 0xffff0000, v95
  v_fmac_f32 v176, v5, v122
  v_fmac_f32 v177, v6, v122
  v_fmac_f32 v186, v5, v123
  v_fmac_f32 v187, v6, v123
  v_lshlrev_b32 v5, 16, v116
  v_and_b32 v6, 0xffff0000, v116
  v_fmac_f32 v178, v5, v122
  v_fmac_f32 v179, v6, v122
  v_fmac_f32 v188, v5, v123
  v_fmac_f32 v189, v6, v123
  v_lshlrev_b32 v5, 16, v96
  v_and_b32 v6, 0xffff0000, v96
  v_fmac_f32 v170, v5, v124
  v_fmac_f32 v171, v6, v124
  v_fmac_f32 v180, v5, v125
  v_fmac_f32 v181, v6, v125
  v_lshlrev_b32 v5, 16, v97
  v_and_b32 v6, 0xffff0000, v97
  v_fmac_f32 v172, v5, v124
  v_fmac_f32 v173, v6, v124
  v_fmac_f32 v182, v5, v125
  v_fmac_f32 v183, v6, v125
  v_lshlrev_b32 v5, 16, v98
  v_and_b32 v6, 0xffff0000, v98
  v_fmac_f32 v174, v5, v124
  v_fmac_f32 v175, v6, v124
  v_fmac_f32 v184, v5, v125
  v_fmac_f32 v185, v6, v125
  v_lshlrev_b32 v5, 16, v99
  v_and_b32 v6, 0xffff0000, v99
  v_fmac_f32 v176, v5, v124
  v_fmac_f32 v177, v6, v124
  v_fmac_f32 v186, v5, v125
  v_fmac_f32 v187, v6, v125
  v_lshlrev_b32 v5, 16, v117
  v_and_b32 v6, 0xffff0000, v117
  v_fmac_f32 v178, v5, v124
  v_fmac_f32 v179, v6, v124
  v_fmac_f32 v188, v5, v125
  v_fmac_f32 v189, v6, v125
  v_lshlrev_b32 v5, 16, v100
  v_and_b32 v6, 0xffff0000, v100
  v_fmac_f32 v170, v5, v126
  v_fmac_f32 v171, v6, v126
  v_fmac_f32 v180, v5, v127
  v_fmac_f32 v181, v6, v127
  v_lshlrev_b32 v5, 16, v101
  v_and_b32 v6, 0xffff0000, v101
  v_fmac_f32 v172, v5, v126
  v_fmac_f32 v173, v6, v126
  v_fmac_f32 v182, v5, v127
  v_fmac_f32 v183, v6, v127
  v_lshlrev_b32 v5, 16, v102
  v_and_b32 v6, 0xffff0000, v102
  v_fmac_f32 v174, v5, v126
  v_fmac_f32 v175, v6, v126
  v_fmac_f32 v184, v5, v127
  v_fmac_f32 v185, v6, v127
  v_lshlrev_b32 v5, 16, v103
  v_and_b32 v6, 0xffff0000, v103
  v_fmac_f32 v176, v5, v126
  v_fmac_f32 v177, v6, v126
  v_fmac_f32 v186, v5, v127
  v_fmac_f32 v187, v6, v127
  v_lshlrev_b32 v5, 16, v118
  v_and_b32 v6, 0xffff0000, v118
  v_fmac_f32 v178, v5, v126
  v_fmac_f32 v179, v6, v126
  v_fmac_f32 v188, v5, v127
  v_fmac_f32 v189, v6, v127
  v_lshlrev_b32 v5, 16, v104
  v_and_b32 v6, 0xffff0000, v104
  v_fmac_f32 v170, v5, v128
  v_fmac_f32 v171, v6, v128
  v_fmac_f32 v180, v5, v129
  v_fmac_f32 v181, v6, v129
  v_lshlrev_b32 v5, 16, v105
  v_and_b32 v6, 0xffff0000, v105
  v_fmac_f32 v172, v5, v128
  v_fmac_f32 v173, v6, v128
  v_fmac_f32 v182, v5, v129
  v_fmac_f32 v183, v6, v129
  v_lshlrev_b32 v5, 16, v106
  v_and_b32 v6, 0xffff0000, v106
  v_fmac_f32 v174, v5, v128
  v_fmac_f32 v175, v6, v128
  v_fmac_f32 v184, v5, v129
  v_fmac_f32 v185, v6, v129
  v_lshlrev_b32 v5, 16, v107
  v_and_b32 v6, 0xffff0000, v107
  v_fmac_f32 v176, v5, v128
  v_fmac_f32 v177, v6, v128
  v_fmac_f32 v186, v5, v129
  v_fmac_f32 v187, v6, v129
  v_lshlrev_b32 v5, 16, v119
  v_and_b32 v6, 0xffff0000, v119
  v_fmac_f32 v178, v5, v128
  v_fmac_f32 v179, v6, v128
  v_fmac_f32 v188, v5, v129
  v_fmac_f32 v189, v6, v129
  v_lshlrev_b32 v5, 16, v108
  v_and_b32 v6, 0xffff0000, v108
  v_fmac_f32 v170, v5, v130
  v_fmac_f32 v171, v6, v130
  v_fmac_f32 v180, v5, v131
  v_fmac_f32 v181, v6, v131
  v_lshlrev_b32 v5, 16, v109
  v_and_b32 v6, 0xffff0000, v109
  v_fmac_f32 v172, v5, v130
  v_fmac_f32 v173, v6, v130
  v_fmac_f32 v182, v5, v131
  v_fmac_f32 v183, v6, v131
  v_lshlrev_b32 v5, 16, v110
  v_and_b32 v6, 0xffff0000, v110
  v_fmac_f32 v174, v5, v130
  v_fmac_f32 v175, v6, v130
  v_fmac_f32 v184, v5, v131
  v_fmac_f32 v185, v6, v131
  v_lshlrev_b32 v5, 16, v111
  v_and_b32 v6, 0xffff0000, v111
  v_fmac_f32 v176, v5, v130
  v_fmac_f32 v177, v6, v130
  v_fmac_f32 v186, v5, v131
  v_fmac_f32 v187, v6, v131
  v_lshlrev_b32 v5, 16, v120
  v_and_b32 v6, 0xffff0000, v120
  v_fmac_f32 v178, v5, v130
  v_fmac_f32 v179, v6, v130
  v_fmac_f32 v188, v5, v131
  v_fmac_f32 v189, v6, v131
  v_lshlrev_b32 v5, 16, v112
  v_and_b32 v6, 0xffff0000, v112
  v_fmac_f32 v170, v5, v132
  v_fmac_f32 v171, v6, v132
  v_fmac_f32 v180, v5, v133
  v_fmac_f32 v181, v6, v133
  v_lshlrev_b32 v5, 16, v113
  v_and_b32 v6, 0xffff0000, v113
  v_fmac_f32 v172, v5, v132
  v_fmac_f32 v173, v6, v132
  v_fmac_f32 v182, v5, v133
  v_fmac_f32 v183, v6, v133
  v_lshlrev_b32 v5, 16, v114
  v_and_b32 v6, 0xffff0000, v114
  v_fmac_f32 v174, v5, v132
  v_fmac_f32 v175, v6, v132
  v_fmac_f32 v184, v5, v133
  v_fmac_f32 v185, v6, v133
  v_lshlrev_b32 v5, 16, v115
  v_and_b32 v6, 0xffff0000, v115
  v_fmac_f32 v176, v5, v132
  v_fmac_f32 v177, v6, v132
  v_fmac_f32 v186, v5, v133
  v_fmac_f32 v187, v6, v133
  v_lshlrev_b32 v5, 16, v121
  v_and_b32 v6, 0xffff0000, v121
  v_fmac_f32 v178, v5, v132
  v_fmac_f32 v179, v6, v132
  v_fmac_f32 v188, v5, v133
  v_fmac_f32 v189, v6, v133
  ds_read_b128 v[92:95], v26 offset:34816
  ds_read_b32 v116, v27 offset:35840
  ds_read_b128 v[96:99], v26 offset:36096
  ds_read_b32 v117, v27 offset:37120
  ds_read_b128 v[100:103], v26 offset:37376
  ds_read_b32 v118, v27 offset:38400
  ds_read_b128 v[104:107], v26 offset:38656
  ds_read_b32 v119, v27 offset:39680
  ds_read_b128 v[108:111], v26 offset:39936
  ds_read_b32 v120, v27 offset:40960
  ds_read_b128 v[112:115], v26 offset:41216
  ds_read_b32 v121, v27 offset:42240
  s_waitcnt lgkmcnt(0)
  v_lshlrev_b32 v5, 16, v92
  v_and_b32 v6, 0xffff0000, v92
  v_fmac_f32 v170, v5, v134
  v_fmac_f32 v171, v6, v134
  v_fmac_f32 v180, v5, v135
  v_fmac_f32 v181, v6, v135
  v_lshlrev_b32 v5, 16, v93
  v_and_b32 v6, 0xffff0000, v93
  v_fmac_f32 v172, v5, v134
  v_fmac_f32 v173, v6, v134
  v_fmac_f32 v182, v5, v135
  v_fmac_f32 v183, v6, v135
  v_lshlrev_b32 v5, 16, v94
  v_and_b32 v6, 0xffff0000, v94
  v_fmac_f32 v174, v5, v134
  v_fmac_f32 v175, v6, v134
  v_fmac_f32 v184, v5, v135
  v_fmac_f32 v185, v6, v135
  v_lshlrev_b32 v5, 16, v95
  v_and_b32 v6, 0xffff0000, v95
  v_fmac_f32 v176, v5, v134
  v_fmac_f32 v177, v6, v134
  v_fmac_f32 v186, v5, v135
  v_fmac_f32 v187, v6, v135
  v_lshlrev_b32 v5, 16, v116
  v_and_b32 v6, 0xffff0000, v116
  v_fmac_f32 v178, v5, v134
  v_fmac_f32 v179, v6, v134
  v_fmac_f32 v188, v5, v135
  v_fmac_f32 v189, v6, v135
  v_lshlrev_b32 v5, 16, v96
  v_and_b32 v6, 0xffff0000, v96
  v_fmac_f32 v170, v5, v136
  v_fmac_f32 v171, v6, v136
  v_fmac_f32 v180, v5, v137
  v_fmac_f32 v181, v6, v137
  v_lshlrev_b32 v5, 16, v97
  v_and_b32 v6, 0xffff0000, v97
  v_fmac_f32 v172, v5, v136
  v_fmac_f32 v173, v6, v136
  v_fmac_f32 v182, v5, v137
  v_fmac_f32 v183, v6, v137
  v_lshlrev_b32 v5, 16, v98
  v_and_b32 v6, 0xffff0000, v98
  v_fmac_f32 v174, v5, v136
  v_fmac_f32 v175, v6, v136
  v_fmac_f32 v184, v5, v137
  v_fmac_f32 v185, v6, v137
  v_lshlrev_b32 v5, 16, v99
  v_and_b32 v6, 0xffff0000, v99
  v_fmac_f32 v176, v5, v136
  v_fmac_f32 v177, v6, v136
  v_fmac_f32 v186, v5, v137
  v_fmac_f32 v187, v6, v137
  v_lshlrev_b32 v5, 16, v117
  v_and_b32 v6, 0xffff0000, v117
  v_fmac_f32 v178, v5, v136
  v_fmac_f32 v179, v6, v136
  v_fmac_f32 v188, v5, v137
  v_fmac_f32 v189, v6, v137
  v_lshlrev_b32 v5, 16, v100
  v_and_b32 v6, 0xffff0000, v100
  v_fmac_f32 v170, v5, v138
  v_fmac_f32 v171, v6, v138
  v_fmac_f32 v180, v5, v139
  v_fmac_f32 v181, v6, v139
  v_lshlrev_b32 v5, 16, v101
  v_and_b32 v6, 0xffff0000, v101
  v_fmac_f32 v172, v5, v138
  v_fmac_f32 v173, v6, v138
  v_fmac_f32 v182, v5, v139
  v_fmac_f32 v183, v6, v139
  v_lshlrev_b32 v5, 16, v102
  v_and_b32 v6, 0xffff0000, v102
  v_fmac_f32 v174, v5, v138
  v_fmac_f32 v175, v6, v138
  v_fmac_f32 v184, v5, v139
  v_fmac_f32 v185, v6, v139
  v_lshlrev_b32 v5, 16, v103
  v_and_b32 v6, 0xffff0000, v103
  v_fmac_f32 v176, v5, v138
  v_fmac_f32 v177, v6, v138
  v_fmac_f32 v186, v5, v139
  v_fmac_f32 v187, v6, v139
  v_lshlrev_b32 v5, 16, v118
  v_and_b32 v6, 0xffff0000, v118
  v_fmac_f32 v178, v5, v138
  v_fmac_f32 v179, v6, v138
  v_fmac_f32 v188, v5, v139
  v_fmac_f32 v189, v6, v139
  v_lshlrev_b32 v5, 16, v104
  v_and_b32 v6, 0xffff0000, v104
  v_fmac_f32 v170, v5, v140
  v_fmac_f32 v171, v6, v140
  v_fmac_f32 v180, v5, v141
  v_fmac_f32 v181, v6, v141
  v_lshlrev_b32 v5, 16, v105
  v_and_b32 v6, 0xffff0000, v105
  v_fmac_f32 v172, v5, v140
  v_fmac_f32 v173, v6, v140
  v_fmac_f32 v182, v5, v141
  v_fmac_f32 v183, v6, v141
  v_lshlrev_b32 v5, 16, v106
  v_and_b32 v6, 0xffff0000, v106
  v_fmac_f32 v174, v5, v140
  v_fmac_f32 v175, v6, v140
  v_fmac_f32 v184, v5, v141
  v_fmac_f32 v185, v6, v141
  v_lshlrev_b32 v5, 16, v107
  v_and_b32 v6, 0xffff0000, v107
  v_fmac_f32 v176, v5, v140
  v_fmac_f32 v177, v6, v140
  v_fmac_f32 v186, v5, v141
  v_fmac_f32 v187, v6, v141
  v_lshlrev_b32 v5, 16, v119
  v_and_b32 v6, 0xffff0000, v119
  v_fmac_f32 v178, v5, v140
  v_fmac_f32 v179, v6, v140
  v_fmac_f32 v188, v5, v141
  v_fmac_f32 v189, v6, v141
  v_lshlrev_b32 v5, 16, v108
  v_and_b32 v6, 0xffff0000, v108
  v_fmac_f32 v170, v5, v142
  v_fmac_f32 v171, v6, v142
  v_fmac_f32 v180, v5, v143
  v_fmac_f32 v181, v6, v143
  v_lshlrev_b32 v5, 16, v109
  v_and_b32 v6, 0xffff0000, v109
  v_fmac_f32 v172, v5, v142
  v_fmac_f32 v173, v6, v142
  v_fmac_f32 v182, v5, v143
  v_fmac_f32 v183, v6, v143
  v_lshlrev_b32 v5, 16, v110
  v_and_b32 v6, 0xffff0000, v110
  v_fmac_f32 v174, v5, v142
  v_fmac_f32 v175, v6, v142
  v_fmac_f32 v184, v5, v143
  v_fmac_f32 v185, v6, v143
  v_lshlrev_b32 v5, 16, v111
  v_and_b32 v6, 0xffff0000, v111
  v_fmac_f32 v176, v5, v142
  v_fmac_f32 v177, v6, v142
  v_fmac_f32 v186, v5, v143
  v_fmac_f32 v187, v6, v143
  v_lshlrev_b32 v5, 16, v120
  v_and_b32 v6, 0xffff0000, v120
  v_fmac_f32 v178, v5, v142
  v_fmac_f32 v179, v6, v142
  v_fmac_f32 v188, v5, v143
  v_fmac_f32 v189, v6, v143
  v_lshlrev_b32 v5, 16, v112
  v_and_b32 v6, 0xffff0000, v112
  v_fmac_f32 v170, v5, v144
  v_fmac_f32 v171, v6, v144
  v_fmac_f32 v180, v5, v145
  v_fmac_f32 v181, v6, v145
  v_lshlrev_b32 v5, 16, v113
  v_and_b32 v6, 0xffff0000, v113
  v_fmac_f32 v172, v5, v144
  v_fmac_f32 v173, v6, v144
  v_fmac_f32 v182, v5, v145
  v_fmac_f32 v183, v6, v145
  v_lshlrev_b32 v5, 16, v114
  v_and_b32 v6, 0xffff0000, v114
  v_fmac_f32 v174, v5, v144
  v_fmac_f32 v175, v6, v144
  v_fmac_f32 v184, v5, v145
  v_fmac_f32 v185, v6, v145
  v_lshlrev_b32 v5, 16, v115
  v_and_b32 v6, 0xffff0000, v115
  v_fmac_f32 v176, v5, v144
  v_fmac_f32 v177, v6, v144
  v_fmac_f32 v186, v5, v145
  v_fmac_f32 v187, v6, v145
  v_lshlrev_b32 v5, 16, v121
  v_and_b32 v6, 0xffff0000, v121
  v_fmac_f32 v178, v5, v144
  v_fmac_f32 v179, v6, v144
  v_fmac_f32 v188, v5, v145
  v_fmac_f32 v189, v6, v145
  s_waitcnt vmcnt(0)
  v_lshlrev_b32 v5, 16, v32
  v_and_b32 v6, 0xffff0000, v32
  v_fmac_f32 v170, v5, v146
  v_fmac_f32 v171, v6, v146
  v_fmac_f32 v180, v5, v147
  v_fmac_f32 v181, v6, v147
  v_lshlrev_b32 v5, 16, v33
  v_and_b32 v6, 0xffff0000, v33
  v_fmac_f32 v172, v5, v146
  v_fmac_f32 v173, v6, v146
  v_fmac_f32 v182, v5, v147
  v_fmac_f32 v183, v6, v147
  v_lshlrev_b32 v5, 16, v34
  v_and_b32 v6, 0xffff0000, v34
  v_fmac_f32 v174, v5, v146
  v_fmac_f32 v175, v6, v146
  v_fmac_f32 v184, v5, v147
  v_fmac_f32 v185, v6, v147
  v_lshlrev_b32 v5, 16, v35
  v_and_b32 v6, 0xffff0000, v35
  v_fmac_f32 v176, v5, v146
  v_fmac_f32 v177, v6, v146
  v_fmac_f32 v186, v5, v147
  v_fmac_f32 v187, v6, v147
  v_lshlrev_b32 v5, 16, v80
  v_and_b32 v6, 0xffff0000, v80
  v_fmac_f32 v178, v5, v146
  v_fmac_f32 v179, v6, v146
  v_fmac_f32 v188, v5, v147
  v_fmac_f32 v189, v6, v147
  v_lshlrev_b32 v5, 16, v36
  v_and_b32 v6, 0xffff0000, v36
  v_fmac_f32 v170, v5, v148
  v_fmac_f32 v171, v6, v148
  v_fmac_f32 v180, v5, v149
  v_fmac_f32 v181, v6, v149
  v_lshlrev_b32 v5, 16, v37
  v_and_b32 v6, 0xffff0000, v37
  v_fmac_f32 v172, v5, v148
  v_fmac_f32 v173, v6, v148
  v_fmac_f32 v182, v5, v149
  v_fmac_f32 v183, v6, v149
  v_lshlrev_b32 v5, 16, v38
  v_and_b32 v6, 0xffff0000, v38
  v_fmac_f32 v174, v5, v148
  v_fmac_f32 v175, v6, v148
  v_fmac_f32 v184, v5, v149
  v_fmac_f32 v185, v6, v149
  v_lshlrev_b32 v5, 16, v39
  v_and_b32 v6, 0xffff0000, v39
  v_fmac_f32 v176, v5, v148
  v_fmac_f32 v177, v6, v148
  v_fmac_f32 v186, v5, v149
  v_fmac_f32 v187, v6, v149
  v_lshlrev_b32 v5, 16, v81
  v_and_b32 v6, 0xffff0000, v81
  v_fmac_f32 v178, v5, v148
  v_fmac_f32 v179, v6, v148
  v_fmac_f32 v188, v5, v149
  v_fmac_f32 v189, v6, v149
  v_lshlrev_b32 v5, 16, v40
  v_and_b32 v6, 0xffff0000, v40
  v_fmac_f32 v170, v5, v150
  v_fmac_f32 v171, v6, v150
  v_fmac_f32 v180, v5, v151
  v_fmac_f32 v181, v6, v151
  v_lshlrev_b32 v5, 16, v41
  v_and_b32 v6, 0xffff0000, v41
  v_fmac_f32 v172, v5, v150
  v_fmac_f32 v173, v6, v150
  v_fmac_f32 v182, v5, v151
  v_fmac_f32 v183, v6, v151
  v_lshlrev_b32 v5, 16, v42
  v_and_b32 v6, 0xffff0000, v42
  v_fmac_f32 v174, v5, v150
  v_fmac_f32 v175, v6, v150
  v_fmac_f32 v184, v5, v151
  v_fmac_f32 v185, v6, v151
  v_lshlrev_b32 v5, 16, v43
  v_and_b32 v6, 0xffff0000, v43
  v_fmac_f32 v176, v5, v150
  v_fmac_f32 v177, v6, v150
  v_fmac_f32 v186, v5, v151
  v_fmac_f32 v187, v6, v151
  v_lshlrev_b32 v5, 16, v82
  v_and_b32 v6, 0xffff0000, v82
  v_fmac_f32 v178, v5, v150
  v_fmac_f32 v179, v6, v150
  v_fmac_f32 v188, v5, v151
  v_fmac_f32 v189, v6, v151
  v_lshlrev_b32 v5, 16, v44
  v_and_b32 v6, 0xffff0000, v44
  v_fmac_f32 v170, v5, v152
  v_fmac_f32 v171, v6, v152
  v_fmac_f32 v180, v5, v153
  v_fmac_f32 v181, v6, v153
  v_lshlrev_b32 v5, 16, v45
  v_and_b32 v6, 0xffff0000, v45
  v_fmac_f32 v172, v5, v152
  v_fmac_f32 v173, v6, v152
  v_fmac_f32 v182, v5, v153
  v_fmac_f32 v183, v6, v153
  v_lshlrev_b32 v5, 16, v46
  v_and_b32 v6, 0xffff0000, v46
  v_fmac_f32 v174, v5, v152
  v_fmac_f32 v175, v6, v152
  v_fmac_f32 v184, v5, v153
  v_fmac_f32 v185, v6, v153
  v_lshlrev_b32 v5, 16, v47
  v_and_b32 v6, 0xffff0000, v47
  v_fmac_f32 v176, v5, v152
  v_fmac_f32 v177, v6, v152
  v_fmac_f32 v186, v5, v153
  v_fmac_f32 v187, v6, v153
  v_lshlrev_b32 v5, 16, v83
  v_and_b32 v6, 0xffff0000, v83
  v_fmac_f32 v178, v5, v152
  v_fmac_f32 v179, v6, v152
  v_fmac_f32 v188, v5, v153
  v_fmac_f32 v189, v6, v153
  v_lshlrev_b32 v5, 16, v48
  v_and_b32 v6, 0xffff0000, v48
  v_fmac_f32 v170, v5, v154
  v_fmac_f32 v171, v6, v154
  v_fmac_f32 v180, v5, v155
  v_fmac_f32 v181, v6, v155
  v_lshlrev_b32 v5, 16, v49
  v_and_b32 v6, 0xffff0000, v49
  v_fmac_f32 v172, v5, v154
  v_fmac_f32 v173, v6, v154
  v_fmac_f32 v182, v5, v155
  v_fmac_f32 v183, v6, v155
  v_lshlrev_b32 v5, 16, v50
  v_and_b32 v6, 0xffff0000, v50
  v_fmac_f32 v174, v5, v154
  v_fmac_f32 v175, v6, v154
  v_fmac_f32 v184, v5, v155
  v_fmac_f32 v185, v6, v155
  v_lshlrev_b32 v5, 16, v51
  v_and_b32 v6, 0xffff0000, v51
  v_fmac_f32 v176, v5, v154
  v_fmac_f32 v177, v6, v154
  v_fmac_f32 v186, v5, v155
  v_fmac_f32 v187, v6, v155
  v_lshlrev_b32 v5, 16, v84
  v_and_b32 v6, 0xffff0000, v84
  v_fmac_f32 v178, v5, v154
  v_fmac_f32 v179, v6, v154
  v_fmac_f32 v188, v5, v155
  v_fmac_f32 v189, v6, v155
  v_lshlrev_b32 v5, 16, v52
  v_and_b32 v6, 0xffff0000, v52
  v_fmac_f32 v170, v5, v156
  v_fmac_f32 v171, v6, v156
  v_fmac_f32 v180, v5, v157
  v_fmac_f32 v181, v6, v157
  v_lshlrev_b32 v5, 16, v53
  v_and_b32 v6, 0xffff0000, v53
  v_fmac_f32 v172, v5, v156
  v_fmac_f32 v173, v6, v156
  v_fmac_f32 v182, v5, v157
  v_fmac_f32 v183, v6, v157
  v_lshlrev_b32 v5, 16, v54
  v_and_b32 v6, 0xffff0000, v54
  v_fmac_f32 v174, v5, v156
  v_fmac_f32 v175, v6, v156
  v_fmac_f32 v184, v5, v157
  v_fmac_f32 v185, v6, v157
  v_lshlrev_b32 v5, 16, v55
  v_and_b32 v6, 0xffff0000, v55
  v_fmac_f32 v176, v5, v156
  v_fmac_f32 v177, v6, v156
  v_fmac_f32 v186, v5, v157
  v_fmac_f32 v187, v6, v157
  v_lshlrev_b32 v5, 16, v85
  v_and_b32 v6, 0xffff0000, v85
  v_fmac_f32 v178, v5, v156
  v_fmac_f32 v179, v6, v156
  v_fmac_f32 v188, v5, v157
  v_fmac_f32 v189, v6, v157
  v_lshlrev_b32 v5, 16, v56
  v_and_b32 v6, 0xffff0000, v56
  v_fmac_f32 v170, v5, v158
  v_fmac_f32 v171, v6, v158
  v_fmac_f32 v180, v5, v159
  v_fmac_f32 v181, v6, v159
  v_lshlrev_b32 v5, 16, v57
  v_and_b32 v6, 0xffff0000, v57
  v_fmac_f32 v172, v5, v158
  v_fmac_f32 v173, v6, v158
  v_fmac_f32 v182, v5, v159
  v_fmac_f32 v183, v6, v159
  v_lshlrev_b32 v5, 16, v58
  v_and_b32 v6, 0xffff0000, v58
  v_fmac_f32 v174, v5, v158
  v_fmac_f32 v175, v6, v158
  v_fmac_f32 v184, v5, v159
  v_fmac_f32 v185, v6, v159
  v_lshlrev_b32 v5, 16, v59
  v_and_b32 v6, 0xffff0000, v59
  v_fmac_f32 v176, v5, v158
  v_fmac_f32 v177, v6, v158
  v_fmac_f32 v186, v5, v159
  v_fmac_f32 v187, v6, v159
  v_lshlrev_b32 v5, 16, v86
  v_and_b32 v6, 0xffff0000, v86
  v_fmac_f32 v178, v5, v158
  v_fmac_f32 v179, v6, v158
  v_fmac_f32 v188, v5, v159
  v_fmac_f32 v189, v6, v159
  v_lshlrev_b32 v5, 16, v60
  v_and_b32 v6, 0xffff0000, v60
  v_fmac_f32 v170, v5, v160
  v_fmac_f32 v171, v6, v160
  v_fmac_f32 v180, v5, v161
  v_fmac_f32 v181, v6, v161
  v_lshlrev_b32 v5, 16, v61
  v_and_b32 v6, 0xffff0000, v61
  v_fmac_f32 v172, v5, v160
  v_fmac_f32 v173, v6, v160
  v_fmac_f32 v182, v5, v161
  v_fmac_f32 v183, v6, v161
  v_lshlrev_b32 v5, 16, v62
  v_and_b32 v6, 0xffff0000, v62
  v_fmac_f32 v174, v5, v160
  v_fmac_f32 v175, v6, v160
  v_fmac_f32 v184, v5, v161
  v_fmac_f32 v185, v6, v161
  v_lshlrev_b32 v5, 16, v63
  v_and_b32 v6, 0xffff0000, v63
  v_fmac_f32 v176, v5, v160
  v_fmac_f32 v177, v6, v160
  v_fmac_f32 v186, v5, v161
  v_fmac_f32 v187, v6, v161
  v_lshlrev_b32 v5, 16, v87
  v_and_b32 v6, 0xffff0000, v87
  v_fmac_f32 v178, v5, v160
  v_fmac_f32 v179, v6, v160
  v_fmac_f32 v188, v5, v161
  v_fmac_f32 v189, v6, v161
  v_lshlrev_b32 v5, 16, v64
  v_and_b32 v6, 0xffff0000, v64
  v_fmac_f32 v170, v5, v162
  v_fmac_f32 v171, v6, v162
  v_fmac_f32 v180, v5, v163
  v_fmac_f32 v181, v6, v163
  v_lshlrev_b32 v5, 16, v65
  v_and_b32 v6, 0xffff0000, v65
  v_fmac_f32 v172, v5, v162
  v_fmac_f32 v173, v6, v162
  v_fmac_f32 v182, v5, v163
  v_fmac_f32 v183, v6, v163
  v_lshlrev_b32 v5, 16, v66
  v_and_b32 v6, 0xffff0000, v66
  v_fmac_f32 v174, v5, v162
  v_fmac_f32 v175, v6, v162
  v_fmac_f32 v184, v5, v163
  v_fmac_f32 v185, v6, v163
  v_lshlrev_b32 v5, 16, v67
  v_and_b32 v6, 0xffff0000, v67
  v_fmac_f32 v176, v5, v162
  v_fmac_f32 v177, v6, v162
  v_fmac_f32 v186, v5, v163
  v_fmac_f32 v187, v6, v163
  v_lshlrev_b32 v5, 16, v88
  v_and_b32 v6, 0xffff0000, v88
  v_fmac_f32 v178, v5, v162
  v_fmac_f32 v179, v6, v162
  v_fmac_f32 v188, v5, v163
  v_fmac_f32 v189, v6, v163
  v_lshlrev_b32 v5, 16, v68
  v_and_b32 v6, 0xffff0000, v68
  v_fmac_f32 v170, v5, v164
  v_fmac_f32 v171, v6, v164
  v_fmac_f32 v180, v5, v165
  v_fmac_f32 v181, v6, v165
  v_lshlrev_b32 v5, 16, v69
  v_and_b32 v6, 0xffff0000, v69
  v_fmac_f32 v172, v5, v164
  v_fmac_f32 v173, v6, v164
  v_fmac_f32 v182, v5, v165
  v_fmac_f32 v183, v6, v165
  v_lshlrev_b32 v5, 16, v70
  v_and_b32 v6, 0xffff0000, v70
  v_fmac_f32 v174, v5, v164
  v_fmac_f32 v175, v6, v164
  v_fmac_f32 v184, v5, v165
  v_fmac_f32 v185, v6, v165
  v_lshlrev_b32 v5, 16, v71
  v_and_b32 v6, 0xffff0000, v71
  v_fmac_f32 v176, v5, v164
  v_fmac_f32 v177, v6, v164
  v_fmac_f32 v186, v5, v165
  v_fmac_f32 v187, v6, v165
  v_lshlrev_b32 v5, 16, v89
  v_and_b32 v6, 0xffff0000, v89
  v_fmac_f32 v178, v5, v164
  v_fmac_f32 v179, v6, v164
  v_fmac_f32 v188, v5, v165
  v_fmac_f32 v189, v6, v165
  v_lshlrev_b32 v5, 16, v72
  v_and_b32 v6, 0xffff0000, v72
  v_fmac_f32 v170, v5, v166
  v_fmac_f32 v171, v6, v166
  v_fmac_f32 v180, v5, v167
  v_fmac_f32 v181, v6, v167
  v_lshlrev_b32 v5, 16, v73
  v_and_b32 v6, 0xffff0000, v73
  v_fmac_f32 v172, v5, v166
  v_fmac_f32 v173, v6, v166
  v_fmac_f32 v182, v5, v167
  v_fmac_f32 v183, v6, v167
  v_lshlrev_b32 v5, 16, v74
  v_and_b32 v6, 0xffff0000, v74
  v_fmac_f32 v174, v5, v166
  v_fmac_f32 v175, v6, v166
  v_fmac_f32 v184, v5, v167
  v_fmac_f32 v185, v6, v167
  v_lshlrev_b32 v5, 16, v75
  v_and_b32 v6, 0xffff0000, v75
  v_fmac_f32 v176, v5, v166
  v_fmac_f32 v177, v6, v166
  v_fmac_f32 v186, v5, v167
  v_fmac_f32 v187, v6, v167
  v_lshlrev_b32 v5, 16, v90
  v_and_b32 v6, 0xffff0000, v90
  v_fmac_f32 v178, v5, v166
  v_fmac_f32 v179, v6, v166
  v_fmac_f32 v188, v5, v167
  v_fmac_f32 v189, v6, v167
  v_lshlrev_b32 v5, 16, v76
  v_and_b32 v6, 0xffff0000, v76
  v_fmac_f32 v170, v5, v168
  v_fmac_f32 v171, v6, v168
  v_fmac_f32 v180, v5, v169
  v_fmac_f32 v181, v6, v169
  v_lshlrev_b32 v5, 16, v77
  v_and_b32 v6, 0xffff0000, v77
  v_fmac_f32 v172, v5, v168
  v_fmac_f32 v173, v6, v168
  v_fmac_f32 v182, v5, v169
  v_fmac_f32 v183, v6, v169
  v_lshlrev_b32 v5, 16, v78
  v_and_b32 v6, 0xffff0000, v78
  v_fmac_f32 v174, v5, v168
  v_fmac_f32 v175, v6, v168
  v_fmac_f32 v184, v5, v169
  v_fmac_f32 v185, v6, v169
  v_lshlrev_b32 v5, 16, v79
  v_and_b32 v6, 0xffff0000, v79
  v_fmac_f32 v176, v5, v168
  v_fmac_f32 v177, v6, v168
  v_fmac_f32 v186, v5, v169
  v_fmac_f32 v187, v6, v169
  v_lshlrev_b32 v5, 16, v91
  v_and_b32 v6, 0xffff0000, v91
  v_fmac_f32 v178, v5, v168
  v_fmac_f32 v179, v6, v168
  v_fmac_f32 v188, v5, v169
  v_fmac_f32 v189, v6, v169
  s_barrier
  s_mul_i32 s64, s59, 5120
  v_lshlrev_b32 v5, 5, v1
  v_add_u32 v5, s64, v5
  v_lshlrev_b32 v6, 3, v1
  v_add_u32 v6, s64, v6
  ds_write_b128 v5, v[170:173] offset:27136
  ds_write_b128 v5, v[174:177] offset:27152
  ds_write_b64 v6, v[178:179] offset:29184
  ds_write_b128 v5, v[180:183] offset:29696
  ds_write_b128 v5, v[184:187] offset:29712
  ds_write_b64 v6, v[188:189] offset:31744
  s_waitcnt lgkmcnt(0)
  s_barrier
  s_mul_i32 s64, s57, 5120
  s_add_u32 s64, s64, 0
  v_lshlrev_b32 v5, 2, v0
  v_add_u32 v6, 27136, v5
  ds_read_b32 v8, v6 offset:0
  ds_read_b32 v9, v6 offset:5120
  ds_read_b32 v10, v6 offset:10240
  ds_read_b32 v11, v6 offset:15360
  ds_read_b32 v12, v6 offset:20480
  ds_read_b32 v13, v6 offset:25600
  ds_read_b32 v14, v6 offset:30720
  ds_read_b32 v15, v6 offset:35840
  ds_read_b32 v16, v6 offset:2048
  ds_read_b32 v17, v6 offset:7168
  ds_read_b32 v18, v6 offset:12288
  ds_read_b32 v19, v6 offset:17408
  ds_read_b32 v20, v6 offset:22528
  ds_read_b32 v21, v6 offset:27648
  ds_read_b32 v22, v6 offset:32768
  ds_read_b32 v23, v6 offset:37888
  ds_read_b32 v24, v6 offset:4096
  ds_read_b32 v25, v6 offset:9216
  ds_read_b32 v26, v6 offset:14336
  ds_read_b32 v27, v6 offset:19456
  ds_read_b32 v28, v6 offset:24576
  ds_read_b32 v29, v6 offset:29696
  ds_read_b32 v30, v6 offset:34816
  ds_read_b32 v31, v6 offset:39936
  s_waitcnt lgkmcnt(0)
  v_add_f32 v8, v8, v12
  v_add_f32 v9, v9, v13
  v_add_f32 v10, v10, v14
  v_add_f32 v11, v11, v15
  v_add_f32 v8, v8, v10
  v_add_f32 v9, v9, v11
  v_add_f32 v8, v8, v9
  v_add_f32 v16, v16, v20
  v_add_f32 v17, v17, v21
  v_add_f32 v18, v18, v22
  v_add_f32 v19, v19, v23
  v_add_f32 v16, v16, v18
  v_add_f32 v17, v17, v19
  v_add_f32 v16, v16, v17
  v_add_f32 v24, v24, v28
  v_add_f32 v25, v25, v29
  v_add_f32 v26, v26, v30
  v_add_f32 v27, v27, v31
  v_add_f32 v24, v24, v26
  v_add_f32 v25, v25, v27
  v_add_f32 v24, v24, v25
  buffer_atomic_add_f32 v8, v5, s[48:51], s64 offen
  buffer_atomic_add_f32 v16, v5, s[48:51], s64 offen offset:2048
  v_cmp_gt_u32 vcc, 256, v0
  s_and_saveexec_b64 s[66:67], vcc
  s_cbranch_execz L_endA2
  s_add_u32 s64, s64, 4096
  s_nop 3
  buffer_atomic_add_f32 v24, v5, s[48:51], s64 offen
L_endA2:
  s_mov_b64 exec, -1
  s_mov_b64 exec, -1
  s_load_dwordx8 s[12:19], s[0:1], 48
  s_load_dwordx2 s[20:21], s[0:1], 80
  s_waitcnt vmcnt(0) lgkmcnt(0)
  s_barrier
  s_cmp_eq_u32 s59, 0
  s_cbranch_scc0 L_f_arr
  v_mov_b32 v5, 1
  v_mov_b32 v6, 0
  s_mov_b64 exec, 1
  buffer_atomic_add v5, v6, s[44:47], 0 offen offset:200 sc0 sc1
  s_waitcnt vmcnt(0)
  ds_write_b32 v6, v5 offset:25104
  s_mov_b64 exec, -1
L_f_arr:
  s_waitcnt lgkmcnt(0)
  s_barrier
  v_mov_b32 v6, 0
  ds_read_b32 v5, v6 offset:25104
  s_waitcnt lgkmcnt(0)
  v_readfirstlane_b32 s2, v5
  s_nop 3
  s_cmp_lt_u32 s2, 48
  s_cbranch_scc0 L_f_end
  s_mov_b32 s28, s12
  s_mov_b32 s29, s13
  s_mov_b32 s30, 1280
  s_mov_b32 s31, 0x00020000
  s_mov_b32 s32, s14
  s_mov_b32 s33, s15
  s_mov_b32 s34, 1966080
  s_mov_b32 s35, 0x00020000
  s_mov_b32 s36, s16
  s_mov_b32 s37, s17
  s_mov_b32 s38, 1966080
  s_mov_b32 s39, 0x00020000
  s_mov_b32 s68, s18
  s_mov_b32 s69, s19
  s_mov_b32 s70, 1966080
  s_mov_b32 s71, 0x00020000
  s_mov_b32 s72, s20
  s_mov_b32 s73, s21
  s_mov_b32 s74, 5120
  s_mov_b32 s75, 0x00020000
  s_and_b32 s60, s59, 1
  s_lshr_b32 s61, s59, 1
  s_cmp_eq_u32 s60, 0
  s_cselect_b32 s52, s32, s36
  s_cselect_b32 s53, s33, s37
  s_mov_b32 s54, s34
  s_mov_b32 s55, s35
  v_lshrrev_b32 v5, 2, v1
  v_mul_u32_u24 v5, 3072, v5
  v_and_b32 v6, 3, v1
  v_lshlrev_b32 v6, 4, v6
  v_add_u32 v9, v5, v6
  v_lshlrev_b32 v28, 4, v1
  v_lshlrev_b32 v29, 2, v1
  s_mul_i32 s65, s59, 1280
  buffer_load_dwordx4 v[32:35], v28, s[24:27], s65 offen
  buffer_load_dword v36, v29, s[24:27], s65 offen offset:1024
  buffer_load_dwordx4 v[38:41], v28, s[28:31], 0 offen
  buffer_load_dword v37, v29, s[28:31], 0 offen offset:1024
  s_mul_i32 s64, s61, 49152
  s_lshl_b32 s65, s2, 6
  s_add_u32 s64, s64, s65
  buffer_load_dwordx4 v[190:193], v9, s[52:55], s64 offen
  s_add_u32 s64, s64, 196608
  buffer_load_dwordx4 v[194:197], v9, s[52:55], s64 offen
  s_add_u32 s64, s64, 196608
  buffer_load_dwordx4 v[198:201], v9, s[52:55], s64 offen
  s_add_u32 s64, s64, 196608
  buffer_load_dwordx4 v[202:205], v9, s[52:55], s64 offen
  s_add_u32 s64, s64, 196608
  buffer_load_dwordx4 v[206:209], v9, s[52:55], s64 offen
  s_add_u32 s64, s64, 196608
  buffer_load_dwordx4 v[210:213], v9, s[52:55], s64 offen
  s_add_u32 s64, s64, 196608
  buffer_load_dwordx4 v[214:217], v9, s[52:55], s64 offen
  s_add_u32 s64, s64, 196608
  buffer_load_dwordx4 v[218:221], v9, s[52:55], s64 offen
  s_add_u32 s64, s64, 196608
  buffer_load_dwordx4 v[222:225], v9, s[52:55], s64 offen
  s_add_u32 s64, s64, 196608
  buffer_load_dwordx4 v[226:229], v9, s[52:55], s64 offen
  s_add_u32 s64, s64, 196608
  s_lshl_b32 s64, s2, 5
  s_lshl_b32 s65, s59, 2
  s_add_u32 s64, s64, s65
  s_mul_i32 s64, s64, 1280
  buffer_load_dwordx4 v[230:233], v28, s[68:71], s64 offen
  buffer_load_dword v246, v29, s[68:71], s64 offen offset:1024
  s_add_u32 s64, s64, 1280
  buffer_load_dwordx4 v[234:237], v28, s[68:71], s64 offen
  buffer_load_dword v247, v29, s[68:71], s64 offen offset:1024
  s_add_u32 s64, s64, 1280
  buffer_load_dwordx4 v[238:241], v28, s[68:71], s64 offen
  buffer_load_dword v248, v29, s[68:71], s64 offen offset:1024
  s_add_u32 s64, s64, 1280
  buffer_load_dwordx4 v[242:245], v28, s[68:71], s64 offen
  buffer_load_dword v249, v29, s[68:71], s64 offen offset:1024
  s_add_u32 s64, s64, 1280
  s_cmp_eq_u32 s59, 0
  s_cbranch_scc0 L_f_w0done
  v_mov_b32 v6, 0
L_f_poll:
  buffer_load_dword v5, v6, s[44:47], 0 offen offset:200 sc0 sc1
  s_waitcnt vmcnt(0)
  v_readfirstlane_b32 s64, v5
  s_nop 3
  s_cmp_eq_u32 s64, 256
  s_cbranch_scc0 L_f_poll
L_f_w0done:
  s_barrier
  s_cmp_lt_u32 s59, 4
  s_cbranch_scc0 L_f_noln
  s_mul_i32 s64, s59, 2560
  s_add_u32 s64, s64, 0
  v_lshlrev_b32 v5, 5, v1
  v_lshlrev_b32 v6, 3, v1
  buffer_load_dwordx4 v[42:45], v5, s[48:51], s64 offen sc0 sc1
  buffer_load_dwordx4 v[46:49], v5, s[48:51], s64 offen offset:16 sc0 sc1
  buffer_load_dwordx2 v[50:51], v6, s[48:51], s64 offen offset:2048 sc0 sc1
  s_waitcnt vmcnt(0)
  v_cvt_pk_bf16_f32 v42, v42, v42
  v_lshlrev_b32 v42, 16, v42
  v_cvt_pk_bf16_f32 v43, v43, v43
  v_lshlrev_b32 v43, 16, v43
  v_cvt_pk_bf16_f32 v44, v44, v44
  v_lshlrev_b32 v44, 16, v44
  v_cvt_pk_bf16_f32 v45, v45, v45
  v_lshlrev_b32 v45, 16, v45
  v_cvt_pk_bf16_f32 v46, v46, v46
  v_lshlrev_b32 v46, 16, v46
  v_cvt_pk_bf16_f32 v47, v47, v47
  v_lshlrev_b32 v47, 16, v47
  v_cvt_pk_bf16_f32 v48, v48, v48
  v_lshlrev_b32 v48, 16, v48
  v_cvt_pk_bf16_f32 v49, v49, v49
  v_lshlrev_b32 v49, 16, v49
  v_cvt_pk_bf16_f32 v50, v50, v50
  v_lshlrev_b32 v50, 16, v50
  v_cvt_pk_bf16_f32 v51, v51, v51
  v_lshlrev_b32 v51, 16, v51
  v_lshlrev_b32 v12, 16, v32
  v_and_b32 v13, 0xffff0000, v32
  v_lshlrev_b32 v14, 16, v33
  v_and_b32 v15, 0xffff0000, v33
  v_lshlrev_b32 v16, 16, v34
  v_and_b32 v17, 0xffff0000, v34
  v_lshlrev_b32 v18, 16, v35
  v_and_b32 v19, 0xffff0000, v35
  v_lshlrev_b32 v20, 16, v36
  v_and_b32 v21, 0xffff0000, v36
  v_add_f32 v12, v12, v42
  v_cvt_pk_bf16_f32 v12, v12, v12
  v_lshlrev_b32 v12, 16, v12
  v_add_f32 v13, v13, v43
  v_cvt_pk_bf16_f32 v13, v13, v13
  v_lshlrev_b32 v13, 16, v13
  v_add_f32 v14, v14, v44
  v_cvt_pk_bf16_f32 v14, v14, v14
  v_lshlrev_b32 v14, 16, v14
  v_add_f32 v15, v15, v45
  v_cvt_pk_bf16_f32 v15, v15, v15
  v_lshlrev_b32 v15, 16, v15
  v_add_f32 v16, v16, v46
  v_cvt_pk_bf16_f32 v16, v16, v16
  v_lshlrev_b32 v16, 16, v16
  v_add_f32 v17, v17, v47
  v_cvt_pk_bf16_f32 v17, v17, v17
  v_lshlrev_b32 v17, 16, v17
  v_add_f32 v18, v18, v48
  v_cvt_pk_bf16_f32 v18, v18, v18
  v_lshlrev_b32 v18, 16, v18
  v_add_f32 v19, v19, v49
  v_cvt_pk_bf16_f32 v19, v19, v19
  v_lshlrev_b32 v19, 16, v19
  v_add_f32 v20, v20, v50
  v_cvt_pk_bf16_f32 v20, v20, v20
  v_lshlrev_b32 v20, 16, v20
  v_add_f32 v21, v21, v51
  v_cvt_pk_bf16_f32 v21, v21, v21
  v_lshlrev_b32 v21, 16, v21
  s_mul_i32 s64, s59, 2560
  v_lshlrev_b32 v5, 5, v1
  v_add_u32 v5, s64, v5
  v_lshlrev_b32 v6, 3, v1
  v_add_u32 v6, s64, v6
  ds_write_b128 v5, v[12:15] offset:10240
  ds_write_b128 v5, v[16:19] offset:10256
  ds_write_b64 v6, v[20:21] offset:12288
  s_nop 1
  v_add_f32 v22, v12, v13
  v_add_f32 v22, v22, v14
  v_add_f32 v22, v22, v15
  v_add_f32 v22, v22, v16
  v_add_f32 v22, v22, v17
  v_add_f32 v22, v22, v18
  v_add_f32 v22, v22, v19
  v_add_f32 v22, v22, v20
  v_add_f32 v22, v22, v21
  s_nop 1
  v_add_f32_dpp v22, v22, v22 quad_perm:[1,0,3,2] row_mask:0xf bank_mask:0xf
  s_nop 1
  v_add_f32_dpp v22, v22, v22 quad_perm:[2,3,0,1] row_mask:0xf bank_mask:0xf
  s_nop 1
  v_add_f32_dpp v22, v22, v22 row_half_mirror row_mask:0xf bank_mask:0xf
  s_nop 1
  v_add_f32_dpp v22, v22, v22 row_mirror row_mask:0xf bank_mask:0xf
  v_mov_b32 v23, v22
  s_nop 1
  v_permlane16_swap_b32 v22, v23
  s_nop 1
  v_add_f32 v22, v22, v23
  v_mov_b32 v23, v22
  s_nop 1
  v_permlane32_swap_b32 v22, v23
  s_nop 1
  v_add_f32 v22, v22, v23
  v_mul_f32 v24, 0x3acccccd, v22
  v_sub_f32 v23, v12, v24
  v_mul_f32 v22, v23, v23
  v_sub_f32 v23, v13, v24
  v_fmac_f32 v22, v23, v23
  v_sub_f32 v23, v14, v24
  v_fmac_f32 v22, v23, v23
  v_sub_f32 v23, v15, v24
  v_fmac_f32 v22, v23, v23
  v_sub_f32 v23, v16, v24
  v_fmac_f32 v22, v23, v23
  v_sub_f32 v23, v17, v24
  v_fmac_f32 v22, v23, v23
  v_sub_f32 v23, v18, v24
  v_fmac_f32 v22, v23, v23
  v_sub_f32 v23, v19, v24
  v_fmac_f32 v22, v23, v23
  v_sub_f32 v23, v20, v24
  v_fmac_f32 v22, v23, v23
  v_sub_f32 v23, v21, v24
  v_fmac_f32 v22, v23, v23
  s_nop 1
  v_add_f32_dpp v22, v22, v22 quad_perm:[1,0,3,2] row_mask:0xf bank_mask:0xf
  s_nop 1
  v_add_f32_dpp v22, v22, v22 quad_perm:[2,3,0,1] row_mask:0xf bank_mask:0xf
  s_nop 1
  v_add_f32_dpp v22, v22, v22 row_half_mirror row_mask:0xf bank_mask:0xf
  s_nop 1
  v_add_f32_dpp v22, v22, v22 row_mirror row_mask:0xf bank_mask:0xf
  v_mov_b32 v23, v22
  s_nop 1
  v_permlane16_swap_b32 v22, v23
  s_nop 1
  v_add_f32 v22, v22, v23
  v_mov_b32 v23, v22
  s_nop 1
  v_permlane32_swap_b32 v22, v23
  s_nop 1
  v_add_f32 v22, v22, v23
  v_mul_f32 v25, 0x3acccccd, v22
  v_cvt_pk_bf16_f32 v24, v24, v24
  v_lshlrev_b32 v24, 16, v24
  v_cvt_pk_bf16_f32 v25, v25, v25
  v_lshlrev_b32 v25, 16, v25
  v_add_f32 v25, 0x3727c5ac, v25
  v_cvt_pk_bf16_f32 v25, v25, v25
  v_lshlrev_b32 v25, 16, v25
  v_sqrt_f32 v25, v25
  s_nop 0
  v_cvt_pk_bf16_f32 v25, v25, v25
  v_lshlrev_b32 v25, 16, v25
  v_rcp_f32 v26, v25
  s_nop 0
  v_sub_f32 v12, v12, v24
  v_cvt_pk_bf16_f32 v12, v12, v12
  v_lshlrev_b32 v12, 16, v12
  v_mul_f32 v22, v12, v26
  v_fma_f32 v23, -v22, v25, v12
  v_fma_f32 v12, v23, v26, v22
  v_cvt_pk_bf16_f32 v12, v12, v12
  v_lshlrev_b32 v12, 16, v12
  v_sub_f32 v13, v13, v24
  v_cvt_pk_bf16_f32 v13, v13, v13
  v_lshlrev_b32 v13, 16, v13
  v_mul_f32 v22, v13, v26
  v_fma_f32 v23, -v22, v25, v13
  v_fma_f32 v13, v23, v26, v22
  v_cvt_pk_bf16_f32 v13, v13, v13
  v_lshlrev_b32 v13, 16, v13
  v_sub_f32 v14, v14, v24
  v_cvt_pk_bf16_f32 v14, v14, v14
  v_lshlrev_b32 v14, 16, v14
  v_mul_f32 v22, v14, v26
  v_fma_f32 v23, -v22, v25, v14
  v_fma_f32 v14, v23, v26, v22
  v_cvt_pk_bf16_f32 v14, v14, v14
  v_lshlrev_b32 v14, 16, v14
  v_sub_f32 v15, v15, v24
  v_cvt_pk_bf16_f32 v15, v15, v15
  v_lshlrev_b32 v15, 16, v15
  v_mul_f32 v22, v15, v26
  v_fma_f32 v23, -v22, v25, v15
  v_fma_f32 v15, v23, v26, v22
  v_cvt_pk_bf16_f32 v15, v15, v15
  v_lshlrev_b32 v15, 16, v15
  v_sub_f32 v16, v16, v24
  v_cvt_pk_bf16_f32 v16, v16, v16
  v_lshlrev_b32 v16, 16, v16
  v_mul_f32 v22, v16, v26
  v_fma_f32 v23, -v22, v25, v16
  v_fma_f32 v16, v23, v26, v22
  v_cvt_pk_bf16_f32 v16, v16, v16
  v_lshlrev_b32 v16, 16, v16
  v_sub_f32 v17, v17, v24
  v_cvt_pk_bf16_f32 v17, v17, v17
  v_lshlrev_b32 v17, 16, v17
  v_mul_f32 v22, v17, v26
  v_fma_f32 v23, -v22, v25, v17
  v_fma_f32 v17, v23, v26, v22
  v_cvt_pk_bf16_f32 v17, v17, v17
  v_lshlrev_b32 v17, 16, v17
  v_sub_f32 v18, v18, v24
  v_cvt_pk_bf16_f32 v18, v18, v18
  v_lshlrev_b32 v18, 16, v18
  v_mul_f32 v22, v18, v26
  v_fma_f32 v23, -v22, v25, v18
  v_fma_f32 v18, v23, v26, v22
  v_cvt_pk_bf16_f32 v18, v18, v18
  v_lshlrev_b32 v18, 16, v18
  v_sub_f32 v19, v19, v24
  v_cvt_pk_bf16_f32 v19, v19, v19
  v_lshlrev_b32 v19, 16, v19
  v_mul_f32 v22, v19, v26
  v_fma_f32 v23, -v22, v25, v19
  v_fma_f32 v19, v23, v26, v22
  v_cvt_pk_bf16_f32 v19, v19, v19
  v_lshlrev_b32 v19, 16, v19
  v_sub_f32 v20, v20, v24
  v_cvt_pk_bf16_f32 v20, v20, v20
  v_lshlrev_b32 v20, 16, v20
  v_mul_f32 v22, v20, v26
  v_fma_f32 v23, -v22, v25, v20
  v_fma_f32 v20, v23, v26, v22
  v_cvt_pk_bf16_f32 v20, v20, v20
  v_lshlrev_b32 v20, 16, v20
  v_sub_f32 v21, v21, v24
  v_cvt_pk_bf16_f32 v21, v21, v21
  v_lshlrev_b32 v21, 16, v21
  v_mul_f32 v22, v21, v26
  v_fma_f32 v23, -v22, v25, v21
  v_fma_f32 v21, v23, v26, v22
  v_cvt_pk_bf16_f32 v21, v21, v21
  v_lshlrev_b32 v21, 16, v21
  s_lshl_b32 s64, s59, 2
  v_lshlrev_b32 v5, 7, v1
  v_add_u32 v5, s64, v5
  v_lshlrev_b32 v6, 5, v1
  v_add_u32 v6, s64, v6
  ds_write_b32 v5, v12 offset:0
  ds_write_b32 v5, v13 offset:16
  ds_write_b32 v5, v14 offset:32
  ds_write_b32 v5, v15 offset:48
  ds_write_b32 v5, v16 offset:64
  ds_write_b32 v5, v17 offset:80
  ds_write_b32 v5, v18 offset:96
  ds_write_b32 v5, v19 offset:112
  ds_write_b32 v6, v20 offset:8192
  ds_write_b32 v6, v21 offset:8208
  v_lshlrev_b32 v42, 16, v38
  v_and_b32 v43, 0xffff0000, v38
  v_lshlrev_b32 v44, 16, v39
  v_and_b32 v45, 0xffff0000, v39
  v_lshlrev_b32 v46, 16, v40
  v_and_b32 v47, 0xffff0000, v40
  v_lshlrev_b32 v48, 16, v41
  v_and_b32 v49, 0xffff0000, v41
  v_lshlrev_b32 v50, 16, v37
  v_and_b32 v51, 0xffff0000, v37
  v_mul_f32 v22, v12, v42
  v_fmac_f32 v22, v13, v43
  v_fmac_f32 v22, v14, v44
  v_fmac_f32 v22, v15, v45
  v_fmac_f32 v22, v16, v46
  v_fmac_f32 v22, v17, v47
  v_fmac_f32 v22, v18, v48
  v_fmac_f32 v22, v19, v49
  v_fmac_f32 v22, v20, v50
  v_fmac_f32 v22, v21, v51
  s_nop 1
  v_add_f32_dpp v22, v22, v22 quad_perm:[1,0,3,2] row_mask:0xf bank_mask:0xf
  s_nop 1
  v_add_f32_dpp v22, v22, v22 quad_perm:[2,3,0,1] row_mask:0xf bank_mask:0xf
  s_nop 1
  v_add_f32_dpp v22, v22, v22 row_half_mirror row_mask:0xf bank_mask:0xf
  s_nop 1
  v_add_f32_dpp v22, v22, v22 row_mirror row_mask:0xf bank_mask:0xf
  v_mov_b32 v23, v22
  s_nop 1
  v_permlane16_swap_b32 v22, v23
  s_nop 1
  v_add_f32 v22, v22, v23
  v_mov_b32 v23, v22
  s_nop 1
  v_permlane32_swap_b32 v22, v23
  s_nop 1
  v_add_f32 v22, v22, v23
  v_cvt_pk_bf16_f32 v22, v22, v22
  v_lshlrev_b32 v22, 16, v22
  v_mul_f32 v23, s83, v22
  v_sub_f32 v23, 0, v23
  v_exp_f32 v23, v23
  s_nop 0
  v_add_f32 v23, 1.0, v23
  v_rcp_f32 v24, v23
  s_nop 0
  v_fma_f32 v23, -v23, v24, 1.0
  v_fma_f32 v24, v23, v24, v24
  v_cvt_pk_bf16_f32 v24, v24, v24
  v_lshlrev_b32 v24, 16, v24
  v_mov_b32 v5, s64
  s_mov_b64 exec, 1
  ds_write_b32 v5, v24 offset:25088
  s_mov_b64 exec, -1
L_f_noln:
  s_waitcnt lgkmcnt(0)
  s_barrier
  s_lshl_b32 s64, s61, 8
  v_lshrrev_b32 v5, 2, v1
  v_lshlrev_b32 v5, 4, v5
  v_add_u32 v5, s64, v5
  ds_read_b128 v[52:55], v5 offset:0
  ds_read_b128 v[56:59], v5 offset:1024
  ds_read_b128 v[60:63], v5 offset:2048
  ds_read_b128 v[64:67], v5 offset:3072
  ds_read_b128 v[68:71], v5 offset:4096
  ds_read_b128 v[72:75], v5 offset:5120
  ds_read_b128 v[76:79], v5 offset:6144
  ds_read_b128 v[80:83], v5 offset:7168
  ds_read_b128 v[84:87], v5 offset:8192
  ds_read_b128 v[88:91], v5 offset:9216
  v_mov_b32 v92, 0
  v_mov_b32 v93, 0
  v_mov_b32 v94, 0
  v_mov_b32 v95, 0
  v_mov_b32 v96, 0
  v_mov_b32 v97, 0
  v_mov_b32 v98, 0
  v_mov_b32 v99, 0
  v_mov_b32 v100, 0
  v_mov_b32 v101, 0
  v_mov_b32 v102, 0
  v_mov_b32 v103, 0
  v_mov_b32 v104, 0
  v_mov_b32 v105, 0
  v_mov_b32 v106, 0
  v_mov_b32 v107, 0
  v_mov_b32 v108, 0
  v_mov_b32 v109, 0
  v_mov_b32 v110, 0
  v_mov_b32 v111, 0
  v_mov_b32 v112, 0
  v_mov_b32 v113, 0
  v_mov_b32 v114, 0
  v_mov_b32 v115, 0
  v_mov_b32 v116, 0
  v_mov_b32 v117, 0
  v_mov_b32 v118, 0
  v_mov_b32 v119, 0
  v_mov_b32 v120, 0
  v_mov_b32 v121, 0
  v_mov_b32 v122, 0
  v_mov_b32 v123, 0
  s_waitcnt vmcnt(0) lgkmcnt(0)
  v_lshlrev_b32 v5, 16, v190
  v_and_b32 v6, 0xffff0000, v190
  v_fmac_f32 v92, v5, v52
  v_fmac_f32 v93, v6, v52
  v_fmac_f32 v100, v5, v53
  v_fmac_f32 v101, v6, v53
  v_fmac_f32 v108, v5, v54
  v_fmac_f32 v109, v6, v54
  v_fmac_f32 v116, v5, v55
  v_fmac_f32 v117, v6, v55
  v_lshlrev_b32 v5, 16, v191
  v_and_b32 v6, 0xffff0000, v191
  v_fmac_f32 v94, v5, v52
  v_fmac_f32 v95, v6, v52
  v_fmac_f32 v102, v5, v53
  v_fmac_f32 v103, v6, v53
  v_fmac_f32 v110, v5, v54
  v_fmac_f32 v111, v6, v54
  v_fmac_f32 v118, v5, v55
  v_fmac_f32 v119, v6, v55
  v_lshlrev_b32 v5, 16, v192
  v_and_b32 v6, 0xffff0000, v192
  v_fmac_f32 v96, v5, v52
  v_fmac_f32 v97, v6, v52
  v_fmac_f32 v104, v5, v53
  v_fmac_f32 v105, v6, v53
  v_fmac_f32 v112, v5, v54
  v_fmac_f32 v113, v6, v54
  v_fmac_f32 v120, v5, v55
  v_fmac_f32 v121, v6, v55
  v_lshlrev_b32 v5, 16, v193
  v_and_b32 v6, 0xffff0000, v193
  v_fmac_f32 v98, v5, v52
  v_fmac_f32 v99, v6, v52
  v_fmac_f32 v106, v5, v53
  v_fmac_f32 v107, v6, v53
  v_fmac_f32 v114, v5, v54
  v_fmac_f32 v115, v6, v54
  v_fmac_f32 v122, v5, v55
  v_fmac_f32 v123, v6, v55
  v_lshlrev_b32 v5, 16, v194
  v_and_b32 v6, 0xffff0000, v194
  v_fmac_f32 v92, v5, v56
  v_fmac_f32 v93, v6, v56
  v_fmac_f32 v100, v5, v57
  v_fmac_f32 v101, v6, v57
  v_fmac_f32 v108, v5, v58
  v_fmac_f32 v109, v6, v58
  v_fmac_f32 v116, v5, v59
  v_fmac_f32 v117, v6, v59
  v_lshlrev_b32 v5, 16, v195
  v_and_b32 v6, 0xffff0000, v195
  v_fmac_f32 v94, v5, v56
  v_fmac_f32 v95, v6, v56
  v_fmac_f32 v102, v5, v57
  v_fmac_f32 v103, v6, v57
  v_fmac_f32 v110, v5, v58
  v_fmac_f32 v111, v6, v58
  v_fmac_f32 v118, v5, v59
  v_fmac_f32 v119, v6, v59
  v_lshlrev_b32 v5, 16, v196
  v_and_b32 v6, 0xffff0000, v196
  v_fmac_f32 v96, v5, v56
  v_fmac_f32 v97, v6, v56
  v_fmac_f32 v104, v5, v57
  v_fmac_f32 v105, v6, v57
  v_fmac_f32 v112, v5, v58
  v_fmac_f32 v113, v6, v58
  v_fmac_f32 v120, v5, v59
  v_fmac_f32 v121, v6, v59
  v_lshlrev_b32 v5, 16, v197
  v_and_b32 v6, 0xffff0000, v197
  v_fmac_f32 v98, v5, v56
  v_fmac_f32 v99, v6, v56
  v_fmac_f32 v106, v5, v57
  v_fmac_f32 v107, v6, v57
  v_fmac_f32 v114, v5, v58
  v_fmac_f32 v115, v6, v58
  v_fmac_f32 v122, v5, v59
  v_fmac_f32 v123, v6, v59
  v_lshlrev_b32 v5, 16, v198
  v_and_b32 v6, 0xffff0000, v198
  v_fmac_f32 v92, v5, v60
  v_fmac_f32 v93, v6, v60
  v_fmac_f32 v100, v5, v61
  v_fmac_f32 v101, v6, v61
  v_fmac_f32 v108, v5, v62
  v_fmac_f32 v109, v6, v62
  v_fmac_f32 v116, v5, v63
  v_fmac_f32 v117, v6, v63
  v_lshlrev_b32 v5, 16, v199
  v_and_b32 v6, 0xffff0000, v199
  v_fmac_f32 v94, v5, v60
  v_fmac_f32 v95, v6, v60
  v_fmac_f32 v102, v5, v61
  v_fmac_f32 v103, v6, v61
  v_fmac_f32 v110, v5, v62
  v_fmac_f32 v111, v6, v62
  v_fmac_f32 v118, v5, v63
  v_fmac_f32 v119, v6, v63
  v_lshlrev_b32 v5, 16, v200
  v_and_b32 v6, 0xffff0000, v200
  v_fmac_f32 v96, v5, v60
  v_fmac_f32 v97, v6, v60
  v_fmac_f32 v104, v5, v61
  v_fmac_f32 v105, v6, v61
  v_fmac_f32 v112, v5, v62
  v_fmac_f32 v113, v6, v62
  v_fmac_f32 v120, v5, v63
  v_fmac_f32 v121, v6, v63
  v_lshlrev_b32 v5, 16, v201
  v_and_b32 v6, 0xffff0000, v201
  v_fmac_f32 v98, v5, v60
  v_fmac_f32 v99, v6, v60
  v_fmac_f32 v106, v5, v61
  v_fmac_f32 v107, v6, v61
  v_fmac_f32 v114, v5, v62
  v_fmac_f32 v115, v6, v62
  v_fmac_f32 v122, v5, v63
  v_fmac_f32 v123, v6, v63
  v_lshlrev_b32 v5, 16, v202
  v_and_b32 v6, 0xffff0000, v202
  v_fmac_f32 v92, v5, v64
  v_fmac_f32 v93, v6, v64
  v_fmac_f32 v100, v5, v65
  v_fmac_f32 v101, v6, v65
  v_fmac_f32 v108, v5, v66
  v_fmac_f32 v109, v6, v66
  v_fmac_f32 v116, v5, v67
  v_fmac_f32 v117, v6, v67
  v_lshlrev_b32 v5, 16, v203
  v_and_b32 v6, 0xffff0000, v203
  v_fmac_f32 v94, v5, v64
  v_fmac_f32 v95, v6, v64
  v_fmac_f32 v102, v5, v65
  v_fmac_f32 v103, v6, v65
  v_fmac_f32 v110, v5, v66
  v_fmac_f32 v111, v6, v66
  v_fmac_f32 v118, v5, v67
  v_fmac_f32 v119, v6, v67
  v_lshlrev_b32 v5, 16, v204
  v_and_b32 v6, 0xffff0000, v204
  v_fmac_f32 v96, v5, v64
  v_fmac_f32 v97, v6, v64
  v_fmac_f32 v104, v5, v65
  v_fmac_f32 v105, v6, v65
  v_fmac_f32 v112, v5, v66
  v_fmac_f32 v113, v6, v66
  v_fmac_f32 v120, v5, v67
  v_fmac_f32 v121, v6, v67
  v_lshlrev_b32 v5, 16, v205
  v_and_b32 v6, 0xffff0000, v205
  v_fmac_f32 v98, v5, v64
  v_fmac_f32 v99, v6, v64
  v_fmac_f32 v106, v5, v65
  v_fmac_f32 v107, v6, v65
  v_fmac_f32 v114, v5, v66
  v_fmac_f32 v115, v6, v66
  v_fmac_f32 v122, v5, v67
  v_fmac_f32 v123, v6, v67
  v_lshlrev_b32 v5, 16, v206
  v_and_b32 v6, 0xffff0000, v206
  v_fmac_f32 v92, v5, v68
  v_fmac_f32 v93, v6, v68
  v_fmac_f32 v100, v5, v69
  v_fmac_f32 v101, v6, v69
  v_fmac_f32 v108, v5, v70
  v_fmac_f32 v109, v6, v70
  v_fmac_f32 v116, v5, v71
  v_fmac_f32 v117, v6, v71
  v_lshlrev_b32 v5, 16, v207
  v_and_b32 v6, 0xffff0000, v207
  v_fmac_f32 v94, v5, v68
  v_fmac_f32 v95, v6, v68
  v_fmac_f32 v102, v5, v69
  v_fmac_f32 v103, v6, v69
  v_fmac_f32 v110, v5, v70
  v_fmac_f32 v111, v6, v70
  v_fmac_f32 v118, v5, v71
  v_fmac_f32 v119, v6, v71
  v_lshlrev_b32 v5, 16, v208
  v_and_b32 v6, 0xffff0000, v208
  v_fmac_f32 v96, v5, v68
  v_fmac_f32 v97, v6, v68
  v_fmac_f32 v104, v5, v69
  v_fmac_f32 v105, v6, v69
  v_fmac_f32 v112, v5, v70
  v_fmac_f32 v113, v6, v70
  v_fmac_f32 v120, v5, v71
  v_fmac_f32 v121, v6, v71
  v_lshlrev_b32 v5, 16, v209
  v_and_b32 v6, 0xffff0000, v209
  v_fmac_f32 v98, v5, v68
  v_fmac_f32 v99, v6, v68
  v_fmac_f32 v106, v5, v69
  v_fmac_f32 v107, v6, v69
  v_fmac_f32 v114, v5, v70
  v_fmac_f32 v115, v6, v70
  v_fmac_f32 v122, v5, v71
  v_fmac_f32 v123, v6, v71
  v_lshlrev_b32 v5, 16, v210
  v_and_b32 v6, 0xffff0000, v210
  v_fmac_f32 v92, v5, v72
  v_fmac_f32 v93, v6, v72
  v_fmac_f32 v100, v5, v73
  v_fmac_f32 v101, v6, v73
  v_fmac_f32 v108, v5, v74
  v_fmac_f32 v109, v6, v74
  v_fmac_f32 v116, v5, v75
  v_fmac_f32 v117, v6, v75
  v_lshlrev_b32 v5, 16, v211
  v_and_b32 v6, 0xffff0000, v211
  v_fmac_f32 v94, v5, v72
  v_fmac_f32 v95, v6, v72
  v_fmac_f32 v102, v5, v73
  v_fmac_f32 v103, v6, v73
  v_fmac_f32 v110, v5, v74
  v_fmac_f32 v111, v6, v74
  v_fmac_f32 v118, v5, v75
  v_fmac_f32 v119, v6, v75
  v_lshlrev_b32 v5, 16, v212
  v_and_b32 v6, 0xffff0000, v212
  v_fmac_f32 v96, v5, v72
  v_fmac_f32 v97, v6, v72
  v_fmac_f32 v104, v5, v73
  v_fmac_f32 v105, v6, v73
  v_fmac_f32 v112, v5, v74
  v_fmac_f32 v113, v6, v74
  v_fmac_f32 v120, v5, v75
  v_fmac_f32 v121, v6, v75
  v_lshlrev_b32 v5, 16, v213
  v_and_b32 v6, 0xffff0000, v213
  v_fmac_f32 v98, v5, v72
  v_fmac_f32 v99, v6, v72
  v_fmac_f32 v106, v5, v73
  v_fmac_f32 v107, v6, v73
  v_fmac_f32 v114, v5, v74
  v_fmac_f32 v115, v6, v74
  v_fmac_f32 v122, v5, v75
  v_fmac_f32 v123, v6, v75
  v_lshlrev_b32 v5, 16, v214
  v_and_b32 v6, 0xffff0000, v214
  v_fmac_f32 v92, v5, v76
  v_fmac_f32 v93, v6, v76
  v_fmac_f32 v100, v5, v77
  v_fmac_f32 v101, v6, v77
  v_fmac_f32 v108, v5, v78
  v_fmac_f32 v109, v6, v78
  v_fmac_f32 v116, v5, v79
  v_fmac_f32 v117, v6, v79
  v_lshlrev_b32 v5, 16, v215
  v_and_b32 v6, 0xffff0000, v215
  v_fmac_f32 v94, v5, v76
  v_fmac_f32 v95, v6, v76
  v_fmac_f32 v102, v5, v77
  v_fmac_f32 v103, v6, v77
  v_fmac_f32 v110, v5, v78
  v_fmac_f32 v111, v6, v78
  v_fmac_f32 v118, v5, v79
  v_fmac_f32 v119, v6, v79
  v_lshlrev_b32 v5, 16, v216
  v_and_b32 v6, 0xffff0000, v216
  v_fmac_f32 v96, v5, v76
  v_fmac_f32 v97, v6, v76
  v_fmac_f32 v104, v5, v77
  v_fmac_f32 v105, v6, v77
  v_fmac_f32 v112, v5, v78
  v_fmac_f32 v113, v6, v78
  v_fmac_f32 v120, v5, v79
  v_fmac_f32 v121, v6, v79
  v_lshlrev_b32 v5, 16, v217
  v_and_b32 v6, 0xffff0000, v217
  v_fmac_f32 v98, v5, v76
  v_fmac_f32 v99, v6, v76
  v_fmac_f32 v106, v5, v77
  v_fmac_f32 v107, v6, v77
  v_fmac_f32 v114, v5, v78
  v_fmac_f32 v115, v6, v78
  v_fmac_f32 v122, v5, v79
  v_fmac_f32 v123, v6, v79
  v_lshlrev_b32 v5, 16, v218
  v_and_b32 v6, 0xffff0000, v218
  v_fmac_f32 v92, v5, v80
  v_fmac_f32 v93, v6, v80
  v_fmac_f32 v100, v5, v81
  v_fmac_f32 v101, v6, v81
  v_fmac_f32 v108, v5, v82
  v_fmac_f32 v109, v6, v82
  v_fmac_f32 v116, v5, v83
  v_fmac_f32 v117, v6, v83
  v_lshlrev_b32 v5, 16, v219
  v_and_b32 v6, 0xffff0000, v219
  v_fmac_f32 v94, v5, v80
  v_fmac_f32 v95, v6, v80
  v_fmac_f32 v102, v5, v81
  v_fmac_f32 v103, v6, v81
  v_fmac_f32 v110, v5, v82
  v_fmac_f32 v111, v6, v82
  v_fmac_f32 v118, v5, v83
  v_fmac_f32 v119, v6, v83
  v_lshlrev_b32 v5, 16, v220
  v_and_b32 v6, 0xffff0000, v220
  v_fmac_f32 v96, v5, v80
  v_fmac_f32 v97, v6, v80
  v_fmac_f32 v104, v5, v81
  v_fmac_f32 v105, v6, v81
  v_fmac_f32 v112, v5, v82
  v_fmac_f32 v113, v6, v82
  v_fmac_f32 v120, v5, v83
  v_fmac_f32 v121, v6, v83
  v_lshlrev_b32 v5, 16, v221
  v_and_b32 v6, 0xffff0000, v221
  v_fmac_f32 v98, v5, v80
  v_fmac_f32 v99, v6, v80
  v_fmac_f32 v106, v5, v81
  v_fmac_f32 v107, v6, v81
  v_fmac_f32 v114, v5, v82
  v_fmac_f32 v115, v6, v82
  v_fmac_f32 v122, v5, v83
  v_fmac_f32 v123, v6, v83
  v_lshlrev_b32 v5, 16, v222
  v_and_b32 v6, 0xffff0000, v222
  v_fmac_f32 v92, v5, v84
  v_fmac_f32 v93, v6, v84
  v_fmac_f32 v100, v5, v85
  v_fmac_f32 v101, v6, v85
  v_fmac_f32 v108, v5, v86
  v_fmac_f32 v109, v6, v86
  v_fmac_f32 v116, v5, v87
  v_fmac_f32 v117, v6, v87
  v_lshlrev_b32 v5, 16, v223
  v_and_b32 v6, 0xffff0000, v223
  v_fmac_f32 v94, v5, v84
  v_fmac_f32 v95, v6, v84
  v_fmac_f32 v102, v5, v85
  v_fmac_f32 v103, v6, v85
  v_fmac_f32 v110, v5, v86
  v_fmac_f32 v111, v6, v86
  v_fmac_f32 v118, v5, v87
  v_fmac_f32 v119, v6, v87
  v_lshlrev_b32 v5, 16, v224
  v_and_b32 v6, 0xffff0000, v224
  v_fmac_f32 v96, v5, v84
  v_fmac_f32 v97, v6, v84
  v_fmac_f32 v104, v5, v85
  v_fmac_f32 v105, v6, v85
  v_fmac_f32 v112, v5, v86
  v_fmac_f32 v113, v6, v86
  v_fmac_f32 v120, v5, v87
  v_fmac_f32 v121, v6, v87
  v_lshlrev_b32 v5, 16, v225
  v_and_b32 v6, 0xffff0000, v225
  v_fmac_f32 v98, v5, v84
  v_fmac_f32 v99, v6, v84
  v_fmac_f32 v106, v5, v85
  v_fmac_f32 v107, v6, v85
  v_fmac_f32 v114, v5, v86
  v_fmac_f32 v115, v6, v86
  v_fmac_f32 v122, v5, v87
  v_fmac_f32 v123, v6, v87
  v_lshlrev_b32 v5, 16, v226
  v_and_b32 v6, 0xffff0000, v226
  v_fmac_f32 v92, v5, v88
  v_fmac_f32 v93, v6, v88
  v_fmac_f32 v100, v5, v89
  v_fmac_f32 v101, v6, v89
  v_fmac_f32 v108, v5, v90
  v_fmac_f32 v109, v6, v90
  v_fmac_f32 v116, v5, v91
  v_fmac_f32 v117, v6, v91
  v_lshlrev_b32 v5, 16, v227
  v_and_b32 v6, 0xffff0000, v227
  v_fmac_f32 v94, v5, v88
  v_fmac_f32 v95, v6, v88
  v_fmac_f32 v102, v5, v89
  v_fmac_f32 v103, v6, v89
  v_fmac_f32 v110, v5, v90
  v_fmac_f32 v111, v6, v90
  v_fmac_f32 v118, v5, v91
  v_fmac_f32 v119, v6, v91
  v_lshlrev_b32 v5, 16, v228
  v_and_b32 v6, 0xffff0000, v228
  v_fmac_f32 v96, v5, v88
  v_fmac_f32 v97, v6, v88
  v_fmac_f32 v104, v5, v89
  v_fmac_f32 v105, v6, v89
  v_fmac_f32 v112, v5, v90
  v_fmac_f32 v113, v6, v90
  v_fmac_f32 v120, v5, v91
  v_fmac_f32 v121, v6, v91
  v_lshlrev_b32 v5, 16, v229
  v_and_b32 v6, 0xffff0000, v229
  v_fmac_f32 v98, v5, v88
  v_fmac_f32 v99, v6, v88
  v_fmac_f32 v106, v5, v89
  v_fmac_f32 v107, v6, v89
  v_fmac_f32 v114, v5, v90
  v_fmac_f32 v115, v6, v90
  v_fmac_f32 v122, v5, v91
  v_fmac_f32 v123, v6, v91
  s_nop 1
  v_permlane32_swap_b32 v92, v108
  v_permlane32_swap_b32 v93, v109
  v_permlane32_swap_b32 v94, v110
  v_permlane32_swap_b32 v95, v111
  v_permlane32_swap_b32 v96, v112
  v_permlane32_swap_b32 v97, v113
  v_permlane32_swap_b32 v98, v114
  v_permlane32_swap_b32 v99, v115
  v_permlane32_swap_b32 v100, v116
  v_permlane32_swap_b32 v101, v117
  v_permlane32_swap_b32 v102, v118
  v_permlane32_swap_b32 v103, v119
  v_permlane32_swap_b32 v104, v120
  v_permlane32_swap_b32 v105, v121
  v_permlane32_swap_b32 v106, v122
  v_permlane32_swap_b32 v107, v123
  s_nop 0
  v_add_f32 v92, v92, v108
  v_add_f32 v93, v93, v109
  v_add_f32 v94, v94, v110
  v_add_f32 v95, v95, v111
  v_add_f32 v96, v96, v112
  v_add_f32 v97, v97, v113
  v_add_f32 v98, v98, v114
  v_add_f32 v99, v99, v115
  v_add_f32 v100, v100, v116
  v_add_f32 v101, v101, v117
  v_add_f32 v102, v102, v118
  v_add_f32 v103, v103, v119
  v_add_f32 v104, v104, v120
  v_add_f32 v105, v105, v121
  v_add_f32 v106, v106, v122
  v_add_f32 v107, v107, v123
  s_nop 1
  v_permlane16_swap_b32 v92, v100
  v_permlane16_swap_b32 v93, v101
  v_permlane16_swap_b32 v94, v102
  v_permlane16_swap_b32 v95, v103
  v_permlane16_swap_b32 v96, v104
  v_permlane16_swap_b32 v97, v105
  v_permlane16_swap_b32 v98, v106
  v_permlane16_swap_b32 v99, v107
  s_nop 0
  v_add_f32 v92, v92, v100
  v_add_f32 v93, v93, v101
  v_add_f32 v94, v94, v102
  v_add_f32 v95, v95, v103
  v_add_f32 v96, v96, v104
  v_add_f32 v97, v97, v105
  v_add_f32 v98, v98, v106
  v_add_f32 v99, v99, v107
  s_nop 1
  v_add_f32_dpp v92, v92, v92 row_ror:8 row_mask:0xf bank_mask:0x3
  v_add_f32_dpp v93, v93, v93 row_ror:8 row_mask:0xf bank_mask:0x3
  v_add_f32_dpp v94, v94, v94 row_ror:8 row_mask:0xf bank_mask:0x3
  v_add_f32_dpp v95, v95, v95 row_ror:8 row_mask:0xf bank_mask:0x3
  v_add_f32_dpp v92, v96, v96 row_ror:8 row_mask:0xf bank_mask:0xc
  v_add_f32_dpp v93, v97, v97 row_ror:8 row_mask:0xf bank_mask:0xc
  v_add_f32_dpp v94, v98, v98 row_ror:8 row_mask:0xf bank_mask:0xc
  v_add_f32_dpp v95, v99, v99 row_ror:8 row_mask:0xf bank_mask:0xc
  s_nop 1
  v_add_f32_dpp v92, v92, v92 row_shl:4 row_mask:0xf bank_mask:0x5
  v_add_f32_dpp v93, v93, v93 row_shl:4 row_mask:0xf bank_mask:0x5
  v_add_f32_dpp v92, v94, v94 row_shr:4 row_mask:0xf bank_mask:0xa
  v_add_f32_dpp v93, v95, v95 row_shr:4 row_mask:0xf bank_mask:0xa
  v_lshrrev_b32 v5, 4, v1
  v_lshlrev_b32 v5, 7, v5
  v_and_b32 v6, 3, v1
  v_lshlrev_b32 v6, 5, v6
  v_add_u32 v5, v5, v6
  v_bfe_u32 v6, v1, 2, 2
  v_lshlrev_b32 v6, 3, v6
  v_add_u32 v5, v5, v6
  s_lshl_b32 s64, s59, 9
  v_add_u32 v5, s64, v5
  ds_write_b64 v5, v[92:93] offset:20480
  s_waitcnt lgkmcnt(0)
  s_barrier
  s_cmp_lt_u32 s59, 2
  s_cbranch_scc0 L_f_noact
  v_lshlrev_b32 v5, 2, v0
  ds_read_b32 v32, v5 offset:20480
  ds_read_b32 v40, v5 offset:20992
  ds_read_b32 v33, v5 offset:21504
  ds_read_b32 v41, v5 offset:22016
  ds_read_b32 v34, v5 offset:22528
  ds_read_b32 v42, v5 offset:23040
  ds_read_b32 v35, v5 offset:23552
  ds_read_b32 v43, v5 offset:24064
  s_waitcnt lgkmcnt(0)
  v_add_f32 v32, v32, v34
  v_add_f32 v33, v33, v35
  v_add_f32 v12, v32, v33
  v_add_f32 v40, v40, v42
  v_add_f32 v41, v41, v43
  v_add_f32 v13, v40, v41
  v_cvt_pk_bf16_f32 v12, v12, v12
  v_lshlrev_b32 v12, 16, v12
  v_cvt_pk_bf16_f32 v13, v13, v13
  v_lshlrev_b32 v13, 16, v13
  v_mul_f32 v15, s83, v12
  v_sub_f32 v15, 0, v15
  v_exp_f32 v15, v15
  s_nop 0
  v_add_f32 v15, 1.0, v15
  v_rcp_f32 v14, v15
  s_nop 0
  v_fma_f32 v15, -v15, v14, 1.0
  v_fma_f32 v14, v15, v14, v14
  v_mul_f32 v14, v14, v12
  v_cvt_pk_bf16_f32 v14, v14, v14
  v_lshlrev_b32 v14, 16, v14
  v_mul_f32 v14, v14, v13
  v_cvt_pk_bf16_f32 v14, v14, v14
  v_lshlrev_b32 v14, 16, v14
  v_and_b32 v5, 31, v0
  v_lshlrev_b32 v5, 4, v5
  v_lshrrev_b32 v6, 5, v0
  v_lshlrev_b32 v6, 2, v6
  v_add_u32 v5, v5, v6
  ds_write_b32 v5, v14 offset:24576
L_f_noact:
  s_waitcnt lgkmcnt(0)
  s_barrier
  s_lshl_b32 s64, s59, 6
  v_mov_b32 v5, s64
  ds_read_b128 v[52:55], v5 offset:24576
  ds_read_b128 v[56:59], v5 offset:24592
  ds_read_b128 v[60:63], v5 offset:24608
  ds_read_b128 v[64:67], v5 offset:24624
  v_mov_b32 v92, 0
  v_mov_b32 v93, 0
  v_mov_b32 v94, 0
  v_mov_b32 v95, 0
  v_mov_b32 v96, 0
  v_mov_b32 v97, 0
  v_mov_b32 v98, 0
  v_mov_b32 v99, 0
  v_mov_b32 v100, 0
  v_mov_b32 v101, 0
  v_mov_b32 v102, 0
  v_mov_b32 v103, 0
  v_mov_b32 v104, 0
  v_mov_b32 v105, 0
  v_mov_b32 v106, 0
  v_mov_b32 v107, 0
  v_mov_b32 v108, 0
  v_mov_b32 v109, 0
  v_mov_b32 v110, 0
  v_mov_b32 v111, 0
  v_mov_b32 v112, 0
  v_mov_b32 v113, 0
  v_mov_b32 v114, 0
  v_mov_b32 v115, 0
  v_mov_b32 v116, 0
  v_mov_b32 v117, 0
  v_mov_b32 v118, 0
  v_mov_b32 v119, 0
  v_mov_b32 v120, 0
  v_mov_b32 v121, 0
  v_mov_b32 v122, 0
  v_mov_b32 v123, 0
  v_mov_b32 v124, 0
  v_mov_b32 v125, 0
  v_mov_b32 v126, 0
  v_mov_b32 v127, 0
  v_mov_b32 v128, 0
  v_mov_b32 v129, 0
  v_mov_b32 v130, 0
  v_mov_b32 v131, 0
  s_waitcnt lgkmcnt(0)
  v_lshlrev_b32 v5, 16, v230
  v_and_b32 v6, 0xffff0000, v230
  v_fmac_f32 v92, v5, v52
  v_fmac_f32 v93, v6, v52
  v_fmac_f32 v102, v5, v53
  v_fmac_f32 v103, v6, v53
  v_fmac_f32 v112, v5, v54
  v_fmac_f32 v113, v6, v54
  v_fmac_f32 v122, v5, v55
  v_fmac_f32 v123, v6, v55
  v_lshlrev_b32 v5, 16, v231
  v_and_b32 v6, 0xffff0000, v231
  v_fmac_f32 v94, v5, v52
  v_fmac_f32 v95, v6, v52
  v_fmac_f32 v104, v5, v53
  v_fmac_f32 v105, v6, v53
  v_fmac_f32 v114, v5, v54
  v_fmac_f32 v115, v6, v54
  v_fmac_f32 v124, v5, v55
  v_fmac_f32 v125, v6, v55
  v_lshlrev_b32 v5, 16, v232
  v_and_b32 v6, 0xffff0000, v232
  v_fmac_f32 v96, v5, v52
  v_fmac_f32 v97, v6, v52
  v_fmac_f32 v106, v5, v53
  v_fmac_f32 v107, v6, v53
  v_fmac_f32 v116, v5, v54
  v_fmac_f32 v117, v6, v54
  v_fmac_f32 v126, v5, v55
  v_fmac_f32 v127, v6, v55
  v_lshlrev_b32 v5, 16, v233
  v_and_b32 v6, 0xffff0000, v233
  v_fmac_f32 v98, v5, v52
  v_fmac_f32 v99, v6, v52
  v_fmac_f32 v108, v5, v53
  v_fmac_f32 v109, v6, v53
  v_fmac_f32 v118, v5, v54
  v_fmac_f32 v119, v6, v54
  v_fmac_f32 v128, v5, v55
  v_fmac_f32 v129, v6, v55
  v_lshlrev_b32 v5, 16, v246
  v_and_b32 v6, 0xffff0000, v246
  v_fmac_f32 v100, v5, v52
  v_fmac_f32 v101, v6, v52
  v_fmac_f32 v110, v5, v53
  v_fmac_f32 v111, v6, v53
  v_fmac_f32 v120, v5, v54
  v_fmac_f32 v121, v6, v54
  v_fmac_f32 v130, v5, v55
  v_fmac_f32 v131, v6, v55
  v_lshlrev_b32 v5, 16, v234
  v_and_b32 v6, 0xffff0000, v234
  v_fmac_f32 v92, v5, v56
  v_fmac_f32 v93, v6, v56
  v_fmac_f32 v102, v5, v57
  v_fmac_f32 v103, v6, v57
  v_fmac_f32 v112, v5, v58
  v_fmac_f32 v113, v6, v58
  v_fmac_f32 v122, v5, v59
  v_fmac_f32 v123, v6, v59
  v_lshlrev_b32 v5, 16, v235
  v_and_b32 v6, 0xffff0000, v235
  v_fmac_f32 v94, v5, v56
  v_fmac_f32 v95, v6, v56
  v_fmac_f32 v104, v5, v57
  v_fmac_f32 v105, v6, v57
  v_fmac_f32 v114, v5, v58
  v_fmac_f32 v115, v6, v58
  v_fmac_f32 v124, v5, v59
  v_fmac_f32 v125, v6, v59
  v_lshlrev_b32 v5, 16, v236
  v_and_b32 v6, 0xffff0000, v236
  v_fmac_f32 v96, v5, v56
  v_fmac_f32 v97, v6, v56
  v_fmac_f32 v106, v5, v57
  v_fmac_f32 v107, v6, v57
  v_fmac_f32 v116, v5, v58
  v_fmac_f32 v117, v6, v58
  v_fmac_f32 v126, v5, v59
  v_fmac_f32 v127, v6, v59
  v_lshlrev_b32 v5, 16, v237
  v_and_b32 v6, 0xffff0000, v237
  v_fmac_f32 v98, v5, v56
  v_fmac_f32 v99, v6, v56
  v_fmac_f32 v108, v5, v57
  v_fmac_f32 v109, v6, v57
  v_fmac_f32 v118, v5, v58
  v_fmac_f32 v119, v6, v58
  v_fmac_f32 v128, v5, v59
  v_fmac_f32 v129, v6, v59
  v_lshlrev_b32 v5, 16, v247
  v_and_b32 v6, 0xffff0000, v247
  v_fmac_f32 v100, v5, v56
  v_fmac_f32 v101, v6, v56
  v_fmac_f32 v110, v5, v57
  v_fmac_f32 v111, v6, v57
  v_fmac_f32 v120, v5, v58
  v_fmac_f32 v121, v6, v58
  v_fmac_f32 v130, v5, v59
  v_fmac_f32 v131, v6, v59
  v_lshlrev_b32 v5, 16, v238
  v_and_b32 v6, 0xffff0000, v238
  v_fmac_f32 v92, v5, v60
  v_fmac_f32 v93, v6, v60
  v_fmac_f32 v102, v5, v61
  v_fmac_f32 v103, v6, v61
  v_fmac_f32 v112, v5, v62
  v_fmac_f32 v113, v6, v62
  v_fmac_f32 v122, v5, v63
  v_fmac_f32 v123, v6, v63
  v_lshlrev_b32 v5, 16, v239
  v_and_b32 v6, 0xffff0000, v239
  v_fmac_f32 v94, v5, v60
  v_fmac_f32 v95, v6, v60
  v_fmac_f32 v104, v5, v61
  v_fmac_f32 v105, v6, v61
  v_fmac_f32 v114, v5, v62
  v_fmac_f32 v115, v6, v62
  v_fmac_f32 v124, v5, v63
  v_fmac_f32 v125, v6, v63
  v_lshlrev_b32 v5, 16, v240
  v_and_b32 v6, 0xffff0000, v240
  v_fmac_f32 v96, v5, v60
  v_fmac_f32 v97, v6, v60
  v_fmac_f32 v106, v5, v61
  v_fmac_f32 v107, v6, v61
  v_fmac_f32 v116, v5, v62
  v_fmac_f32 v117, v6, v62
  v_fmac_f32 v126, v5, v63
  v_fmac_f32 v127, v6, v63
  v_lshlrev_b32 v5, 16, v241
  v_and_b32 v6, 0xffff0000, v241
  v_fmac_f32 v98, v5, v60
  v_fmac_f32 v99, v6, v60
  v_fmac_f32 v108, v5, v61
  v_fmac_f32 v109, v6, v61
  v_fmac_f32 v118, v5, v62
  v_fmac_f32 v119, v6, v62
  v_fmac_f32 v128, v5, v63
  v_fmac_f32 v129, v6, v63
  v_lshlrev_b32 v5, 16, v248
  v_and_b32 v6, 0xffff0000, v248
  v_fmac_f32 v100, v5, v60
  v_fmac_f32 v101, v6, v60
  v_fmac_f32 v110, v5, v61
  v_fmac_f32 v111, v6, v61
  v_fmac_f32 v120, v5, v62
  v_fmac_f32 v121, v6, v62
  v_fmac_f32 v130, v5, v63
  v_fmac_f32 v131, v6, v63
  v_lshlrev_b32 v5, 16, v242
  v_and_b32 v6, 0xffff0000, v242
  v_fmac_f32 v92, v5, v64
  v_fmac_f32 v93, v6, v64
  v_fmac_f32 v102, v5, v65
  v_fmac_f32 v103, v6, v65
  v_fmac_f32 v112, v5, v66
  v_fmac_f32 v113, v6, v66
  v_fmac_f32 v122, v5, v67
  v_fmac_f32 v123, v6, v67
  v_lshlrev_b32 v5, 16, v243
  v_and_b32 v6, 0xffff0000, v243
  v_fmac_f32 v94, v5, v64
  v_fmac_f32 v95, v6, v64
  v_fmac_f32 v104, v5, v65
  v_fmac_f32 v105, v6, v65
  v_fmac_f32 v114, v5, v66
  v_fmac_f32 v115, v6, v66
  v_fmac_f32 v124, v5, v67
  v_fmac_f32 v125, v6, v67
  v_lshlrev_b32 v5, 16, v244
  v_and_b32 v6, 0xffff0000, v244
  v_fmac_f32 v96, v5, v64
  v_fmac_f32 v97, v6, v64
  v_fmac_f32 v106, v5, v65
  v_fmac_f32 v107, v6, v65
  v_fmac_f32 v116, v5, v66
  v_fmac_f32 v117, v6, v66
  v_fmac_f32 v126, v5, v67
  v_fmac_f32 v127, v6, v67
  v_lshlrev_b32 v5, 16, v245
  v_and_b32 v6, 0xffff0000, v245
  v_fmac_f32 v98, v5, v64
  v_fmac_f32 v99, v6, v64
  v_fmac_f32 v108, v5, v65
  v_fmac_f32 v109, v6, v65
  v_fmac_f32 v118, v5, v66
  v_fmac_f32 v119, v6, v66
  v_fmac_f32 v128, v5, v67
  v_fmac_f32 v129, v6, v67
  v_lshlrev_b32 v5, 16, v249
  v_and_b32 v6, 0xffff0000, v249
  v_fmac_f32 v100, v5, v64
  v_fmac_f32 v101, v6, v64
  v_fmac_f32 v110, v5, v65
  v_fmac_f32 v111, v6, v65
  v_fmac_f32 v120, v5, v66
  v_fmac_f32 v121, v6, v66
  v_fmac_f32 v130, v5, v67
  v_fmac_f32 v131, v6, v67
  s_mul_i32 s64, s59, 10240
  v_lshlrev_b32 v5, 5, v1
  v_add_u32 v5, s64, v5
  v_lshlrev_b32 v6, 3, v1
  v_add_u32 v6, s64, v6
  ds_write_b128 v5, v[92:95] offset:25600
  ds_write_b128 v5, v[96:99] offset:25616
  ds_write_b64 v6, v[100:101] offset:27648
  ds_write_b128 v5, v[102:105] offset:28160
  ds_write_b128 v5, v[106:109] offset:28176
  ds_write_b64 v6, v[110:111] offset:30208
  ds_write_b128 v5, v[112:115] offset:30720
  ds_write_b128 v5, v[116:119] offset:30736
  ds_write_b64 v6, v[120:121] offset:32768
  ds_write_b128 v5, v[122:125] offset:33280
  ds_write_b128 v5, v[126:129] offset:33296
  ds_write_b64 v6, v[130:131] offset:35328
  s_waitcnt lgkmcnt(0)
  s_barrier
  v_lshlrev_b32 v5, 2, v0
  v_add_u32 v6, 25600, v5
  ds_read_b32 v32, v6 offset:0
  ds_read_b32 v33, v6 offset:10240
  ds_read_b32 v34, v6 offset:20480
  ds_read_b32 v35, v6 offset:30720
  ds_read_b32 v36, v6 offset:40960
  ds_read_b32 v37, v6 offset:51200
  v_add_u32 v7, 61440, v6
  ds_read_b32 v38, v7
  v_add_u32 v7, 71680, v6
  ds_read_b32 v39, v7
  v_add_u32 v6, 27648, v5
  ds_read_b32 v40, v6 offset:0
  ds_read_b32 v41, v6 offset:10240
  ds_read_b32 v42, v6 offset:20480
  ds_read_b32 v43, v6 offset:30720
  ds_read_b32 v44, v6 offset:40960
  ds_read_b32 v45, v6 offset:51200
  v_add_u32 v7, 61440, v6
  ds_read_b32 v46, v7
  v_add_u32 v7, 71680, v6
  ds_read_b32 v47, v7
  v_add_u32 v6, 29696, v5
  ds_read_b32 v48, v6 offset:0
  ds_read_b32 v49, v6 offset:10240
  ds_read_b32 v50, v6 offset:20480
  ds_read_b32 v51, v6 offset:30720
  ds_read_b32 v52, v6 offset:40960
  ds_read_b32 v53, v6 offset:51200
  v_add_u32 v7, 61440, v6
  ds_read_b32 v54, v7
  v_add_u32 v7, 71680, v6
  ds_read_b32 v55, v7
  v_add_u32 v6, 31744, v5
  ds_read_b32 v56, v6 offset:0
  ds_read_b32 v57, v6 offset:10240
  ds_read_b32 v58, v6 offset:20480
  ds_read_b32 v59, v6 offset:30720
  ds_read_b32 v60, v6 offset:40960
  ds_read_b32 v61, v6 offset:51200
  v_add_u32 v7, 61440, v6
  ds_read_b32 v62, v7
  v_add_u32 v7, 71680, v6
  ds_read_b32 v63, v7
  v_add_u32 v6, 33792, v5
  ds_read_b32 v64, v6 offset:0
  ds_read_b32 v65, v6 offset:10240
  ds_read_b32 v66, v6 offset:20480
  ds_read_b32 v67, v6 offset:30720
  ds_read_b32 v68, v6 offset:40960
  ds_read_b32 v69, v6 offset:51200
  v_add_u32 v7, 61440, v6
  ds_read_b32 v70, v7
  v_add_u32 v7, 71680, v6
  ds_read_b32 v71, v7
  s_waitcnt lgkmcnt(0)
  v_add_f32 v32, v32, v36
  v_add_f32 v33, v33, v37
  v_add_f32 v34, v34, v38
  v_add_f32 v35, v35, v39
  v_add_f32 v32, v32, v34
  v_add_f32 v33, v33, v35
  v_add_f32 v32, v32, v33
  s_mov_b32 s64, 16384
  s_nop 0
  buffer_atomic_add_f32 v32, v5, s[48:51], s64 offen
  v_add_f32 v40, v40, v44
  v_add_f32 v41, v41, v45
  v_add_f32 v42, v42, v46
  v_add_f32 v43, v43, v47
  v_add_f32 v40, v40, v42
  v_add_f32 v41, v41, v43
  v_add_f32 v40, v40, v41
  s_mov_b32 s64, 18432
  s_nop 0
  buffer_atomic_add_f32 v40, v5, s[48:51], s64 offen
  v_add_f32 v48, v48, v52
  v_add_f32 v49, v49, v53
  v_add_f32 v50, v50, v54
  v_add_f32 v51, v51, v55
  v_add_f32 v48, v48, v50
  v_add_f32 v49, v49, v51
  v_add_f32 v48, v48, v49
  s_mov_b32 s64, 20480
  s_nop 0
  buffer_atomic_add_f32 v48, v5, s[48:51], s64 offen
  v_add_f32 v56, v56, v60
  v_add_f32 v57, v57, v61
  v_add_f32 v58, v58, v62
  v_add_f32 v59, v59, v63
  v_add_f32 v56, v56, v58
  v_add_f32 v57, v57, v59
  v_add_f32 v56, v56, v57
  s_mov_b32 s64, 22528
  s_nop 0
  buffer_atomic_add_f32 v56, v5, s[48:51], s64 offen
  v_add_f32 v64, v64, v68
  v_add_f32 v65, v65, v69
  v_add_f32 v66, v66, v70
  v_add_f32 v67, v67, v71
  v_add_f32 v64, v64, v66
  v_add_f32 v65, v65, v67
  v_add_f32 v64, v64, v65
  s_mov_b32 s64, 24576
  s_nop 0
  buffer_atomic_add_f32 v64, v5, s[48:51], s64 offen
  s_waitcnt vmcnt(0)
  s_barrier
  s_cmp_eq_u32 s59, 0
  s_cbranch_scc0 L_f_noctr
  v_mov_b32 v5, 1
  v_mov_b32 v6, 0
  s_mov_b64 exec, 1
  buffer_atomic_add v5, v6, s[44:47], 0 offen offset:204 sc0 sc1
  s_waitcnt vmcnt(0)
  ds_write_b32 v6, v5 offset:25104
  s_mov_b64 exec, -1
L_f_noctr:
  s_waitcnt lgkmcnt(0)
  s_barrier
  v_mov_b32 v6, 0
  ds_read_b32 v5, v6 offset:25104
  s_waitcnt lgkmcnt(0)
  v_readfirstlane_b32 s64, v5
  s_nop 3
  s_cmp_eq_u32 s64, 47
  s_cbranch_scc0 L_f_end
  v_add_u32 v20, 0, v0
  v_lshlrev_b32 v5, 2, v20
  s_mov_b32 s64, 16384
  s_nop 0
  buffer_load_dword v32, v5, s[48:51], s64 offen sc0 sc1
  ds_read_b32 v40, v5 offset:10240
  v_mov_b32 v6, 0
  v_cmp_le_u32 vcc, 640, v20
  s_nop 1
  v_addc_co_u32 v6, vcc, 0, v6, vcc
  v_cmp_le_u32 vcc, 1280, v20
  s_nop 1
  v_addc_co_u32 v6, vcc, 0, v6, vcc
  v_cmp_le_u32 vcc, 1920, v20
  s_nop 1
  v_addc_co_u32 v6, vcc, 0, v6, vcc
  v_mul_u32_u24 v7, 640, v6
  v_sub_u32 v7, v20, v7
  v_lshlrev_b32 v7, 4, v7
  v_lshlrev_b32 v6, 2, v6
  v_add_u32 v7, v7, v6
  ds_read_b32 v48, v7 offset:0
  ds_read_b32 v56, v6 offset:25088
  v_add_u32 v21, 512, v0
  v_lshlrev_b32 v5, 2, v21
  s_mov_b32 s64, 16384
  s_nop 0
  buffer_load_dword v33, v5, s[48:51], s64 offen sc0 sc1
  ds_read_b32 v41, v5 offset:10240
  v_mov_b32 v6, 0
  v_cmp_le_u32 vcc, 640, v21
  s_nop 1
  v_addc_co_u32 v6, vcc, 0, v6, vcc
  v_cmp_le_u32 vcc, 1280, v21
  s_nop 1
  v_addc_co_u32 v6, vcc, 0, v6, vcc
  v_cmp_le_u32 vcc, 1920, v21
  s_nop 1
  v_addc_co_u32 v6, vcc, 0, v6, vcc
  v_mul_u32_u24 v7, 640, v6
  v_sub_u32 v7, v21, v7
  v_lshlrev_b32 v7, 4, v7
  v_lshlrev_b32 v6, 2, v6
  v_add_u32 v7, v7, v6
  ds_read_b32 v49, v7 offset:0
  ds_read_b32 v57, v6 offset:25088
  v_add_u32 v22, 1024, v0
  v_lshlrev_b32 v5, 2, v22
  s_mov_b32 s64, 16384
  s_nop 0
  buffer_load_dword v34, v5, s[48:51], s64 offen sc0 sc1
  ds_read_b32 v42, v5 offset:10240
  v_mov_b32 v6, 0
  v_cmp_le_u32 vcc, 640, v22
  s_nop 1
  v_addc_co_u32 v6, vcc, 0, v6, vcc
  v_cmp_le_u32 vcc, 1280, v22
  s_nop 1
  v_addc_co_u32 v6, vcc, 0, v6, vcc
  v_cmp_le_u32 vcc, 1920, v22
  s_nop 1
  v_addc_co_u32 v6, vcc, 0, v6, vcc
  v_mul_u32_u24 v7, 640, v6
  v_sub_u32 v7, v22, v7
  v_lshlrev_b32 v7, 4, v7
  v_lshlrev_b32 v6, 2, v6
  v_add_u32 v7, v7, v6
  ds_read_b32 v50, v7 offset:0
  ds_read_b32 v58, v6 offset:25088
  v_add_u32 v23, 1536, v0
  v_lshlrev_b32 v5, 2, v23
  s_mov_b32 s64, 16384
  s_nop 0
  buffer_load_dword v35, v5, s[48:51], s64 offen sc0 sc1
  ds_read_b32 v43, v5 offset:10240
  v_mov_b32 v6, 0
  v_cmp_le_u32 vcc, 640, v23
  s_nop 1
  v_addc_co_u32 v6, vcc, 0, v6, vcc
  v_cmp_le_u32 vcc, 1280, v23
  s_nop 1
  v_addc_co_u32 v6, vcc, 0, v6, vcc
  v_cmp_le_u32 vcc, 1920, v23
  s_nop 1
  v_addc_co_u32 v6, vcc, 0, v6, vcc
  v_mul_u32_u24 v7, 640, v6
  v_sub_u32 v7, v23, v7
  v_lshlrev_b32 v7, 4, v7
  v_lshlrev_b32 v6, 2, v6
  v_add_u32 v7, v7, v6
  ds_read_b32 v51, v7 offset:0
  ds_read_b32 v59, v6 offset:25088
  v_add_u32 v24, 2048, v0
  v_lshlrev_b32 v5, 2, v24
  s_mov_b32 s64, 16384
  s_nop 0
  buffer_load_dword v36, v5, s[48:51], s64 offen sc0 sc1
  ds_read_b32 v44, v5 offset:10240
  v_mov_b32 v6, 0
  v_cmp_le_u32 vcc, 640, v24
  s_nop 1
  v_addc_co_u32 v6, vcc, 0, v6, vcc
  v_cmp_le_u32 vcc, 1280, v24
  s_nop 1
  v_addc_co_u32 v6, vcc, 0, v6, vcc
  v_cmp_le_u32 vcc, 1920, v24
  s_nop 1
  v_addc_co_u32 v6, vcc, 0, v6, vcc
  v_mul_u32_u24 v7, 640, v6
  v_sub_u32 v7, v24, v7
  v_lshlrev_b32 v7, 4, v7
  v_lshlrev_b32 v6, 2, v6
  v_add_u32 v7, v7, v6
  ds_read_b32 v52, v7 offset:0
  ds_read_b32 v60, v6 offset:25088
  s_waitcnt vmcnt(0) lgkmcnt(0)
  v_cvt_pk_bf16_f32 v32, v32, v32
  v_lshlrev_b32 v32, 16, v32
  v_mul_f32 v32, v32, v56
  v_cvt_pk_bf16_f32 v32, v32, v32
  v_lshlrev_b32 v32, 16, v32
  v_add_f32 v32, v32, v48
  v_cvt_pk_bf16_f32 v32, v32, v32
  v_lshlrev_b32 v32, 16, v32
  v_add_f32 v32, v32, v40
  v_cvt_pk_bf16_f32 v32, v32, v32
  v_lshlrev_b32 v5, 1, v20
  buffer_store_short v32, v5, s[72:75], 0 offen
  v_cvt_pk_bf16_f32 v33, v33, v33
  v_lshlrev_b32 v33, 16, v33
  v_mul_f32 v33, v33, v57
  v_cvt_pk_bf16_f32 v33, v33, v33
  v_lshlrev_b32 v33, 16, v33
  v_add_f32 v33, v33, v49
  v_cvt_pk_bf16_f32 v33, v33, v33
  v_lshlrev_b32 v33, 16, v33
  v_add_f32 v33, v33, v41
  v_cvt_pk_bf16_f32 v33, v33, v33
  v_lshlrev_b32 v5, 1, v21
  buffer_store_short v33, v5, s[72:75], 0 offen
  v_cvt_pk_bf16_f32 v34, v34, v34
  v_lshlrev_b32 v34, 16, v34
  v_mul_f32 v34, v34, v58
  v_cvt_pk_bf16_f32 v34, v34, v34
  v_lshlrev_b32 v34, 16, v34
  v_add_f32 v34, v34, v50
  v_cvt_pk_bf16_f32 v34, v34, v34
  v_lshlrev_b32 v34, 16, v34
  v_add_f32 v34, v34, v42
  v_cvt_pk_bf16_f32 v34, v34, v34
  v_lshlrev_b32 v5, 1, v22
  buffer_store_short v34, v5, s[72:75], 0 offen
  v_cvt_pk_bf16_f32 v35, v35, v35
  v_lshlrev_b32 v35, 16, v35
  v_mul_f32 v35, v35, v59
  v_cvt_pk_bf16_f32 v35, v35, v35
  v_lshlrev_b32 v35, 16, v35
  v_add_f32 v35, v35, v51
  v_cvt_pk_bf16_f32 v35, v35, v35
  v_lshlrev_b32 v35, 16, v35
  v_add_f32 v35, v35, v43
  v_cvt_pk_bf16_f32 v35, v35, v35
  v_lshlrev_b32 v5, 1, v23
  buffer_store_short v35, v5, s[72:75], 0 offen
  v_cvt_pk_bf16_f32 v36, v36, v36
  v_lshlrev_b32 v36, 16, v36
  v_mul_f32 v36, v36, v60
  v_cvt_pk_bf16_f32 v36, v36, v36
  v_lshlrev_b32 v36, 16, v36
  v_add_f32 v36, v36, v52
  v_cvt_pk_bf16_f32 v36, v36, v36
  v_lshlrev_b32 v36, 16, v36
  v_add_f32 v36, v36, v44
  v_cvt_pk_bf16_f32 v36, v36, v36
  v_lshlrev_b32 v5, 1, v24
  buffer_store_short v36, v5, s[72:75], 0 offen
L_f_end:
L_endA:
  s_endpgm
.section .rodata,"a"
.p2align 6
.amdhsa_kernel attn_kernel
  .amdhsa_next_free_vgpr 256
  .amdhsa_next_free_sgpr 100
  .amdhsa_accum_offset 256
  .amdhsa_group_segment_fixed_size 0
  .amdhsa_kernarg_size 104
  .amdhsa_user_sgpr_count 2
  .amdhsa_user_sgpr_kernarg_segment_ptr 1
  .amdhsa_system_sgpr_workgroup_id_x 1
.end_amdhsa_kernel
```
